```python
import torch

def _softmax(x, axis=-1):
    return torch.softmax(x, dim=axis)
def _gelu(x):
    return torch.nn.functional.gelu(x, approximate="tanh")
def _silu(x):
    return torch.nn.functional.silu(x)
def _sigmoid(x):
    return torch.sigmoid(x)
def _layernorm(x, axis=-1, eps=1e-5):
    m = x.mean(dim=axis, keepdim=True)
    v = x.var(dim=axis, keepdim=True, unbiased=False)
    return (x - m) / torch.sqrt(v + eps)
def _scatter_add(tgt, idx, src, axis=0):
    return tgt.clone().index_add_(axis, idx, src)
def _segment_sum(src, seg, n):
    out = torch.zeros((n,) + src.shape[1:], dtype=src.dtype)
    return out.index_add_(0, seg, src)
def _pad(x, pw):
    flat = tuple(v for pair in reversed(pw) for v in pair)
    return torch.nn.functional.pad(x, flat)

kernel_name = 'sequential_preLN__mha_block_cached__dense_activation_squared_relu__decode'

def setup_inputs():

    _w = (lambda a: (lambda t: t.to(torch.bfloat16) if t.is_floating_point() else t)(torch.as_tensor(a)))
    def _A_setup():
        B, Sq, D = 2, 1, 640
        H, Sk, Dh = 32, 8192, 192
        return {
            "x": _w((lambda *s: torch.randn(*s, dtype=torch.bfloat16) * 0.05)(B, Sq, D)),
            "k_cache": _w((lambda *s: torch.randn(*s, dtype=torch.bfloat16) * 3.2)(B, H, Sk, Dh)),
            "v_cache": _w((lambda *s: torch.randn(*s, dtype=torch.bfloat16) * 0.4)(B, H, Sk, Dh)),
            "wq": _w((lambda *s: torch.randn(*s, dtype=torch.bfloat16) * 3.2)(D, H * Dh) * (D ** -0.5)),
            "wo": _w((lambda *s: torch.randn(*s, dtype=torch.bfloat16) * 0.4)(H * Dh, D) * ((H * Dh) ** -0.5)),
        }
    _A_in = _A_setup()

    def _B_setup():
        B, S, D, F = 2, 1, 640, 1536
        return {
            "x": _w((lambda *s: torch.randn(*s, dtype=torch.bfloat16) * 0.05)(B, S, D)),
            "w1": _w((lambda *s: torch.randn(*s, dtype=torch.bfloat16) * 0.05)(D, F)),
            "b1": _w((lambda *s: torch.randn(*s, dtype=torch.bfloat16) * 0.8)(F)),
            "w2": _w((lambda *s: torch.randn(*s, dtype=torch.bfloat16) * 0.05)(F, D)),
            "b2": _w((lambda *s: torch.randn(*s, dtype=torch.bfloat16) * 3.2)(D)),
        }
    _B_in = _B_setup()

    return {
        "A_x": _A_in["x"],
        "A_k_cache": _A_in["k_cache"],
        "A_v_cache": _A_in["v_cache"],
        "A_wq": _A_in["wq"],
        "A_wo": _A_in["wo"],
        "B_x": _B_in["x"],
        "B_w1": _B_in["w1"],
        "B_b1": _B_in["b1"],
        "B_w2": _B_in["w2"],
        "B_b2": _B_in["b2"],
    }

def reference(A_x, A_k_cache, A_v_cache, A_wq, A_wo, B_x, B_w1, B_b1, B_w2, B_b2):
    def _A_ref(x, k_cache, v_cache, wq, wo):
        B, Sq, D = x.shape
        H, Dh = 32, 192
        q = (lambda x, *d: x.permute(*d))((x @ wq).reshape(B, Sq, H, Dh), 0, 2, 1, 3)
        scores = torch.einsum("bhqd,bhkd->bhqk", q, k_cache) * (Dh ** -0.5)
        p = _softmax(scores, axis=-1)
        o = torch.einsum("bhqk,bhkd->bhqd", p, v_cache)
        return (lambda x, *d: x.permute(*d))(o, 0, 2, 1, 3).reshape(B, Sq, H * Dh) @ wo

    def _B_ref(x, w1, b1, w2, b2):
        h = torch.einsum("bsd,df->bsf", x, w1) + b1
        zero = torch.zeros_like(h)
        r = torch.where(h > zero, h, zero)
        h = r * r
        out = torch.einsum("bsf,fd->bsd", h, w2) + b2
        return out

    x = A_x
    h = x + _A_ref(_layernorm(x, axis=-1), A_k_cache, A_v_cache, A_wq, A_wo)
    h2 = h + _B_ref(_layernorm(h, axis=-1), B_w1, B_b1, B_w2, B_b2)
    return h2
```

```asm
; @launch grid=(256,1,1) block=(256,1,1) lds=30720
.amdgcn_target "amdgcn-amd-amdhsa--gfx950"
.text
.globl sequential_preLN__mha_block_cached__dense_activation_squared_relu__decode_kernel
.p2align 8
.type sequential_preLN__mha_block_cached__dense_activation_squared_relu__decode_kernel,@function
sequential_preLN__mha_block_cached__dense_activation_squared_relu__decode_kernel:
    s_cmp_ge_u32 s2, 256
    s_cbranch_scc1 L_END
    s_load_dwordx16 s[64:79], s[0:1], 0
    s_load_dwordx8 s[80:87], s[0:1], 64
    s_load_dwordx2 s[88:89], s[0:1], 96
    s_and_b32 s13, s2, 7
    s_lshr_b32 s3, s2, 3
    s_lshl_b32 s14, s13, 2
    s_lshr_b32 s13, s3, 3
    s_add_u32 s14, s14, s13
    s_and_b32 s11, s3, 7
    s_lshl_b32 s3, s14, 3
    s_add_u32 s3, s3, s11
    v_and_b32 v1, 63, v0
    v_lshrrev_b32 v2, 6, v0
    s_nop 0
    v_readfirstlane_b32 s12, v2
    v_lshrrev_b32 v188, 3, v1
    v_and_b32 v189, 7, v1
    v_lshlrev_b32 v189, 4, v189
    v_mul_u32_u24 v2, 384, v188
    v_add_u32 v2, v2, v189
    s_lshl_b32 s13, s11, 2
    s_add_u32 s13, s13, s12
    s_mul_i32 s13, s13, 98304
    v_add_u32 v2, s13, v2
    v_mul_u32_u24 v3, 12288, v188
    v_add_u32 v3, v3, v189
    s_mov_b32 s36, 0x3fb8aa3b
    s_mov_b32 s37, 0x3d93cd3a
    s_mov_b32 s24, 0
    s_mov_b32 s25, 0
    s_mul_i32 s42, s3, 13440
    s_mul_i32 s13, s14, 3145728
    s_waitcnt lgkmcnt(0)
    s_add_u32 s16, s66, s13
    s_addc_u32 s17, s67, 0
    s_mov_b32 s18, 103809024
    s_mov_b32 s19, 0x00020000
    s_add_u32 s20, s68, s13
    s_addc_u32 s21, s69, 0
    s_mov_b32 s22, 103809024
    s_mov_b32 s23, 0x00020000
    s_mul_i32 s13, s14, 384
    s_add_u32 s28, s70, s13
    s_addc_u32 s29, s71, 0
    s_sub_u32 s30, 7864320, s13
    s_mov_b32 s31, 0x00020000
    s_mov_b32 s32, s72
    s_mov_b32 s33, s73
    s_mov_b32 s34, 7864320
    s_mov_b32 s35, 0x00020000

    s_cmp_ge_u32 s12, 2
    s_cbranch_scc1 L_P1_GE2
    s_mul_i32 s13, s12, 1280
    v_lshl_add_u32 v191, v1, 2, s13

    global_load_dword v74, v191, s[64:65] offset:0
    global_load_dword v75, v191, s[64:65] offset:256
    global_load_dword v76, v191, s[64:65] offset:512
    global_load_dword v77, v191, s[64:65] offset:768
    global_load_dword v78, v191, s[64:65] offset:1024
    s_cmp_eq_u32 s12, 0
    s_cbranch_scc1 L_P1_NZ
    v_mov_b32 v192, 0
    v_mov_b32 v193, 0
    v_mov_b32 v194, 0
    v_mov_b32 v195, 0
    v_lshl_add_u32 v191, v1, 4, s42
    global_store_dwordx4 v191, v[192:195], s[88:89] sc1
    v_min_u32 v191, 38, v1
    v_lshl_add_u32 v191, v191, 4, s42
    global_store_dwordx4 v191, v[192:195], s[88:89] offset:1024 sc1
    s_barrier
    s_waitcnt vmcnt(0)
    s_mov_b64 s[40:41], exec
    s_mov_b64 exec, 1
    s_lshl_b32 s13, s14, 2
    v_mov_b32 v192, s13
    v_mov_b32 v193, 1
    global_atomic_add v192, v193, s[86:87]
    s_mov_b64 exec, s[40:41]
    s_branch L_P1_LN
L_P1_NZ:
    s_barrier
    s_waitcnt vmcnt(0)
L_P1_LN:

    v_lshlrev_b32 v80, 16, v74
    v_and_b32 v81, 0xffff0000, v74
    v_lshlrev_b32 v82, 16, v75
    v_and_b32 v83, 0xffff0000, v75
    v_lshlrev_b32 v84, 16, v76
    v_and_b32 v85, 0xffff0000, v76
    v_lshlrev_b32 v86, 16, v77
    v_and_b32 v87, 0xffff0000, v77
    v_lshlrev_b32 v88, 16, v78
    v_and_b32 v89, 0xffff0000, v78
    v_add_f32 v90, v80, v81
    v_add_f32 v90, v90, v82
    v_add_f32 v90, v90, v83
    v_add_f32 v90, v90, v84
    v_add_f32 v90, v90, v85
    v_add_f32 v90, v90, v86
    v_add_f32 v90, v90, v87
    v_add_f32 v90, v90, v88
    v_add_f32 v90, v90, v89
    s_nop 1
    v_add_f32_dpp v91, v90, v90 quad_perm:[1,0,3,2] row_mask:0xf bank_mask:0xf
    s_nop 1
    v_add_f32_dpp v90, v91, v91 quad_perm:[2,3,0,1] row_mask:0xf bank_mask:0xf
    s_nop 1
    v_add_f32_dpp v91, v90, v90 row_half_mirror row_mask:0xf bank_mask:0xf
    s_nop 1
    v_add_f32_dpp v90, v91, v91 row_mirror row_mask:0xf bank_mask:0xf
    s_nop 1
    v_readlane_b32 s44, v90, 0
    v_readlane_b32 s45, v90, 16
    v_readlane_b32 s46, v90, 32
    v_readlane_b32 s47, v90, 48
    s_nop 1
    v_mov_b32 v90, s44
    v_add_f32 v90, s45, v90
    v_add_f32 v90, s46, v90
    v_add_f32 v90, s47, v90
    v_mul_f32 v92, 0x3acccccd, v90
    v_sub_f32 v91, v80, v92
    v_mul_f32 v90, v91, v91
    v_sub_f32 v91, v81, v92
    v_fmac_f32 v90, v91, v91
    v_sub_f32 v91, v82, v92
    v_fmac_f32 v90, v91, v91
    v_sub_f32 v91, v83, v92
    v_fmac_f32 v90, v91, v91
    v_sub_f32 v91, v84, v92
    v_fmac_f32 v90, v91, v91
    v_sub_f32 v91, v85, v92
    v_fmac_f32 v90, v91, v91
    v_sub_f32 v91, v86, v92
    v_fmac_f32 v90, v91, v91
    v_sub_f32 v91, v87, v92
    v_fmac_f32 v90, v91, v91
    v_sub_f32 v91, v88, v92
    v_fmac_f32 v90, v91, v91
    v_sub_f32 v91, v89, v92
    v_fmac_f32 v90, v91, v91
    s_nop 1
    v_add_f32_dpp v91, v90, v90 quad_perm:[1,0,3,2] row_mask:0xf bank_mask:0xf
    s_nop 1
    v_add_f32_dpp v90, v91, v91 quad_perm:[2,3,0,1] row_mask:0xf bank_mask:0xf
    s_nop 1
    v_add_f32_dpp v91, v90, v90 row_half_mirror row_mask:0xf bank_mask:0xf
    s_nop 1
    v_add_f32_dpp v90, v91, v91 row_mirror row_mask:0xf bank_mask:0xf
    s_nop 1
    v_readlane_b32 s44, v90, 0
    v_readlane_b32 s45, v90, 16
    v_readlane_b32 s46, v90, 32
    v_readlane_b32 s47, v90, 48
    s_nop 1
    v_mov_b32 v90, s44
    v_add_f32 v90, s45, v90
    v_add_f32 v90, s46, v90
    v_add_f32 v90, s47, v90
    v_mul_f32 v90, 0x3acccccd, v90
    v_cvt_pk_bf16_f32 v90, v90, v90
    v_and_b32 v90, 0xffff0000, v90
    v_cvt_pk_bf16_f32 v92, v92, v92
    v_and_b32 v92, 0xffff0000, v92
    v_add_f32 v90, 0x3727c5ac, v90
    v_cvt_pk_bf16_f32 v90, v90, v90
    v_and_b32 v90, 0xffff0000, v90
    v_sqrt_f32 v93, v90
    s_nop 0
    v_cvt_pk_bf16_f32 v93, v93, v93
    v_and_b32 v93, 0xffff0000, v93
    v_rcp_f32 v94, v93
    s_nop 0
    v_sub_f32 v80, v80, v92
    v_cvt_pk_bf16_f32 v80, v80, v80
    v_and_b32 v80, 0xffff0000, v80
    v_mul_f32 v95, v80, v94
    v_fma_f32 v91, -v95, v93, v80
    v_fma_f32 v80, v91, v94, v95
    v_cvt_pk_bf16_f32 v80, v80, v80
    v_and_b32 v80, 0xffff0000, v80
    v_sub_f32 v81, v81, v92
    v_cvt_pk_bf16_f32 v81, v81, v81
    v_and_b32 v81, 0xffff0000, v81
    v_mul_f32 v95, v81, v94
    v_fma_f32 v91, -v95, v93, v81
    v_fma_f32 v81, v91, v94, v95
    v_cvt_pk_bf16_f32 v81, v81, v81
    v_and_b32 v81, 0xffff0000, v81
    v_sub_f32 v82, v82, v92
    v_cvt_pk_bf16_f32 v82, v82, v82
    v_and_b32 v82, 0xffff0000, v82
    v_mul_f32 v95, v82, v94
    v_fma_f32 v91, -v95, v93, v82
    v_fma_f32 v82, v91, v94, v95
    v_cvt_pk_bf16_f32 v82, v82, v82
    v_and_b32 v82, 0xffff0000, v82
    v_sub_f32 v83, v83, v92
    v_cvt_pk_bf16_f32 v83, v83, v83
    v_and_b32 v83, 0xffff0000, v83
    v_mul_f32 v95, v83, v94
    v_fma_f32 v91, -v95, v93, v83
    v_fma_f32 v83, v91, v94, v95
    v_cvt_pk_bf16_f32 v83, v83, v83
    v_and_b32 v83, 0xffff0000, v83
    v_sub_f32 v84, v84, v92
    v_cvt_pk_bf16_f32 v84, v84, v84
    v_and_b32 v84, 0xffff0000, v84
    v_mul_f32 v95, v84, v94
    v_fma_f32 v91, -v95, v93, v84
    v_fma_f32 v84, v91, v94, v95
    v_cvt_pk_bf16_f32 v84, v84, v84
    v_and_b32 v84, 0xffff0000, v84
    v_sub_f32 v85, v85, v92
    v_cvt_pk_bf16_f32 v85, v85, v85
    v_and_b32 v85, 0xffff0000, v85
    v_mul_f32 v95, v85, v94
    v_fma_f32 v91, -v95, v93, v85
    v_fma_f32 v85, v91, v94, v95
    v_cvt_pk_bf16_f32 v85, v85, v85
    v_and_b32 v85, 0xffff0000, v85
    v_sub_f32 v86, v86, v92
    v_cvt_pk_bf16_f32 v86, v86, v86
    v_and_b32 v86, 0xffff0000, v86
    v_mul_f32 v95, v86, v94
    v_fma_f32 v91, -v95, v93, v86
    v_fma_f32 v86, v91, v94, v95
    v_cvt_pk_bf16_f32 v86, v86, v86
    v_and_b32 v86, 0xffff0000, v86
    v_sub_f32 v87, v87, v92
    v_cvt_pk_bf16_f32 v87, v87, v87
    v_and_b32 v87, 0xffff0000, v87
    v_mul_f32 v95, v87, v94
    v_fma_f32 v91, -v95, v93, v87
    v_fma_f32 v87, v91, v94, v95
    v_cvt_pk_bf16_f32 v87, v87, v87
    v_and_b32 v87, 0xffff0000, v87
    v_sub_f32 v88, v88, v92
    v_cvt_pk_bf16_f32 v88, v88, v88
    v_and_b32 v88, 0xffff0000, v88
    v_mul_f32 v95, v88, v94
    v_fma_f32 v91, -v95, v93, v88
    v_fma_f32 v88, v91, v94, v95
    v_cvt_pk_bf16_f32 v88, v88, v88
    v_and_b32 v88, 0xffff0000, v88
    v_sub_f32 v89, v89, v92
    v_cvt_pk_bf16_f32 v89, v89, v89
    v_and_b32 v89, 0xffff0000, v89
    v_mul_f32 v95, v89, v94
    v_fma_f32 v91, -v95, v93, v89
    v_fma_f32 v89, v91, v94, v95
    v_cvt_pk_bf16_f32 v89, v89, v89
    v_and_b32 v89, 0xffff0000, v89
    s_mul_i32 s13, s12, 2560
    v_lshl_add_u32 v188, v1, 3, s13
    ds_write_b64 v188, v[80:81] offset:0
    ds_write_b64 v188, v[82:83] offset:512
    ds_write_b64 v188, v[84:85] offset:1024
    ds_write_b64 v188, v[86:87] offset:1536
    ds_write_b64 v188, v[88:89] offset:2048
    s_branch L_P1_RING
L_P1_GE2:
    s_mul_i32 s13, s11, 80
    s_sub_u32 s26, s12, 2
    s_mul_i32 s26, s26, 40
    s_add_u32 s26, s26, s13
    s_mul_i32 s26, s26, 12288

    buffer_load_dwordx4 v[64:67], v3, s[28:31], s26 offen offset:0 nt
    buffer_load_dwordx4 v[68:71], v3, s[28:31], s26 offen offset:128 nt
    buffer_load_dwordx4 v[72:75], v3, s[28:31], s26 offen offset:256 nt
    s_add_u32 s26, s26, 98304
    buffer_load_dwordx4 v[76:79], v3, s[28:31], s26 offen offset:0 nt
    buffer_load_dwordx4 v[80:83], v3, s[28:31], s26 offen offset:128 nt
    buffer_load_dwordx4 v[84:87], v3, s[28:31], s26 offen offset:256 nt
    s_add_u32 s26, s26, 98304
    buffer_load_dwordx4 v[88:91], v3, s[28:31], s26 offen offset:0 nt
    buffer_load_dwordx4 v[92:95], v3, s[28:31], s26 offen offset:128 nt
    buffer_load_dwordx4 v[96:99], v3, s[28:31], s26 offen offset:256 nt
    s_add_u32 s26, s26, 98304
    buffer_load_dwordx4 v[100:103], v3, s[28:31], s26 offen offset:0 nt
    buffer_load_dwordx4 v[104:107], v3, s[28:31], s26 offen offset:128 nt
    buffer_load_dwordx4 v[108:111], v3, s[28:31], s26 offen offset:256 nt
    s_add_u32 s26, s26, 98304
    buffer_load_dwordx4 v[112:115], v3, s[28:31], s26 offen offset:0 nt
    buffer_load_dwordx4 v[116:119], v3, s[28:31], s26 offen offset:128 nt
    buffer_load_dwordx4 v[120:123], v3, s[28:31], s26 offen offset:256 nt
    s_add_u32 s26, s26, 98304
    s_barrier
L_P1_RING:

    buffer_load_dwordx4 v[128:131], v2, s[16:19], s24 offen offset:0 nt
    buffer_load_dwordx4 v[132:135], v2, s[16:19], s24 offen offset:128 nt
    buffer_load_dwordx4 v[136:139], v2, s[16:19], s24 offen offset:256 nt
    s_add_u32 s24, s24, 3072
    buffer_load_dwordx4 v[140:143], v2, s[16:19], s24 offen offset:0 nt
    buffer_load_dwordx4 v[144:147], v2, s[16:19], s24 offen offset:128 nt
    buffer_load_dwordx4 v[148:151], v2, s[16:19], s24 offen offset:256 nt
    s_add_u32 s24, s24, 3072
    buffer_load_dwordx4 v[152:155], v2, s[16:19], s24 offen offset:0 nt
    buffer_load_dwordx4 v[156:159], v2, s[16:19], s24 offen offset:128 nt
    buffer_load_dwordx4 v[160:163], v2, s[16:19], s24 offen offset:256 nt
    s_add_u32 s24, s24, 3072
    buffer_load_dwordx4 v[164:167], v2, s[16:19], s24 offen offset:0 nt
    buffer_load_dwordx4 v[168:171], v2, s[16:19], s24 offen offset:128 nt
    buffer_load_dwordx4 v[172:175], v2, s[16:19], s24 offen offset:256 nt
    s_add_u32 s24, s24, 3072
    buffer_load_dwordx4 v[176:179], v2, s[16:19], s24 offen offset:0 nt
    buffer_load_dwordx4 v[180:183], v2, s[16:19], s24 offen offset:128 nt
    buffer_load_dwordx4 v[184:187], v2, s[16:19], s24 offen offset:256 nt
    s_add_u32 s24, s24, 3072
    s_cmp_lt_u32 s12, 2
    s_cbranch_scc1 L_NOE1
    buffer_load_dwordx4 a[76:79], v2, s[16:19], s24 offen offset:0 nt
    buffer_load_dwordx4 a[80:83], v2, s[16:19], s24 offen offset:128 nt
    buffer_load_dwordx4 a[84:87], v2, s[16:19], s24 offen offset:256 nt
    s_add_u32 s24, s24, 3072
    buffer_load_dwordx4 a[88:91], v2, s[16:19], s24 offen offset:0 nt
    buffer_load_dwordx4 a[92:95], v2, s[16:19], s24 offen offset:128 nt
    buffer_load_dwordx4 a[96:99], v2, s[16:19], s24 offen offset:256 nt
    s_add_u32 s24, s24, 3072
    buffer_load_dwordx4 a[100:103], v2, s[16:19], s24 offen offset:0 nt
    buffer_load_dwordx4 a[104:107], v2, s[16:19], s24 offen offset:128 nt
    buffer_load_dwordx4 a[108:111], v2, s[16:19], s24 offen offset:256 nt
    s_add_u32 s24, s24, 3072
L_NOE1:
    s_waitcnt lgkmcnt(0)
    s_barrier

    s_cmp_lt_u32 s12, 2
    s_cbranch_scc1 L_P3_SKIP
    v_lshrrev_b32 v188, 3, v1
    s_mul_i32 s13, s11, 80
    s_sub_u32 s26, s12, 2
    s_mul_i32 s26, s26, 40
    s_add_u32 s13, s13, s26
    v_add_u32 v188, s13, v188
    v_lshlrev_b32 v188, 2, v188

    ds_read_b32 v4, v188 offset:0
    ds_read_b32 v5, v188 offset:32
    ds_read_b32 v6, v188 offset:64
    ds_read_b32 v7, v188 offset:96
    ds_read_b32 v8, v188 offset:128
    ds_read_b32 v9, v188 offset:2560
    ds_read_b32 v10, v188 offset:2592
    ds_read_b32 v11, v188 offset:2624
    ds_read_b32 v12, v188 offset:2656
    ds_read_b32 v13, v188 offset:2688
    v_mov_b32 v16, 0
    v_mov_b32 v17, 0
    v_mov_b32 v18, 0
    v_mov_b32 v19, 0
    v_mov_b32 v20, 0
    v_mov_b32 v21, 0
    v_mov_b32 v22, 0
    v_mov_b32 v23, 0
    v_mov_b32 v24, 0
    v_mov_b32 v25, 0
    v_mov_b32 v26, 0
    v_mov_b32 v27, 0
    v_mov_b32 v28, 0
    v_mov_b32 v29, 0
    v_mov_b32 v30, 0
    v_mov_b32 v31, 0
    v_mov_b32 v32, 0
    v_mov_b32 v33, 0
    v_mov_b32 v34, 0
    v_mov_b32 v35, 0
    v_mov_b32 v36, 0
    v_mov_b32 v37, 0
    v_mov_b32 v38, 0
    v_mov_b32 v39, 0
    v_mov_b32 v40, 0
    v_mov_b32 v41, 0
    v_mov_b32 v42, 0
    v_mov_b32 v43, 0
    v_mov_b32 v44, 0
    v_mov_b32 v45, 0
    v_mov_b32 v46, 0
    v_mov_b32 v47, 0
    v_mov_b32 v48, 0
    v_mov_b32 v49, 0
    v_mov_b32 v50, 0
    v_mov_b32 v51, 0
    v_mov_b32 v52, 0
    v_mov_b32 v53, 0
    v_mov_b32 v54, 0
    v_mov_b32 v55, 0
    v_mov_b32 v56, 0
    v_mov_b32 v57, 0
    v_mov_b32 v58, 0
    v_mov_b32 v59, 0
    v_mov_b32 v60, 0
    v_mov_b32 v61, 0
    v_mov_b32 v62, 0
    v_mov_b32 v63, 0
    s_waitcnt vmcnt(24) lgkmcnt(0)
    v_lshrrev_b32 v189, 16, v4
    v_dot2c_f32_bf16 v16, v64, v189
    v_dot2c_f32_bf16 v17, v64, v4
    v_dot2c_f32_bf16 v18, v65, v189
    v_dot2c_f32_bf16 v19, v65, v4
    v_dot2c_f32_bf16 v20, v66, v189
    v_dot2c_f32_bf16 v21, v66, v4
    v_dot2c_f32_bf16 v22, v67, v189
    v_dot2c_f32_bf16 v23, v67, v4
    v_dot2c_f32_bf16 v24, v68, v189
    v_dot2c_f32_bf16 v25, v68, v4
    v_dot2c_f32_bf16 v26, v69, v189
    v_dot2c_f32_bf16 v27, v69, v4
    v_dot2c_f32_bf16 v28, v70, v189
    v_dot2c_f32_bf16 v29, v70, v4
    v_dot2c_f32_bf16 v30, v71, v189
    v_dot2c_f32_bf16 v31, v71, v4
    v_dot2c_f32_bf16 v32, v72, v189
    v_dot2c_f32_bf16 v33, v72, v4
    v_dot2c_f32_bf16 v34, v73, v189
    v_dot2c_f32_bf16 v35, v73, v4
    v_dot2c_f32_bf16 v36, v74, v189
    v_dot2c_f32_bf16 v37, v74, v4
    v_dot2c_f32_bf16 v38, v75, v189
    v_dot2c_f32_bf16 v39, v75, v4
    v_lshrrev_b32 v189, 16, v9
    v_dot2c_f32_bf16 v40, v64, v189
    v_dot2c_f32_bf16 v41, v64, v9
    v_dot2c_f32_bf16 v42, v65, v189
    v_dot2c_f32_bf16 v43, v65, v9
    v_dot2c_f32_bf16 v44, v66, v189
    v_dot2c_f32_bf16 v45, v66, v9
    v_dot2c_f32_bf16 v46, v67, v189
    v_dot2c_f32_bf16 v47, v67, v9
    v_dot2c_f32_bf16 v48, v68, v189
    v_dot2c_f32_bf16 v49, v68, v9
    v_dot2c_f32_bf16 v50, v69, v189
    v_dot2c_f32_bf16 v51, v69, v9
    v_dot2c_f32_bf16 v52, v70, v189
    v_dot2c_f32_bf16 v53, v70, v9
    v_dot2c_f32_bf16 v54, v71, v189
    v_dot2c_f32_bf16 v55, v71, v9
    v_dot2c_f32_bf16 v56, v72, v189
    v_dot2c_f32_bf16 v57, v72, v9
    v_dot2c_f32_bf16 v58, v73, v189
    v_dot2c_f32_bf16 v59, v73, v9
    v_dot2c_f32_bf16 v60, v74, v189
    v_dot2c_f32_bf16 v61, v74, v9
    v_dot2c_f32_bf16 v62, v75, v189
    v_dot2c_f32_bf16 v63, v75, v9
    v_lshrrev_b32 v189, 16, v5
    v_dot2c_f32_bf16 v16, v76, v189
    v_dot2c_f32_bf16 v17, v76, v5
    v_dot2c_f32_bf16 v18, v77, v189
    v_dot2c_f32_bf16 v19, v77, v5
    v_dot2c_f32_bf16 v20, v78, v189
    v_dot2c_f32_bf16 v21, v78, v5
    v_dot2c_f32_bf16 v22, v79, v189
    v_dot2c_f32_bf16 v23, v79, v5
    v_dot2c_f32_bf16 v24, v80, v189
    v_dot2c_f32_bf16 v25, v80, v5
    v_dot2c_f32_bf16 v26, v81, v189
    v_dot2c_f32_bf16 v27, v81, v5
    v_dot2c_f32_bf16 v28, v82, v189
    v_dot2c_f32_bf16 v29, v82, v5
    v_dot2c_f32_bf16 v30, v83, v189
    v_dot2c_f32_bf16 v31, v83, v5
    v_dot2c_f32_bf16 v32, v84, v189
    v_dot2c_f32_bf16 v33, v84, v5
    v_dot2c_f32_bf16 v34, v85, v189
    v_dot2c_f32_bf16 v35, v85, v5
    v_dot2c_f32_bf16 v36, v86, v189
    v_dot2c_f32_bf16 v37, v86, v5
    v_dot2c_f32_bf16 v38, v87, v189
    v_dot2c_f32_bf16 v39, v87, v5
    v_lshrrev_b32 v189, 16, v10
    v_dot2c_f32_bf16 v40, v76, v189
    v_dot2c_f32_bf16 v41, v76, v10
    v_dot2c_f32_bf16 v42, v77, v189
    v_dot2c_f32_bf16 v43, v77, v10
    v_dot2c_f32_bf16 v44, v78, v189
    v_dot2c_f32_bf16 v45, v78, v10
    v_dot2c_f32_bf16 v46, v79, v189
    v_dot2c_f32_bf16 v47, v79, v10
    v_dot2c_f32_bf16 v48, v80, v189
    v_dot2c_f32_bf16 v49, v80, v10
    v_dot2c_f32_bf16 v50, v81, v189
    v_dot2c_f32_bf16 v51, v81, v10
    v_dot2c_f32_bf16 v52, v82, v189
    v_dot2c_f32_bf16 v53, v82, v10
    v_dot2c_f32_bf16 v54, v83, v189
    v_dot2c_f32_bf16 v55, v83, v10
    v_dot2c_f32_bf16 v56, v84, v189
    v_dot2c_f32_bf16 v57, v84, v10
    v_dot2c_f32_bf16 v58, v85, v189
    v_dot2c_f32_bf16 v59, v85, v10
    v_dot2c_f32_bf16 v60, v86, v189
    v_dot2c_f32_bf16 v61, v86, v10
    v_dot2c_f32_bf16 v62, v87, v189
    v_dot2c_f32_bf16 v63, v87, v10
    v_lshrrev_b32 v189, 16, v6
    v_dot2c_f32_bf16 v16, v88, v189
    v_dot2c_f32_bf16 v17, v88, v6
    v_dot2c_f32_bf16 v18, v89, v189
    v_dot2c_f32_bf16 v19, v89, v6
    v_dot2c_f32_bf16 v20, v90, v189
    v_dot2c_f32_bf16 v21, v90, v6
    v_dot2c_f32_bf16 v22, v91, v189
    v_dot2c_f32_bf16 v23, v91, v6
    v_dot2c_f32_bf16 v24, v92, v189
    v_dot2c_f32_bf16 v25, v92, v6
    v_dot2c_f32_bf16 v26, v93, v189
    v_dot2c_f32_bf16 v27, v93, v6
    v_dot2c_f32_bf16 v28, v94, v189
    v_dot2c_f32_bf16 v29, v94, v6
    v_dot2c_f32_bf16 v30, v95, v189
    v_dot2c_f32_bf16 v31, v95, v6
    v_dot2c_f32_bf16 v32, v96, v189
    v_dot2c_f32_bf16 v33, v96, v6
    v_dot2c_f32_bf16 v34, v97, v189
    v_dot2c_f32_bf16 v35, v97, v6
    v_dot2c_f32_bf16 v36, v98, v189
    v_dot2c_f32_bf16 v37, v98, v6
    v_dot2c_f32_bf16 v38, v99, v189
    v_dot2c_f32_bf16 v39, v99, v6
    v_lshrrev_b32 v189, 16, v11
    v_dot2c_f32_bf16 v40, v88, v189
    v_dot2c_f32_bf16 v41, v88, v11
    v_dot2c_f32_bf16 v42, v89, v189
    v_dot2c_f32_bf16 v43, v89, v11
    v_dot2c_f32_bf16 v44, v90, v189
    v_dot2c_f32_bf16 v45, v90, v11
    v_dot2c_f32_bf16 v46, v91, v189
    v_dot2c_f32_bf16 v47, v91, v11
    v_dot2c_f32_bf16 v48, v92, v189
    v_dot2c_f32_bf16 v49, v92, v11
    v_dot2c_f32_bf16 v50, v93, v189
    v_dot2c_f32_bf16 v51, v93, v11
    v_dot2c_f32_bf16 v52, v94, v189
    v_dot2c_f32_bf16 v53, v94, v11
    v_dot2c_f32_bf16 v54, v95, v189
    v_dot2c_f32_bf16 v55, v95, v11
    v_dot2c_f32_bf16 v56, v96, v189
    v_dot2c_f32_bf16 v57, v96, v11
    v_dot2c_f32_bf16 v58, v97, v189
    v_dot2c_f32_bf16 v59, v97, v11
    v_dot2c_f32_bf16 v60, v98, v189
    v_dot2c_f32_bf16 v61, v98, v11
    v_dot2c_f32_bf16 v62, v99, v189
    v_dot2c_f32_bf16 v63, v99, v11
    v_lshrrev_b32 v189, 16, v7
    v_dot2c_f32_bf16 v16, v100, v189
    v_dot2c_f32_bf16 v17, v100, v7
    v_dot2c_f32_bf16 v18, v101, v189
    v_dot2c_f32_bf16 v19, v101, v7
    v_dot2c_f32_bf16 v20, v102, v189
    v_dot2c_f32_bf16 v21, v102, v7
    v_dot2c_f32_bf16 v22, v103, v189
    v_dot2c_f32_bf16 v23, v103, v7
    v_dot2c_f32_bf16 v24, v104, v189
    v_dot2c_f32_bf16 v25, v104, v7
    v_dot2c_f32_bf16 v26, v105, v189
    v_dot2c_f32_bf16 v27, v105, v7
    v_dot2c_f32_bf16 v28, v106, v189
    v_dot2c_f32_bf16 v29, v106, v7
    v_dot2c_f32_bf16 v30, v107, v189
    v_dot2c_f32_bf16 v31, v107, v7
    v_dot2c_f32_bf16 v32, v108, v189
    v_dot2c_f32_bf16 v33, v108, v7
    v_dot2c_f32_bf16 v34, v109, v189
    v_dot2c_f32_bf16 v35, v109, v7
    v_dot2c_f32_bf16 v36, v110, v189
    v_dot2c_f32_bf16 v37, v110, v7
    v_dot2c_f32_bf16 v38, v111, v189
    v_dot2c_f32_bf16 v39, v111, v7
    v_lshrrev_b32 v189, 16, v12
    v_dot2c_f32_bf16 v40, v100, v189
    v_dot2c_f32_bf16 v41, v100, v12
    v_dot2c_f32_bf16 v42, v101, v189
    v_dot2c_f32_bf16 v43, v101, v12
    v_dot2c_f32_bf16 v44, v102, v189
    v_dot2c_f32_bf16 v45, v102, v12
    v_dot2c_f32_bf16 v46, v103, v189
    v_dot2c_f32_bf16 v47, v103, v12
    v_dot2c_f32_bf16 v48, v104, v189
    v_dot2c_f32_bf16 v49, v104, v12
    v_dot2c_f32_bf16 v50, v105, v189
    v_dot2c_f32_bf16 v51, v105, v12
    v_dot2c_f32_bf16 v52, v106, v189
    v_dot2c_f32_bf16 v53, v106, v12
    v_dot2c_f32_bf16 v54, v107, v189
    v_dot2c_f32_bf16 v55, v107, v12
    v_dot2c_f32_bf16 v56, v108, v189
    v_dot2c_f32_bf16 v57, v108, v12
    v_dot2c_f32_bf16 v58, v109, v189
    v_dot2c_f32_bf16 v59, v109, v12
    v_dot2c_f32_bf16 v60, v110, v189
    v_dot2c_f32_bf16 v61, v110, v12
    v_dot2c_f32_bf16 v62, v111, v189
    v_dot2c_f32_bf16 v63, v111, v12
    v_lshrrev_b32 v189, 16, v8
    v_dot2c_f32_bf16 v16, v112, v189
    v_dot2c_f32_bf16 v17, v112, v8
    v_dot2c_f32_bf16 v18, v113, v189
    v_dot2c_f32_bf16 v19, v113, v8
    v_dot2c_f32_bf16 v20, v114, v189
    v_dot2c_f32_bf16 v21, v114, v8
    v_dot2c_f32_bf16 v22, v115, v189
    v_dot2c_f32_bf16 v23, v115, v8
    v_dot2c_f32_bf16 v24, v116, v189
    v_dot2c_f32_bf16 v25, v116, v8
    v_dot2c_f32_bf16 v26, v117, v189
    v_dot2c_f32_bf16 v27, v117, v8
    v_dot2c_f32_bf16 v28, v118, v189
    v_dot2c_f32_bf16 v29, v118, v8
    v_dot2c_f32_bf16 v30, v119, v189
    v_dot2c_f32_bf16 v31, v119, v8
    v_dot2c_f32_bf16 v32, v120, v189
    v_dot2c_f32_bf16 v33, v120, v8
    v_dot2c_f32_bf16 v34, v121, v189
    v_dot2c_f32_bf16 v35, v121, v8
    v_dot2c_f32_bf16 v36, v122, v189
    v_dot2c_f32_bf16 v37, v122, v8
    v_dot2c_f32_bf16 v38, v123, v189
    v_dot2c_f32_bf16 v39, v123, v8
    v_lshrrev_b32 v189, 16, v13
    v_dot2c_f32_bf16 v40, v112, v189
    v_dot2c_f32_bf16 v41, v112, v13
    v_dot2c_f32_bf16 v42, v113, v189
    v_dot2c_f32_bf16 v43, v113, v13
    v_dot2c_f32_bf16 v44, v114, v189
    v_dot2c_f32_bf16 v45, v114, v13
    v_dot2c_f32_bf16 v46, v115, v189
    v_dot2c_f32_bf16 v47, v115, v13
    v_dot2c_f32_bf16 v48, v116, v189
    v_dot2c_f32_bf16 v49, v116, v13
    v_dot2c_f32_bf16 v50, v117, v189
    v_dot2c_f32_bf16 v51, v117, v13
    v_dot2c_f32_bf16 v52, v118, v189
    v_dot2c_f32_bf16 v53, v118, v13
    v_dot2c_f32_bf16 v54, v119, v189
    v_dot2c_f32_bf16 v55, v119, v13
    v_dot2c_f32_bf16 v56, v120, v189
    v_dot2c_f32_bf16 v57, v120, v13
    v_dot2c_f32_bf16 v58, v121, v189
    v_dot2c_f32_bf16 v59, v121, v13
    v_dot2c_f32_bf16 v60, v122, v189
    v_dot2c_f32_bf16 v61, v122, v13
    v_dot2c_f32_bf16 v62, v123, v189
    v_dot2c_f32_bf16 v63, v123, v13
    s_nop 3
    v_add_f32_dpp v16, v16, v16 row_ror:8 row_mask:0xf bank_mask:0xf
    v_add_f32_dpp v17, v17, v17 row_ror:8 row_mask:0xf bank_mask:0xf
    v_add_f32_dpp v18, v18, v18 row_ror:8 row_mask:0xf bank_mask:0xf
    v_add_f32_dpp v19, v19, v19 row_ror:8 row_mask:0xf bank_mask:0xf
    v_add_f32_dpp v20, v20, v20 row_ror:8 row_mask:0xf bank_mask:0xf
    v_add_f32_dpp v21, v21, v21 row_ror:8 row_mask:0xf bank_mask:0xf
    v_add_f32_dpp v22, v22, v22 row_ror:8 row_mask:0xf bank_mask:0xf
    v_add_f32_dpp v23, v23, v23 row_ror:8 row_mask:0xf bank_mask:0xf
    v_add_f32_dpp v24, v24, v24 row_ror:8 row_mask:0xf bank_mask:0xf
    v_add_f32_dpp v25, v25, v25 row_ror:8 row_mask:0xf bank_mask:0xf
    v_add_f32_dpp v26, v26, v26 row_ror:8 row_mask:0xf bank_mask:0xf
    v_add_f32_dpp v27, v27, v27 row_ror:8 row_mask:0xf bank_mask:0xf
    v_add_f32_dpp v28, v28, v28 row_ror:8 row_mask:0xf bank_mask:0xf
    v_add_f32_dpp v29, v29, v29 row_ror:8 row_mask:0xf bank_mask:0xf
    v_add_f32_dpp v30, v30, v30 row_ror:8 row_mask:0xf bank_mask:0xf
    v_add_f32_dpp v31, v31, v31 row_ror:8 row_mask:0xf bank_mask:0xf
    v_add_f32_dpp v32, v32, v32 row_ror:8 row_mask:0xf bank_mask:0xf
    v_add_f32_dpp v33, v33, v33 row_ror:8 row_mask:0xf bank_mask:0xf
    v_add_f32_dpp v34, v34, v34 row_ror:8 row_mask:0xf bank_mask:0xf
    v_add_f32_dpp v35, v35, v35 row_ror:8 row_mask:0xf bank_mask:0xf
    v_add_f32_dpp v36, v36, v36 row_ror:8 row_mask:0xf bank_mask:0xf
    v_add_f32_dpp v37, v37, v37 row_ror:8 row_mask:0xf bank_mask:0xf
    v_add_f32_dpp v38, v38, v38 row_ror:8 row_mask:0xf bank_mask:0xf
    v_add_f32_dpp v39, v39, v39 row_ror:8 row_mask:0xf bank_mask:0xf
    v_add_f32_dpp v40, v40, v40 row_ror:8 row_mask:0xf bank_mask:0xf
    v_add_f32_dpp v41, v41, v41 row_ror:8 row_mask:0xf bank_mask:0xf
    v_add_f32_dpp v42, v42, v42 row_ror:8 row_mask:0xf bank_mask:0xf
    v_add_f32_dpp v43, v43, v43 row_ror:8 row_mask:0xf bank_mask:0xf
    v_add_f32_dpp v44, v44, v44 row_ror:8 row_mask:0xf bank_mask:0xf
    v_add_f32_dpp v45, v45, v45 row_ror:8 row_mask:0xf bank_mask:0xf
    v_add_f32_dpp v46, v46, v46 row_ror:8 row_mask:0xf bank_mask:0xf
    v_add_f32_dpp v47, v47, v47 row_ror:8 row_mask:0xf bank_mask:0xf
    v_add_f32_dpp v48, v48, v48 row_ror:8 row_mask:0xf bank_mask:0xf
    v_add_f32_dpp v49, v49, v49 row_ror:8 row_mask:0xf bank_mask:0xf
    v_add_f32_dpp v50, v50, v50 row_ror:8 row_mask:0xf bank_mask:0xf
    v_add_f32_dpp v51, v51, v51 row_ror:8 row_mask:0xf bank_mask:0xf
    v_add_f32_dpp v52, v52, v52 row_ror:8 row_mask:0xf bank_mask:0xf
    v_add_f32_dpp v53, v53, v53 row_ror:8 row_mask:0xf bank_mask:0xf
    v_add_f32_dpp v54, v54, v54 row_ror:8 row_mask:0xf bank_mask:0xf
    v_add_f32_dpp v55, v55, v55 row_ror:8 row_mask:0xf bank_mask:0xf
    v_add_f32_dpp v56, v56, v56 row_ror:8 row_mask:0xf bank_mask:0xf
    v_add_f32_dpp v57, v57, v57 row_ror:8 row_mask:0xf bank_mask:0xf
    v_add_f32_dpp v58, v58, v58 row_ror:8 row_mask:0xf bank_mask:0xf
    v_add_f32_dpp v59, v59, v59 row_ror:8 row_mask:0xf bank_mask:0xf
    v_add_f32_dpp v60, v60, v60 row_ror:8 row_mask:0xf bank_mask:0xf
    v_add_f32_dpp v61, v61, v61 row_ror:8 row_mask:0xf bank_mask:0xf
    v_add_f32_dpp v62, v62, v62 row_ror:8 row_mask:0xf bank_mask:0xf
    v_add_f32_dpp v63, v63, v63 row_ror:8 row_mask:0xf bank_mask:0xf
    v_lshrrev_b32 v188, 4, v0
    v_subrev_u32 v188, 8, v188
    v_mul_u32_u24 v188, 1536, v188
    v_and_b32 v189, 7, v1
    v_lshl_add_u32 v188, v189, 5, v188

    ds_write_b128 v188, v[16:19] offset:6144
    ds_write_b128 v188, v[20:23] offset:6160
    ds_write_b128 v188, v[24:27] offset:6400
    ds_write_b128 v188, v[28:31] offset:6416
    ds_write_b128 v188, v[32:35] offset:6656
    ds_write_b128 v188, v[36:39] offset:6672
    ds_write_b128 v188, v[40:43] offset:6912
    ds_write_b128 v188, v[44:47] offset:6928
    ds_write_b128 v188, v[48:51] offset:7168
    ds_write_b128 v188, v[52:55] offset:7184
    ds_write_b128 v188, v[56:59] offset:7424
    ds_write_b128 v188, v[60:63] offset:7440
L_P3_SKIP:
    s_waitcnt lgkmcnt(0)
    s_barrier
    v_lshlrev_b32 v188, 2, v0

    ds_read_b32 v16, v188 offset:6144
    ds_read_b32 v17, v188 offset:7680
    ds_read_b32 v18, v188 offset:9216
    ds_read_b32 v19, v188 offset:10752
    ds_read_b32 v20, v188 offset:12288
    ds_read_b32 v21, v188 offset:13824
    ds_read_b32 v22, v188 offset:15360
    ds_read_b32 v23, v188 offset:16896
    s_cmp_ge_u32 s12, 2
    s_cbranch_scc1 L_SP1_q
    ds_read_b32 v32, v188 offset:7168
    ds_read_b32 v33, v188 offset:8704
    ds_read_b32 v34, v188 offset:10240
    ds_read_b32 v35, v188 offset:11776
    ds_read_b32 v36, v188 offset:13312
    ds_read_b32 v37, v188 offset:14848
    ds_read_b32 v38, v188 offset:16384
    ds_read_b32 v39, v188 offset:17920
    s_waitcnt lgkmcnt(0)
    v_add_f32 v32, v32, v36
    v_add_f32 v33, v33, v37
    v_add_f32 v34, v34, v38
    v_add_f32 v35, v35, v39
    v_add_f32 v32, v32, v34
    v_add_f32 v33, v33, v35
    v_add_f32 v32, v32, v33
    v_or_b32 v32, 1, v32
    v_add_u32 v189, s42, v188
    global_store_dword v189, v32, s[88:89] offset:1136 sc1
L_SP1_q:
    s_waitcnt lgkmcnt(0)
    v_add_f32 v16, v16, v20
    v_add_f32 v17, v17, v21
    v_add_f32 v18, v18, v22
    v_add_f32 v19, v19, v23
    v_add_f32 v16, v16, v18
    v_add_f32 v17, v17, v19
    v_add_f32 v16, v16, v17
    v_or_b32 v16, 1, v16
    v_add_u32 v189, s42, v188
    global_store_dword v189, v16, s[88:89] offset:112 sc1
    s_cmp_eq_u32 s12, 0
    s_cbranch_scc1 L_P5_GO
    v_mov_b32 v190, 0
    v_mov_b32 v191, 0
    v_mov_b32 v192, 0
    v_mov_b32 v193, 0

    v_add_u32 v194, -64, v0
    v_min_u32 v194, 735, v194
    v_lshl_add_u32 v194, v194, 4, s42
    global_store_dwordx4 v194, v[190:193], s[88:89] offset:1648 sc1
    v_add_u32 v194, 128, v0
    v_min_u32 v194, 735, v194
    v_lshl_add_u32 v194, v194, 4, s42
    global_store_dwordx4 v194, v[190:193], s[88:89] offset:1648 sc1
    v_add_u32 v194, 320, v0
    v_min_u32 v194, 735, v194
    v_lshl_add_u32 v194, v194, 4, s42
    global_store_dwordx4 v194, v[190:193], s[88:89] offset:1648 sc1
    v_add_u32 v194, 512, v0
    v_min_u32 v194, 735, v194
    v_lshl_add_u32 v194, v194, 4, s42
    global_store_dwordx4 v194, v[190:193], s[88:89] offset:1648 sc1
    s_cmp_ge_u32 s12, 2
    s_cbranch_scc1 L_SKE1
    s_waitcnt vmcnt(12)
    buffer_load_dwordx4 a[76:79], v2, s[16:19], s24 offen offset:0 nt
    buffer_load_dwordx4 a[80:83], v2, s[16:19], s24 offen offset:128 nt
    buffer_load_dwordx4 a[84:87], v2, s[16:19], s24 offen offset:256 nt
    s_add_u32 s24, s24, 3072
    s_waitcnt vmcnt(12)
    buffer_load_dwordx4 a[88:91], v2, s[16:19], s24 offen offset:0 nt
    buffer_load_dwordx4 a[92:95], v2, s[16:19], s24 offen offset:128 nt
    buffer_load_dwordx4 a[96:99], v2, s[16:19], s24 offen offset:256 nt
    s_add_u32 s24, s24, 3072
    s_waitcnt vmcnt(12)
    buffer_load_dwordx4 a[100:103], v2, s[16:19], s24 offen offset:0 nt
    buffer_load_dwordx4 a[104:107], v2, s[16:19], s24 offen offset:128 nt
    buffer_load_dwordx4 a[108:111], v2, s[16:19], s24 offen offset:256 nt
    s_add_u32 s24, s24, 3072
L_SKE1:
    s_waitcnt vmcnt(12)
    buffer_load_dwordx4 a[112:115], v2, s[16:19], s24 offen offset:0 nt
    buffer_load_dwordx4 a[116:119], v2, s[16:19], s24 offen offset:128 nt
    buffer_load_dwordx4 a[120:123], v2, s[16:19], s24 offen offset:256 nt
    s_add_u32 s24, s24, 3072
    s_waitcnt vmcnt(12)
    buffer_load_dwordx4 a[124:127], v2, s[16:19], s24 offen offset:0 nt
    buffer_load_dwordx4 a[128:131], v2, s[16:19], s24 offen offset:128 nt
    buffer_load_dwordx4 a[132:135], v2, s[16:19], s24 offen offset:256 nt
    s_add_u32 s24, s24, 3072
    s_waitcnt vmcnt(12)
    buffer_load_dwordx4 a[136:139], v2, s[16:19], s24 offen offset:0 nt
    buffer_load_dwordx4 a[140:143], v2, s[16:19], s24 offen offset:128 nt
    buffer_load_dwordx4 a[144:147], v2, s[16:19], s24 offen offset:256 nt
    s_add_u32 s24, s24, 3072
    s_waitcnt vmcnt(12)
    buffer_load_dwordx4 a[148:151], v2, s[16:19], s24 offen offset:0 nt
    buffer_load_dwordx4 a[152:155], v2, s[16:19], s24 offen offset:128 nt
    buffer_load_dwordx4 a[156:159], v2, s[16:19], s24 offen offset:256 nt
    s_add_u32 s24, s24, 3072
    s_waitcnt vmcnt(12)
    buffer_load_dwordx4 a[160:163], v2, s[16:19], s24 offen offset:0 nt
    buffer_load_dwordx4 a[164:167], v2, s[16:19], s24 offen offset:128 nt
    buffer_load_dwordx4 a[168:171], v2, s[16:19], s24 offen offset:256 nt
    s_add_u32 s24, s24, 3072
    s_branch L_P5_SKIP
L_P5_GO:
    s_lshl_b32 s13, s14, 2
    v_mov_b32 v192, s13
L_HCHK:
    global_load_dword v193, v192, s[86:87] sc1
    s_waitcnt vmcnt(0)
    v_readfirstlane_b32 s13, v193
    s_nop 3
    s_cmp_eq_u32 s13, 8
    s_cbranch_scc1 L_HOK
    s_sleep 16
    s_branch L_HCHK
L_HOK:
    s_mul_i32 s13, s14, 107520
    v_lshl_add_u32 v189, v0, 3, s13

    v_add_u32 v64, 0, v189
    v_add_u32 v65, 13440, v189
    v_add_u32 v66, 26880, v189
    v_add_u32 v67, 40320, v189
    v_add_u32 v68, 53760, v189
    v_add_u32 v69, 67200, v189
    v_add_u32 v70, 80640, v189
    v_add_u32 v71, 94080, v189
L_QG:
    global_load_dwordx2 v[16:17], v64, s[88:89] offset:112 sc1
    global_load_dwordx2 v[32:33], v64, s[88:89] offset:624 sc1
    global_load_dwordx2 v[48:49], v64, s[88:89] offset:1136 sc1
    global_load_dwordx2 v[18:19], v65, s[88:89] offset:112 sc1
    global_load_dwordx2 v[34:35], v65, s[88:89] offset:624 sc1
    global_load_dwordx2 v[50:51], v65, s[88:89] offset:1136 sc1
    global_load_dwordx2 v[20:21], v66, s[88:89] offset:112 sc1
    global_load_dwordx2 v[36:37], v66, s[88:89] offset:624 sc1
    global_load_dwordx2 v[52:53], v66, s[88:89] offset:1136 sc1
    global_load_dwordx2 v[22:23], v67, s[88:89] offset:112 sc1
    global_load_dwordx2 v[38:39], v67, s[88:89] offset:624 sc1
    global_load_dwordx2 v[54:55], v67, s[88:89] offset:1136 sc1
    global_load_dwordx2 v[24:25], v68, s[88:89] offset:112 sc1
    global_load_dwordx2 v[40:41], v68, s[88:89] offset:624 sc1
    global_load_dwordx2 v[56:57], v68, s[88:89] offset:1136 sc1
    global_load_dwordx2 v[26:27], v69, s[88:89] offset:112 sc1
    global_load_dwordx2 v[42:43], v69, s[88:89] offset:624 sc1
    global_load_dwordx2 v[58:59], v69, s[88:89] offset:1136 sc1
    global_load_dwordx2 v[28:29], v70, s[88:89] offset:112 sc1
    global_load_dwordx2 v[44:45], v70, s[88:89] offset:624 sc1
    global_load_dwordx2 v[60:61], v70, s[88:89] offset:1136 sc1
    global_load_dwordx2 v[30:31], v71, s[88:89] offset:112 sc1
    global_load_dwordx2 v[46:47], v71, s[88:89] offset:624 sc1
    global_load_dwordx2 v[62:63], v71, s[88:89] offset:1136 sc1
    s_waitcnt vmcnt(0)
    v_and_b32 v188, 1, v16
    v_and_b32 v188, v188, v17
    v_and_b32 v188, v188, v32
    v_and_b32 v188, v188, v33
    v_and_b32 v188, v188, v48
    v_and_b32 v188, v188, v49
    v_and_b32 v188, v188, v18
    v_and_b32 v188, v188, v19
    v_and_b32 v188, v188, v34
    v_and_b32 v188, v188, v35
    v_and_b32 v188, v188, v50
    v_and_b32 v188, v188, v51
    v_and_b32 v188, v188, v20
    v_and_b32 v188, v188, v21
    v_and_b32 v188, v188, v36
    v_and_b32 v188, v188, v37
    v_and_b32 v188, v188, v52
    v_and_b32 v188, v188, v53
    v_and_b32 v188, v188, v22
    v_and_b32 v188, v188, v23
    v_and_b32 v188, v188, v38
    v_and_b32 v188, v188, v39
    v_and_b32 v188, v188, v54
    v_and_b32 v188, v188, v55
    v_and_b32 v188, v188, v24
    v_and_b32 v188, v188, v25
    v_and_b32 v188, v188, v40
    v_and_b32 v188, v188, v41
    v_and_b32 v188, v188, v56
    v_and_b32 v188, v188, v57
    v_and_b32 v188, v188, v26
    v_and_b32 v188, v188, v27
    v_and_b32 v188, v188, v42
    v_and_b32 v188, v188, v43
    v_and_b32 v188, v188, v58
    v_and_b32 v188, v188, v59
    v_and_b32 v188, v188, v28
    v_and_b32 v188, v188, v29
    v_and_b32 v188, v188, v44
    v_and_b32 v188, v188, v45
    v_and_b32 v188, v188, v60
    v_and_b32 v188, v188, v61
    v_and_b32 v188, v188, v30
    v_and_b32 v188, v188, v31
    v_and_b32 v188, v188, v46
    v_and_b32 v188, v188, v47
    v_and_b32 v188, v188, v62
    v_and_b32 v188, v188, v63
    v_cmp_eq_u32 vcc, 1, v188
    s_nop 1
    s_cmp_eq_u64 vcc, exec
    s_cbranch_scc1 L_QG_OK
    s_sleep 1
    s_branch L_QG
L_QG_OK:
    v_add_f32 v16, v16, v18
    v_add_f32 v17, v17, v19
    v_add_f32 v20, v20, v22
    v_add_f32 v21, v21, v23
    v_add_f32 v24, v24, v26
    v_add_f32 v25, v25, v27
    v_add_f32 v28, v28, v30
    v_add_f32 v29, v29, v31
    v_add_f32 v16, v16, v20
    v_add_f32 v17, v17, v21
    v_add_f32 v24, v24, v28
    v_add_f32 v25, v25, v29
    v_add_f32 v16, v16, v24
    v_add_f32 v17, v17, v25
    v_cvt_pk_bf16_f32 v16, v16, v17
    v_add_f32 v32, v32, v34
    v_add_f32 v33, v33, v35
    v_add_f32 v36, v36, v38
    v_add_f32 v37, v37, v39
    v_add_f32 v40, v40, v42
    v_add_f32 v41, v41, v43
    v_add_f32 v44, v44, v46
    v_add_f32 v45, v45, v47
    v_add_f32 v32, v32, v36
    v_add_f32 v33, v33, v37
    v_add_f32 v40, v40, v44
    v_add_f32 v41, v41, v45
    v_add_f32 v32, v32, v40
    v_add_f32 v33, v33, v41
    v_cvt_pk_bf16_f32 v32, v32, v33
    v_add_f32 v48, v48, v50
    v_add_f32 v49, v49, v51
    v_add_f32 v52, v52, v54
    v_add_f32 v53, v53, v55
    v_add_f32 v56, v56, v58
    v_add_f32 v57, v57, v59
    v_add_f32 v60, v60, v62
    v_add_f32 v61, v61, v63
    v_add_f32 v48, v48, v52
    v_add_f32 v49, v49, v53
    v_add_f32 v56, v56, v60
    v_add_f32 v57, v57, v61
    v_add_f32 v48, v48, v56
    v_add_f32 v49, v49, v57
    v_cvt_pk_bf16_f32 v48, v48, v49
    v_lshlrev_b32 v188, 2, v0
    ds_write_b32 v188, v16 offset:5120
    ds_write_b32 v188, v32 offset:5376
    ds_write_b32 v188, v48 offset:5632
    buffer_load_dwordx4 a[76:79], v2, s[16:19], s24 offen offset:0 nt
    buffer_load_dwordx4 a[80:83], v2, s[16:19], s24 offen offset:128 nt
    buffer_load_dwordx4 a[84:87], v2, s[16:19], s24 offen offset:256 nt
    s_add_u32 s24, s24, 3072
    buffer_load_dwordx4 a[88:91], v2, s[16:19], s24 offen offset:0 nt
    buffer_load_dwordx4 a[92:95], v2, s[16:19], s24 offen offset:128 nt
    buffer_load_dwordx4 a[96:99], v2, s[16:19], s24 offen offset:256 nt
    s_add_u32 s24, s24, 3072
    buffer_load_dwordx4 a[100:103], v2, s[16:19], s24 offen offset:0 nt
    buffer_load_dwordx4 a[104:107], v2, s[16:19], s24 offen offset:128 nt
    buffer_load_dwordx4 a[108:111], v2, s[16:19], s24 offen offset:256 nt
    s_add_u32 s24, s24, 3072
    buffer_load_dwordx4 a[112:115], v2, s[16:19], s24 offen offset:0 nt
    buffer_load_dwordx4 a[116:119], v2, s[16:19], s24 offen offset:128 nt
    buffer_load_dwordx4 a[120:123], v2, s[16:19], s24 offen offset:256 nt
    s_add_u32 s24, s24, 3072
    buffer_load_dwordx4 a[124:127], v2, s[16:19], s24 offen offset:0 nt
    buffer_load_dwordx4 a[128:131], v2, s[16:19], s24 offen offset:128 nt
    buffer_load_dwordx4 a[132:135], v2, s[16:19], s24 offen offset:256 nt
    s_add_u32 s24, s24, 3072
    buffer_load_dwordx4 a[136:139], v2, s[16:19], s24 offen offset:0 nt
    buffer_load_dwordx4 a[140:143], v2, s[16:19], s24 offen offset:128 nt
    buffer_load_dwordx4 a[144:147], v2, s[16:19], s24 offen offset:256 nt
    s_add_u32 s24, s24, 3072
    buffer_load_dwordx4 a[148:151], v2, s[16:19], s24 offen offset:0 nt
    buffer_load_dwordx4 a[152:155], v2, s[16:19], s24 offen offset:128 nt
    buffer_load_dwordx4 a[156:159], v2, s[16:19], s24 offen offset:256 nt
    s_add_u32 s24, s24, 3072
    buffer_load_dwordx4 a[160:163], v2, s[16:19], s24 offen offset:0 nt
    buffer_load_dwordx4 a[164:167], v2, s[16:19], s24 offen offset:128 nt
    buffer_load_dwordx4 a[168:171], v2, s[16:19], s24 offen offset:256 nt
    s_add_u32 s24, s24, 3072
L_P5_SKIP:
    s_waitcnt lgkmcnt(0)
    s_barrier
    v_and_b32 v188, 7, v1
    v_lshlrev_b32 v3, 4, v188

    ds_read_b128 v[4:7], v3 offset:5120
    ds_read_b128 v[8:11], v3 offset:5248
    ds_read_b128 v[12:15], v3 offset:5376
    s_waitcnt lgkmcnt(0)
    v_bfe_u32 v195, v1, 2, 3
    s_lshl_b32 s13, s14, 3
    v_add_u32 v195, s13, v195
    v_mul_u32_u24 v195, 13440, v195
    v_and_b32 v188, 3, v1
    v_lshl_add_u32 v195, v188, 3, v195

    s_waitcnt vmcnt(36)
    v_mov_b32 v188, 0
    v_mov_b32 v189, 0
    v_mov_b32 v190, 0
    v_dot2c_f32_bf16 v188, v128, v4
    v_dot2c_f32_bf16 v189, v132, v8
    v_dot2c_f32_bf16 v190, v136, v12
    v_dot2c_f32_bf16 v188, v129, v5
    v_dot2c_f32_bf16 v189, v133, v9
    v_dot2c_f32_bf16 v190, v137, v13
    v_dot2c_f32_bf16 v188, v130, v6
    v_dot2c_f32_bf16 v189, v134, v10
    v_dot2c_f32_bf16 v190, v138, v14
    v_dot2c_f32_bf16 v188, v131, v7
    v_dot2c_f32_bf16 v189, v135, v11
    v_dot2c_f32_bf16 v190, v139, v15
    buffer_load_dwordx4 v[128:131], v2, s[16:19], s24 offen offset:0 nt
    buffer_load_dwordx4 v[132:135], v2, s[16:19], s24 offen offset:128 nt
    buffer_load_dwordx4 v[136:139], v2, s[16:19], s24 offen offset:256 nt
    s_add_u32 s24, s24, 3072
    v_add_f32 v188, v188, v189
    v_add_f32 v188, v188, v190
    s_nop 1
    v_add_f32_dpp v189, v188, v188 quad_perm:[1,0,3,2] row_mask:0xf bank_mask:0xf
    s_nop 1
    v_add_f32_dpp v188, v189, v189 quad_perm:[2,3,0,1] row_mask:0xf bank_mask:0xf
    s_nop 1
    v_add_f32_dpp v189, v188, v188 row_half_mirror row_mask:0xf bank_mask:0xf
    v_cvt_pk_bf16_f32 v189, v189, v189
    v_and_b32 v189, 0xffff0000, v189
    v_mul_f32 v64, s37, v189
    v_cvt_pk_bf16_f32 v64, v64, v64
    v_and_b32 v64, 0xffff0000, v64
    s_waitcnt vmcnt(36)
    v_mov_b32 v188, 0
    v_mov_b32 v189, 0
    v_mov_b32 v190, 0
    v_dot2c_f32_bf16 v188, v140, v4
    v_dot2c_f32_bf16 v189, v144, v8
    v_dot2c_f32_bf16 v190, v148, v12
    v_dot2c_f32_bf16 v188, v141, v5
    v_dot2c_f32_bf16 v189, v145, v9
    v_dot2c_f32_bf16 v190, v149, v13
    v_dot2c_f32_bf16 v188, v142, v6
    v_dot2c_f32_bf16 v189, v146, v10
    v_dot2c_f32_bf16 v190, v150, v14
    v_dot2c_f32_bf16 v188, v143, v7
    v_dot2c_f32_bf16 v189, v147, v11
    v_dot2c_f32_bf16 v190, v151, v15
    buffer_load_dwordx4 v[140:143], v2, s[16:19], s24 offen offset:0 nt
    buffer_load_dwordx4 v[144:147], v2, s[16:19], s24 offen offset:128 nt
    buffer_load_dwordx4 v[148:151], v2, s[16:19], s24 offen offset:256 nt
    s_add_u32 s24, s24, 3072
    v_add_f32 v188, v188, v189
    v_add_f32 v188, v188, v190
    s_nop 1
    v_add_f32_dpp v189, v188, v188 quad_perm:[1,0,3,2] row_mask:0xf bank_mask:0xf
    s_nop 1
    v_add_f32_dpp v188, v189, v189 quad_perm:[2,3,0,1] row_mask:0xf bank_mask:0xf
    s_nop 1
    v_add_f32_dpp v189, v188, v188 row_half_mirror row_mask:0xf bank_mask:0xf
    v_cvt_pk_bf16_f32 v189, v189, v189
    v_and_b32 v189, 0xffff0000, v189
    v_mul_f32 v65, s37, v189
    v_cvt_pk_bf16_f32 v65, v65, v65
    v_and_b32 v65, 0xffff0000, v65
    s_waitcnt vmcnt(36)
    v_mov_b32 v188, 0
    v_mov_b32 v189, 0
    v_mov_b32 v190, 0
    v_dot2c_f32_bf16 v188, v152, v4
    v_dot2c_f32_bf16 v189, v156, v8
    v_dot2c_f32_bf16 v190, v160, v12
    v_dot2c_f32_bf16 v188, v153, v5
    v_dot2c_f32_bf16 v189, v157, v9
    v_dot2c_f32_bf16 v190, v161, v13
    v_dot2c_f32_bf16 v188, v154, v6
    v_dot2c_f32_bf16 v189, v158, v10
    v_dot2c_f32_bf16 v190, v162, v14
    v_dot2c_f32_bf16 v188, v155, v7
    v_dot2c_f32_bf16 v189, v159, v11
    v_dot2c_f32_bf16 v190, v163, v15
    buffer_load_dwordx4 v[152:155], v2, s[16:19], s24 offen offset:0 nt
    buffer_load_dwordx4 v[156:159], v2, s[16:19], s24 offen offset:128 nt
    buffer_load_dwordx4 v[160:163], v2, s[16:19], s24 offen offset:256 nt
    s_add_u32 s24, s24, 3072
    v_add_f32 v188, v188, v189
    v_add_f32 v188, v188, v190
    s_nop 1
    v_add_f32_dpp v189, v188, v188 quad_perm:[1,0,3,2] row_mask:0xf bank_mask:0xf
    s_nop 1
    v_add_f32_dpp v188, v189, v189 quad_perm:[2,3,0,1] row_mask:0xf bank_mask:0xf
    s_nop 1
    v_add_f32_dpp v189, v188, v188 row_half_mirror row_mask:0xf bank_mask:0xf
    v_cvt_pk_bf16_f32 v189, v189, v189
    v_and_b32 v189, 0xffff0000, v189
    v_mul_f32 v66, s37, v189
    v_cvt_pk_bf16_f32 v66, v66, v66
    v_and_b32 v66, 0xffff0000, v66
    s_waitcnt vmcnt(36)
    v_mov_b32 v188, 0
    v_mov_b32 v189, 0
    v_mov_b32 v190, 0
    v_dot2c_f32_bf16 v188, v164, v4
    v_dot2c_f32_bf16 v189, v168, v8
    v_dot2c_f32_bf16 v190, v172, v12
    v_dot2c_f32_bf16 v188, v165, v5
    v_dot2c_f32_bf16 v189, v169, v9
    v_dot2c_f32_bf16 v190, v173, v13
    v_dot2c_f32_bf16 v188, v166, v6
    v_dot2c_f32_bf16 v189, v170, v10
    v_dot2c_f32_bf16 v190, v174, v14
    v_dot2c_f32_bf16 v188, v167, v7
    v_dot2c_f32_bf16 v189, v171, v11
    v_dot2c_f32_bf16 v190, v175, v15
    buffer_load_dwordx4 v[164:167], v2, s[16:19], s24 offen offset:0 nt
    buffer_load_dwordx4 v[168:171], v2, s[16:19], s24 offen offset:128 nt
    buffer_load_dwordx4 v[172:175], v2, s[16:19], s24 offen offset:256 nt
    s_add_u32 s24, s24, 3072
    v_add_f32 v188, v188, v189
    v_add_f32 v188, v188, v190
    s_nop 1
    v_add_f32_dpp v189, v188, v188 quad_perm:[1,0,3,2] row_mask:0xf bank_mask:0xf
    s_nop 1
    v_add_f32_dpp v188, v189, v189 quad_perm:[2,3,0,1] row_mask:0xf bank_mask:0xf
    s_nop 1
    v_add_f32_dpp v189, v188, v188 row_half_mirror row_mask:0xf bank_mask:0xf
    v_cvt_pk_bf16_f32 v189, v189, v189
    v_and_b32 v189, 0xffff0000, v189
    v_mul_f32 v67, s37, v189
    v_cvt_pk_bf16_f32 v67, v67, v67
    v_and_b32 v67, 0xffff0000, v67
    s_waitcnt vmcnt(36)
    v_mov_b32 v188, 0
    v_mov_b32 v189, 0
    v_mov_b32 v190, 0
    v_dot2c_f32_bf16 v188, v176, v4
    v_dot2c_f32_bf16 v189, v180, v8
    v_dot2c_f32_bf16 v190, v184, v12
    v_dot2c_f32_bf16 v188, v177, v5
    v_dot2c_f32_bf16 v189, v181, v9
    v_dot2c_f32_bf16 v190, v185, v13
    v_dot2c_f32_bf16 v188, v178, v6
    v_dot2c_f32_bf16 v189, v182, v10
    v_dot2c_f32_bf16 v190, v186, v14
    v_dot2c_f32_bf16 v188, v179, v7
    v_dot2c_f32_bf16 v189, v183, v11
    v_dot2c_f32_bf16 v190, v187, v15
    buffer_load_dwordx4 v[176:179], v2, s[16:19], s24 offen offset:0 nt
    buffer_load_dwordx4 v[180:183], v2, s[16:19], s24 offen offset:128 nt
    buffer_load_dwordx4 v[184:187], v2, s[16:19], s24 offen offset:256 nt
    s_add_u32 s24, s24, 3072
    v_add_f32 v188, v188, v189
    v_add_f32 v188, v188, v190
    s_nop 1
    v_add_f32_dpp v189, v188, v188 quad_perm:[1,0,3,2] row_mask:0xf bank_mask:0xf
    s_nop 1
    v_add_f32_dpp v188, v189, v189 quad_perm:[2,3,0,1] row_mask:0xf bank_mask:0xf
    s_nop 1
    v_add_f32_dpp v189, v188, v188 row_half_mirror row_mask:0xf bank_mask:0xf
    v_cvt_pk_bf16_f32 v189, v189, v189
    v_and_b32 v189, 0xffff0000, v189
    v_mul_f32 v68, s37, v189
    v_cvt_pk_bf16_f32 v68, v68, v68
    v_and_b32 v68, 0xffff0000, v68
    s_waitcnt vmcnt(36)
    v_accvgpr_read_b32 v16, a76
    v_accvgpr_read_b32 v17, a77
    v_accvgpr_read_b32 v18, a78
    v_accvgpr_read_b32 v19, a79
    v_accvgpr_read_b32 v20, a80
    v_accvgpr_read_b32 v21, a81
    v_accvgpr_read_b32 v22, a82
    v_accvgpr_read_b32 v23, a83
    v_accvgpr_read_b32 v24, a84
    v_accvgpr_read_b32 v25, a85
    v_accvgpr_read_b32 v26, a86
    v_accvgpr_read_b32 v27, a87
    v_mov_b32 v188, 0
    v_mov_b32 v189, 0
    v_mov_b32 v190, 0
    v_dot2c_f32_bf16 v188, v16, v4
    v_dot2c_f32_bf16 v189, v20, v8
    v_dot2c_f32_bf16 v190, v24, v12
    v_dot2c_f32_bf16 v188, v17, v5
    v_dot2c_f32_bf16 v189, v21, v9
    v_dot2c_f32_bf16 v190, v25, v13
    v_dot2c_f32_bf16 v188, v18, v6
    v_dot2c_f32_bf16 v189, v22, v10
    v_dot2c_f32_bf16 v190, v26, v14
    v_dot2c_f32_bf16 v188, v19, v7
    v_dot2c_f32_bf16 v189, v23, v11
    v_dot2c_f32_bf16 v190, v27, v15
    s_nop 3
    v_add_f32 v188, v188, v189
    v_add_f32 v188, v188, v190
    s_nop 1
    v_add_f32_dpp v189, v188, v188 quad_perm:[1,0,3,2] row_mask:0xf bank_mask:0xf
    s_nop 1
    v_add_f32_dpp v188, v189, v189 quad_perm:[2,3,0,1] row_mask:0xf bank_mask:0xf
    s_nop 1
    v_add_f32_dpp v189, v188, v188 row_half_mirror row_mask:0xf bank_mask:0xf
    v_cvt_pk_bf16_f32 v189, v189, v189
    v_and_b32 v189, 0xffff0000, v189
    v_mul_f32 v69, s37, v189
    v_cvt_pk_bf16_f32 v69, v69, v69
    v_and_b32 v69, 0xffff0000, v69
    s_waitcnt vmcnt(33)
    v_accvgpr_read_b32 v16, a88
    v_accvgpr_read_b32 v17, a89
    v_accvgpr_read_b32 v18, a90
    v_accvgpr_read_b32 v19, a91
    v_accvgpr_read_b32 v20, a92
    v_accvgpr_read_b32 v21, a93
    v_accvgpr_read_b32 v22, a94
    v_accvgpr_read_b32 v23, a95
    v_accvgpr_read_b32 v24, a96
    v_accvgpr_read_b32 v25, a97
    v_accvgpr_read_b32 v26, a98
    v_accvgpr_read_b32 v27, a99
    v_mov_b32 v188, 0
    v_mov_b32 v189, 0
    v_mov_b32 v190, 0
    v_dot2c_f32_bf16 v188, v16, v4
    v_dot2c_f32_bf16 v189, v20, v8
    v_dot2c_f32_bf16 v190, v24, v12
    v_dot2c_f32_bf16 v188, v17, v5
    v_dot2c_f32_bf16 v189, v21, v9
    v_dot2c_f32_bf16 v190, v25, v13
    v_dot2c_f32_bf16 v188, v18, v6
    v_dot2c_f32_bf16 v189, v22, v10
    v_dot2c_f32_bf16 v190, v26, v14
    v_dot2c_f32_bf16 v188, v19, v7
    v_dot2c_f32_bf16 v189, v23, v11
    v_dot2c_f32_bf16 v190, v27, v15
    s_nop 3
    v_add_f32 v188, v188, v189
    v_add_f32 v188, v188, v190
    s_nop 1
    v_add_f32_dpp v189, v188, v188 quad_perm:[1,0,3,2] row_mask:0xf bank_mask:0xf
    s_nop 1
    v_add_f32_dpp v188, v189, v189 quad_perm:[2,3,0,1] row_mask:0xf bank_mask:0xf
    s_nop 1
    v_add_f32_dpp v189, v188, v188 row_half_mirror row_mask:0xf bank_mask:0xf
    v_cvt_pk_bf16_f32 v189, v189, v189
    v_and_b32 v189, 0xffff0000, v189
    v_mul_f32 v70, s37, v189
    v_cvt_pk_bf16_f32 v70, v70, v70
    v_and_b32 v70, 0xffff0000, v70
    s_waitcnt vmcnt(30)
    v_accvgpr_read_b32 v16, a100
    v_accvgpr_read_b32 v17, a101
    v_accvgpr_read_b32 v18, a102
    v_accvgpr_read_b32 v19, a103
    v_accvgpr_read_b32 v20, a104
    v_accvgpr_read_b32 v21, a105
    v_accvgpr_read_b32 v22, a106
    v_accvgpr_read_b32 v23, a107
    v_accvgpr_read_b32 v24, a108
    v_accvgpr_read_b32 v25, a109
    v_accvgpr_read_b32 v26, a110
    v_accvgpr_read_b32 v27, a111
    v_mov_b32 v188, 0
    v_mov_b32 v189, 0
    v_mov_b32 v190, 0
    v_dot2c_f32_bf16 v188, v16, v4
    v_dot2c_f32_bf16 v189, v20, v8
    v_dot2c_f32_bf16 v190, v24, v12
    v_dot2c_f32_bf16 v188, v17, v5
    v_dot2c_f32_bf16 v189, v21, v9
    v_dot2c_f32_bf16 v190, v25, v13
    v_dot2c_f32_bf16 v188, v18, v6
    v_dot2c_f32_bf16 v189, v22, v10
    v_dot2c_f32_bf16 v190, v26, v14
    v_dot2c_f32_bf16 v188, v19, v7
    v_dot2c_f32_bf16 v189, v23, v11
    v_dot2c_f32_bf16 v190, v27, v15
    s_nop 3
    v_add_f32 v188, v188, v189
    v_add_f32 v188, v188, v190
    s_nop 1
    v_add_f32_dpp v189, v188, v188 quad_perm:[1,0,3,2] row_mask:0xf bank_mask:0xf
    s_nop 1
    v_add_f32_dpp v188, v189, v189 quad_perm:[2,3,0,1] row_mask:0xf bank_mask:0xf
    s_nop 1
    v_add_f32_dpp v189, v188, v188 row_half_mirror row_mask:0xf bank_mask:0xf
    v_cvt_pk_bf16_f32 v189, v189, v189
    v_and_b32 v189, 0xffff0000, v189
    v_mul_f32 v71, s37, v189
    v_cvt_pk_bf16_f32 v71, v71, v71
    v_and_b32 v71, 0xffff0000, v71
    s_waitcnt vmcnt(27)
    v_accvgpr_read_b32 v16, a112
    v_accvgpr_read_b32 v17, a113
    v_accvgpr_read_b32 v18, a114
    v_accvgpr_read_b32 v19, a115
    v_accvgpr_read_b32 v20, a116
    v_accvgpr_read_b32 v21, a117
    v_accvgpr_read_b32 v22, a118
    v_accvgpr_read_b32 v23, a119
    v_accvgpr_read_b32 v24, a120
    v_accvgpr_read_b32 v25, a121
    v_accvgpr_read_b32 v26, a122
    v_accvgpr_read_b32 v27, a123
    v_mov_b32 v188, 0
    v_mov_b32 v189, 0
    v_mov_b32 v190, 0
    v_dot2c_f32_bf16 v188, v16, v4
    v_dot2c_f32_bf16 v189, v20, v8
    v_dot2c_f32_bf16 v190, v24, v12
    v_dot2c_f32_bf16 v188, v17, v5
    v_dot2c_f32_bf16 v189, v21, v9
    v_dot2c_f32_bf16 v190, v25, v13
    v_dot2c_f32_bf16 v188, v18, v6
    v_dot2c_f32_bf16 v189, v22, v10
    v_dot2c_f32_bf16 v190, v26, v14
    v_dot2c_f32_bf16 v188, v19, v7
    v_dot2c_f32_bf16 v189, v23, v11
    v_dot2c_f32_bf16 v190, v27, v15
    s_nop 3
    v_add_f32 v188, v188, v189
    v_add_f32 v188, v188, v190
    s_nop 1
    v_add_f32_dpp v189, v188, v188 quad_perm:[1,0,3,2] row_mask:0xf bank_mask:0xf
    s_nop 1
    v_add_f32_dpp v188, v189, v189 quad_perm:[2,3,0,1] row_mask:0xf bank_mask:0xf
    s_nop 1
    v_add_f32_dpp v189, v188, v188 row_half_mirror row_mask:0xf bank_mask:0xf
    v_cvt_pk_bf16_f32 v189, v189, v189
    v_and_b32 v189, 0xffff0000, v189
    v_mul_f32 v72, s37, v189
    v_cvt_pk_bf16_f32 v72, v72, v72
    v_and_b32 v72, 0xffff0000, v72
    s_waitcnt vmcnt(24)
    v_accvgpr_read_b32 v16, a124
    v_accvgpr_read_b32 v17, a125
    v_accvgpr_read_b32 v18, a126
    v_accvgpr_read_b32 v19, a127
    v_accvgpr_read_b32 v20, a128
    v_accvgpr_read_b32 v21, a129
    v_accvgpr_read_b32 v22, a130
    v_accvgpr_read_b32 v23, a131
    v_accvgpr_read_b32 v24, a132
    v_accvgpr_read_b32 v25, a133
    v_accvgpr_read_b32 v26, a134
    v_accvgpr_read_b32 v27, a135
    v_mov_b32 v188, 0
    v_mov_b32 v189, 0
    v_mov_b32 v190, 0
    v_dot2c_f32_bf16 v188, v16, v4
    v_dot2c_f32_bf16 v189, v20, v8
    v_dot2c_f32_bf16 v190, v24, v12
    v_dot2c_f32_bf16 v188, v17, v5
    v_dot2c_f32_bf16 v189, v21, v9
    v_dot2c_f32_bf16 v190, v25, v13
    v_dot2c_f32_bf16 v188, v18, v6
    v_dot2c_f32_bf16 v189, v22, v10
    v_dot2c_f32_bf16 v190, v26, v14
    v_dot2c_f32_bf16 v188, v19, v7
    v_dot2c_f32_bf16 v189, v23, v11
    v_dot2c_f32_bf16 v190, v27, v15
    s_nop 3
    v_add_f32 v188, v188, v189
    v_add_f32 v188, v188, v190
    s_nop 1
    v_add_f32_dpp v189, v188, v188 quad_perm:[1,0,3,2] row_mask:0xf bank_mask:0xf
    s_nop 1
    v_add_f32_dpp v188, v189, v189 quad_perm:[2,3,0,1] row_mask:0xf bank_mask:0xf
    s_nop 1
    v_add_f32_dpp v189, v188, v188 row_half_mirror row_mask:0xf bank_mask:0xf
    v_cvt_pk_bf16_f32 v189, v189, v189
    v_and_b32 v189, 0xffff0000, v189
    v_mul_f32 v73, s37, v189
    v_cvt_pk_bf16_f32 v73, v73, v73
    v_and_b32 v73, 0xffff0000, v73
    s_waitcnt vmcnt(21)
    v_accvgpr_read_b32 v16, a136
    v_accvgpr_read_b32 v17, a137
    v_accvgpr_read_b32 v18, a138
    v_accvgpr_read_b32 v19, a139
    v_accvgpr_read_b32 v20, a140
    v_accvgpr_read_b32 v21, a141
    v_accvgpr_read_b32 v22, a142
    v_accvgpr_read_b32 v23, a143
    v_accvgpr_read_b32 v24, a144
    v_accvgpr_read_b32 v25, a145
    v_accvgpr_read_b32 v26, a146
    v_accvgpr_read_b32 v27, a147
    v_mov_b32 v188, 0
    v_mov_b32 v189, 0
    v_mov_b32 v190, 0
    v_dot2c_f32_bf16 v188, v16, v4
    v_dot2c_f32_bf16 v189, v20, v8
    v_dot2c_f32_bf16 v190, v24, v12
    v_dot2c_f32_bf16 v188, v17, v5
    v_dot2c_f32_bf16 v189, v21, v9
    v_dot2c_f32_bf16 v190, v25, v13
    v_dot2c_f32_bf16 v188, v18, v6
    v_dot2c_f32_bf16 v189, v22, v10
    v_dot2c_f32_bf16 v190, v26, v14
    v_dot2c_f32_bf16 v188, v19, v7
    v_dot2c_f32_bf16 v189, v23, v11
    v_dot2c_f32_bf16 v190, v27, v15
    s_nop 3
    v_add_f32 v188, v188, v189
    v_add_f32 v188, v188, v190
    s_nop 1
    v_add_f32_dpp v189, v188, v188 quad_perm:[1,0,3,2] row_mask:0xf bank_mask:0xf
    s_nop 1
    v_add_f32_dpp v188, v189, v189 quad_perm:[2,3,0,1] row_mask:0xf bank_mask:0xf
    s_nop 1
    v_add_f32_dpp v189, v188, v188 row_half_mirror row_mask:0xf bank_mask:0xf
    v_cvt_pk_bf16_f32 v189, v189, v189
    v_and_b32 v189, 0xffff0000, v189
    v_mul_f32 v74, s37, v189
    v_cvt_pk_bf16_f32 v74, v74, v74
    v_and_b32 v74, 0xffff0000, v74
    s_waitcnt vmcnt(18)
    v_accvgpr_read_b32 v16, a148
    v_accvgpr_read_b32 v17, a149
    v_accvgpr_read_b32 v18, a150
    v_accvgpr_read_b32 v19, a151
    v_accvgpr_read_b32 v20, a152
    v_accvgpr_read_b32 v21, a153
    v_accvgpr_read_b32 v22, a154
    v_accvgpr_read_b32 v23, a155
    v_accvgpr_read_b32 v24, a156
    v_accvgpr_read_b32 v25, a157
    v_accvgpr_read_b32 v26, a158
    v_accvgpr_read_b32 v27, a159
    v_mov_b32 v188, 0
    v_mov_b32 v189, 0
    v_mov_b32 v190, 0
    v_dot2c_f32_bf16 v188, v16, v4
    v_dot2c_f32_bf16 v189, v20, v8
    v_dot2c_f32_bf16 v190, v24, v12
    v_dot2c_f32_bf16 v188, v17, v5
    v_dot2c_f32_bf16 v189, v21, v9
    v_dot2c_f32_bf16 v190, v25, v13
    v_dot2c_f32_bf16 v188, v18, v6
    v_dot2c_f32_bf16 v189, v22, v10
    v_dot2c_f32_bf16 v190, v26, v14
    v_dot2c_f32_bf16 v188, v19, v7
    v_dot2c_f32_bf16 v189, v23, v11
    v_dot2c_f32_bf16 v190, v27, v15
    s_nop 3
    v_add_f32 v188, v188, v189
    v_add_f32 v188, v188, v190
    s_nop 1
    v_add_f32_dpp v189, v188, v188 quad_perm:[1,0,3,2] row_mask:0xf bank_mask:0xf
    s_nop 1
    v_add_f32_dpp v188, v189, v189 quad_perm:[2,3,0,1] row_mask:0xf bank_mask:0xf
    s_nop 1
    v_add_f32_dpp v189, v188, v188 row_half_mirror row_mask:0xf bank_mask:0xf
    v_cvt_pk_bf16_f32 v189, v189, v189
    v_and_b32 v189, 0xffff0000, v189
    v_mul_f32 v75, s37, v189
    v_cvt_pk_bf16_f32 v75, v75, v75
    v_and_b32 v75, 0xffff0000, v75
    s_waitcnt vmcnt(15)
    v_accvgpr_read_b32 v16, a160
    v_accvgpr_read_b32 v17, a161
    v_accvgpr_read_b32 v18, a162
    v_accvgpr_read_b32 v19, a163
    v_accvgpr_read_b32 v20, a164
    v_accvgpr_read_b32 v21, a165
    v_accvgpr_read_b32 v22, a166
    v_accvgpr_read_b32 v23, a167
    v_accvgpr_read_b32 v24, a168
    v_accvgpr_read_b32 v25, a169
    v_accvgpr_read_b32 v26, a170
    v_accvgpr_read_b32 v27, a171
    v_mov_b32 v188, 0
    v_mov_b32 v189, 0
    v_mov_b32 v190, 0
    v_dot2c_f32_bf16 v188, v16, v4
    v_dot2c_f32_bf16 v189, v20, v8
    v_dot2c_f32_bf16 v190, v24, v12
    v_dot2c_f32_bf16 v188, v17, v5
    v_dot2c_f32_bf16 v189, v21, v9
    v_dot2c_f32_bf16 v190, v25, v13
    v_dot2c_f32_bf16 v188, v18, v6
    v_dot2c_f32_bf16 v189, v22, v10
    v_dot2c_f32_bf16 v190, v26, v14
    v_dot2c_f32_bf16 v188, v19, v7
    v_dot2c_f32_bf16 v189, v23, v11
    v_dot2c_f32_bf16 v190, v27, v15
    s_nop 3
    v_add_f32 v188, v188, v189
    v_add_f32 v188, v188, v190
    s_nop 1
    v_add_f32_dpp v189, v188, v188 quad_perm:[1,0,3,2] row_mask:0xf bank_mask:0xf
    s_nop 1
    v_add_f32_dpp v188, v189, v189 quad_perm:[2,3,0,1] row_mask:0xf bank_mask:0xf
    s_nop 1
    v_add_f32_dpp v189, v188, v188 row_half_mirror row_mask:0xf bank_mask:0xf
    v_cvt_pk_bf16_f32 v189, v189, v189
    v_and_b32 v189, 0xffff0000, v189
    v_mul_f32 v76, s37, v189
    v_cvt_pk_bf16_f32 v76, v76, v76
    v_and_b32 v76, 0xffff0000, v76
    s_waitcnt vmcnt(12)
    v_mov_b32 v188, 0
    v_mov_b32 v189, 0
    v_mov_b32 v190, 0
    v_dot2c_f32_bf16 v188, v128, v4
    v_dot2c_f32_bf16 v189, v132, v8
    v_dot2c_f32_bf16 v190, v136, v12
    v_dot2c_f32_bf16 v188, v129, v5
    v_dot2c_f32_bf16 v189, v133, v9
    v_dot2c_f32_bf16 v190, v137, v13
    v_dot2c_f32_bf16 v188, v130, v6
    v_dot2c_f32_bf16 v189, v134, v10
    v_dot2c_f32_bf16 v190, v138, v14
    v_dot2c_f32_bf16 v188, v131, v7
    v_dot2c_f32_bf16 v189, v135, v11
    v_dot2c_f32_bf16 v190, v139, v15
    buffer_load_dwordx4 v[128:131], v2, s[16:19], s24 offen offset:0 nt
    buffer_load_dwordx4 v[132:135], v2, s[16:19], s24 offen offset:128 nt
    buffer_load_dwordx4 v[136:139], v2, s[16:19], s24 offen offset:256 nt
    s_add_u32 s24, s24, 3072
    v_add_f32 v188, v188, v189
    v_add_f32 v188, v188, v190
    s_nop 1
    v_add_f32_dpp v189, v188, v188 quad_perm:[1,0,3,2] row_mask:0xf bank_mask:0xf
    s_nop 1
    v_add_f32_dpp v188, v189, v189 quad_perm:[2,3,0,1] row_mask:0xf bank_mask:0xf
    s_nop 1
    v_add_f32_dpp v189, v188, v188 row_half_mirror row_mask:0xf bank_mask:0xf
    v_cvt_pk_bf16_f32 v189, v189, v189
    v_and_b32 v189, 0xffff0000, v189
    v_mul_f32 v77, s37, v189
    v_cvt_pk_bf16_f32 v77, v77, v77
    v_and_b32 v77, 0xffff0000, v77
    s_waitcnt vmcnt(12)
    v_mov_b32 v188, 0
    v_mov_b32 v189, 0
    v_mov_b32 v190, 0
    v_dot2c_f32_bf16 v188, v140, v4
    v_dot2c_f32_bf16 v189, v144, v8
    v_dot2c_f32_bf16 v190, v148, v12
    v_dot2c_f32_bf16 v188, v141, v5
    v_dot2c_f32_bf16 v189, v145, v9
    v_dot2c_f32_bf16 v190, v149, v13
    v_dot2c_f32_bf16 v188, v142, v6
    v_dot2c_f32_bf16 v189, v146, v10
    v_dot2c_f32_bf16 v190, v150, v14
    v_dot2c_f32_bf16 v188, v143, v7
    v_dot2c_f32_bf16 v189, v147, v11
    v_dot2c_f32_bf16 v190, v151, v15
    buffer_load_dwordx4 v[140:143], v2, s[16:19], s24 offen offset:0 nt
    buffer_load_dwordx4 v[144:147], v2, s[16:19], s24 offen offset:128 nt
    buffer_load_dwordx4 v[148:151], v2, s[16:19], s24 offen offset:256 nt
    s_add_u32 s24, s24, 3072
    v_add_f32 v188, v188, v189
    v_add_f32 v188, v188, v190
    s_nop 1
    v_add_f32_dpp v189, v188, v188 quad_perm:[1,0,3,2] row_mask:0xf bank_mask:0xf
    s_nop 1
    v_add_f32_dpp v188, v189, v189 quad_perm:[2,3,0,1] row_mask:0xf bank_mask:0xf
    s_nop 1
    v_add_f32_dpp v189, v188, v188 row_half_mirror row_mask:0xf bank_mask:0xf
    v_cvt_pk_bf16_f32 v189, v189, v189
    v_and_b32 v189, 0xffff0000, v189
    v_mul_f32 v78, s37, v189
    v_cvt_pk_bf16_f32 v78, v78, v78
    v_and_b32 v78, 0xffff0000, v78
    s_waitcnt vmcnt(12)
    v_mov_b32 v188, 0
    v_mov_b32 v189, 0
    v_mov_b32 v190, 0
    v_dot2c_f32_bf16 v188, v152, v4
    v_dot2c_f32_bf16 v189, v156, v8
    v_dot2c_f32_bf16 v190, v160, v12
    v_dot2c_f32_bf16 v188, v153, v5
    v_dot2c_f32_bf16 v189, v157, v9
    v_dot2c_f32_bf16 v190, v161, v13
    v_dot2c_f32_bf16 v188, v154, v6
    v_dot2c_f32_bf16 v189, v158, v10
    v_dot2c_f32_bf16 v190, v162, v14
    v_dot2c_f32_bf16 v188, v155, v7
    v_dot2c_f32_bf16 v189, v159, v11
    v_dot2c_f32_bf16 v190, v163, v15
    buffer_load_dwordx4 v[152:155], v2, s[16:19], s24 offen offset:0 nt
    buffer_load_dwordx4 v[156:159], v2, s[16:19], s24 offen offset:128 nt
    buffer_load_dwordx4 v[160:163], v2, s[16:19], s24 offen offset:256 nt
    s_add_u32 s24, s24, 3072
    v_add_f32 v188, v188, v189
    v_add_f32 v188, v188, v190
    s_nop 1
    v_add_f32_dpp v189, v188, v188 quad_perm:[1,0,3,2] row_mask:0xf bank_mask:0xf
    s_nop 1
    v_add_f32_dpp v188, v189, v189 quad_perm:[2,3,0,1] row_mask:0xf bank_mask:0xf
    s_nop 1
    v_add_f32_dpp v189, v188, v188 row_half_mirror row_mask:0xf bank_mask:0xf
    v_cvt_pk_bf16_f32 v189, v189, v189
    v_and_b32 v189, 0xffff0000, v189
    v_mul_f32 v79, s37, v189
    v_cvt_pk_bf16_f32 v79, v79, v79
    v_and_b32 v79, 0xffff0000, v79
    s_mov_b64 s[40:41], exec
    s_mov_b64 exec, 1
    s_lshl_b32 s13, s12, 2
    s_add_u32 s13, s13, s42
    v_mov_b32 v190, s13
    v_mov_b32 v191, 1
    global_store_dword v190, v191, s[88:89] offset:96 sc1
    s_mov_b64 exec, s[40:41]

    s_waitcnt vmcnt(13)
    v_mov_b32 v188, 0
    v_mov_b32 v189, 0
    v_mov_b32 v190, 0
    v_dot2c_f32_bf16 v188, v164, v4
    v_dot2c_f32_bf16 v189, v168, v8
    v_dot2c_f32_bf16 v190, v172, v12
    v_dot2c_f32_bf16 v188, v165, v5
    v_dot2c_f32_bf16 v189, v169, v9
    v_dot2c_f32_bf16 v190, v173, v13
    v_dot2c_f32_bf16 v188, v166, v6
    v_dot2c_f32_bf16 v189, v170, v10
    v_dot2c_f32_bf16 v190, v174, v14
    v_dot2c_f32_bf16 v188, v167, v7
    v_dot2c_f32_bf16 v189, v171, v11
    v_dot2c_f32_bf16 v190, v175, v15
    buffer_load_dwordx4 v[164:167], v2, s[16:19], s24 offen offset:0 nt
    buffer_load_dwordx4 v[168:171], v2, s[16:19], s24 offen offset:128 nt
    buffer_load_dwordx4 v[172:175], v2, s[16:19], s24 offen offset:256 nt
    s_add_u32 s24, s24, 3072
    v_add_f32 v188, v188, v189
    v_add_f32 v188, v188, v190
    s_nop 1
    v_add_f32_dpp v189, v188, v188 quad_perm:[1,0,3,2] row_mask:0xf bank_mask:0xf
    s_nop 1
    v_add_f32_dpp v188, v189, v189 quad_perm:[2,3,0,1] row_mask:0xf bank_mask:0xf
    s_nop 1
    v_add_f32_dpp v189, v188, v188 row_half_mirror row_mask:0xf bank_mask:0xf
    v_cvt_pk_bf16_f32 v189, v189, v189
    v_and_b32 v189, 0xffff0000, v189
    v_mul_f32 v80, s37, v189
    v_cvt_pk_bf16_f32 v80, v80, v80
    v_and_b32 v80, 0xffff0000, v80
    s_waitcnt vmcnt(13)
    v_mov_b32 v188, 0
    v_mov_b32 v189, 0
    v_mov_b32 v190, 0
    v_dot2c_f32_bf16 v188, v176, v4
    v_dot2c_f32_bf16 v189, v180, v8
    v_dot2c_f32_bf16 v190, v184, v12
    v_dot2c_f32_bf16 v188, v177, v5
    v_dot2c_f32_bf16 v189, v181, v9
    v_dot2c_f32_bf16 v190, v185, v13
    v_dot2c_f32_bf16 v188, v178, v6
    v_dot2c_f32_bf16 v189, v182, v10
    v_dot2c_f32_bf16 v190, v186, v14
    v_dot2c_f32_bf16 v188, v179, v7
    v_dot2c_f32_bf16 v189, v183, v11
    v_dot2c_f32_bf16 v190, v187, v15
    buffer_load_dwordx4 v[176:179], v2, s[16:19], s24 offen offset:0 nt
    buffer_load_dwordx4 v[180:183], v2, s[16:19], s24 offen offset:128 nt
    buffer_load_dwordx4 v[184:187], v2, s[16:19], s24 offen offset:256 nt
    s_add_u32 s24, s24, 3072
    v_add_f32 v188, v188, v189
    v_add_f32 v188, v188, v190
    s_nop 1
    v_add_f32_dpp v189, v188, v188 quad_perm:[1,0,3,2] row_mask:0xf bank_mask:0xf
    s_nop 1
    v_add_f32_dpp v188, v189, v189 quad_perm:[2,3,0,1] row_mask:0xf bank_mask:0xf
    s_nop 1
    v_add_f32_dpp v189, v188, v188 row_half_mirror row_mask:0xf bank_mask:0xf
    v_cvt_pk_bf16_f32 v189, v189, v189
    v_and_b32 v189, 0xffff0000, v189
    v_mul_f32 v81, s37, v189
    v_cvt_pk_bf16_f32 v81, v81, v81
    v_and_b32 v81, 0xffff0000, v81
    s_waitcnt vmcnt(13)
    v_mov_b32 v188, 0
    v_mov_b32 v189, 0
    v_mov_b32 v190, 0
    v_dot2c_f32_bf16 v188, v128, v4
    v_dot2c_f32_bf16 v189, v132, v8
    v_dot2c_f32_bf16 v190, v136, v12
    v_dot2c_f32_bf16 v188, v129, v5
    v_dot2c_f32_bf16 v189, v133, v9
    v_dot2c_f32_bf16 v190, v137, v13
    v_dot2c_f32_bf16 v188, v130, v6
    v_dot2c_f32_bf16 v189, v134, v10
    v_dot2c_f32_bf16 v190, v138, v14
    v_dot2c_f32_bf16 v188, v131, v7
    v_dot2c_f32_bf16 v189, v135, v11
    v_dot2c_f32_bf16 v190, v139, v15
    buffer_load_dwordx4 v[128:131], v2, s[16:19], s24 offen offset:0 nt
    buffer_load_dwordx4 v[132:135], v2, s[16:19], s24 offen offset:128 nt
    buffer_load_dwordx4 v[136:139], v2, s[16:19], s24 offen offset:256 nt
    s_add_u32 s24, s24, 3072
    v_add_f32 v188, v188, v189
    v_add_f32 v188, v188, v190
    s_nop 1
    v_add_f32_dpp v189, v188, v188 quad_perm:[1,0,3,2] row_mask:0xf bank_mask:0xf
    s_nop 1
    v_add_f32_dpp v188, v189, v189 quad_perm:[2,3,0,1] row_mask:0xf bank_mask:0xf
    s_nop 1
    v_add_f32_dpp v189, v188, v188 row_half_mirror row_mask:0xf bank_mask:0xf
    v_cvt_pk_bf16_f32 v189, v189, v189
    v_and_b32 v189, 0xffff0000, v189
    v_mul_f32 v82, s37, v189
    v_cvt_pk_bf16_f32 v82, v82, v82
    v_and_b32 v82, 0xffff0000, v82
    s_waitcnt vmcnt(13)
    v_mov_b32 v188, 0
    v_mov_b32 v189, 0
    v_mov_b32 v190, 0
    v_dot2c_f32_bf16 v188, v140, v4
    v_dot2c_f32_bf16 v189, v144, v8
    v_dot2c_f32_bf16 v190, v148, v12
    v_dot2c_f32_bf16 v188, v141, v5
    v_dot2c_f32_bf16 v189, v145, v9
    v_dot2c_f32_bf16 v190, v149, v13
    v_dot2c_f32_bf16 v188, v142, v6
    v_dot2c_f32_bf16 v189, v146, v10
    v_dot2c_f32_bf16 v190, v150, v14
    v_dot2c_f32_bf16 v188, v143, v7
    v_dot2c_f32_bf16 v189, v147, v11
    v_dot2c_f32_bf16 v190, v151, v15
    buffer_load_dwordx4 v[140:143], v2, s[16:19], s24 offen offset:0 nt
    buffer_load_dwordx4 v[144:147], v2, s[16:19], s24 offen offset:128 nt
    buffer_load_dwordx4 v[148:151], v2, s[16:19], s24 offen offset:256 nt
    s_add_u32 s24, s24, 3072
    v_add_f32 v188, v188, v189
    v_add_f32 v188, v188, v190
    s_nop 1
    v_add_f32_dpp v189, v188, v188 quad_perm:[1,0,3,2] row_mask:0xf bank_mask:0xf
    s_nop 1
    v_add_f32_dpp v188, v189, v189 quad_perm:[2,3,0,1] row_mask:0xf bank_mask:0xf
    s_nop 1
    v_add_f32_dpp v189, v188, v188 row_half_mirror row_mask:0xf bank_mask:0xf
    v_cvt_pk_bf16_f32 v189, v189, v189
    v_and_b32 v189, 0xffff0000, v189
    v_mul_f32 v83, s37, v189
    v_cvt_pk_bf16_f32 v83, v83, v83
    v_and_b32 v83, 0xffff0000, v83
    s_waitcnt vmcnt(13)
    v_mov_b32 v188, 0
    v_mov_b32 v189, 0
    v_mov_b32 v190, 0
    v_dot2c_f32_bf16 v188, v152, v4
    v_dot2c_f32_bf16 v189, v156, v8
    v_dot2c_f32_bf16 v190, v160, v12
    v_dot2c_f32_bf16 v188, v153, v5
    v_dot2c_f32_bf16 v189, v157, v9
    v_dot2c_f32_bf16 v190, v161, v13
    v_dot2c_f32_bf16 v188, v154, v6
    v_dot2c_f32_bf16 v189, v158, v10
    v_dot2c_f32_bf16 v190, v162, v14
    v_dot2c_f32_bf16 v188, v155, v7
    v_dot2c_f32_bf16 v189, v159, v11
    v_dot2c_f32_bf16 v190, v163, v15
    buffer_load_dwordx4 v[152:155], v2, s[16:19], s24 offen offset:0 nt
    buffer_load_dwordx4 v[156:159], v2, s[16:19], s24 offen offset:128 nt
    buffer_load_dwordx4 v[160:163], v2, s[16:19], s24 offen offset:256 nt
    s_add_u32 s24, s24, 3072
    v_add_f32 v188, v188, v189
    v_add_f32 v188, v188, v190
    s_nop 1
    v_add_f32_dpp v189, v188, v188 quad_perm:[1,0,3,2] row_mask:0xf bank_mask:0xf
    s_nop 1
    v_add_f32_dpp v188, v189, v189 quad_perm:[2,3,0,1] row_mask:0xf bank_mask:0xf
    s_nop 1
    v_add_f32_dpp v189, v188, v188 row_half_mirror row_mask:0xf bank_mask:0xf
    v_cvt_pk_bf16_f32 v189, v189, v189
    v_and_b32 v189, 0xffff0000, v189
    v_mul_f32 v84, s37, v189
    v_cvt_pk_bf16_f32 v84, v84, v84
    v_and_b32 v84, 0xffff0000, v84
    s_waitcnt vmcnt(12)
    v_mov_b32 v188, 0
    v_mov_b32 v189, 0
    v_mov_b32 v190, 0
    v_dot2c_f32_bf16 v188, v164, v4
    v_dot2c_f32_bf16 v189, v168, v8
    v_dot2c_f32_bf16 v190, v172, v12
    v_dot2c_f32_bf16 v188, v165, v5
    v_dot2c_f32_bf16 v189, v169, v9
    v_dot2c_f32_bf16 v190, v173, v13
    v_dot2c_f32_bf16 v188, v166, v6
    v_dot2c_f32_bf16 v189, v170, v10
    v_dot2c_f32_bf16 v190, v174, v14
    v_dot2c_f32_bf16 v188, v167, v7
    v_dot2c_f32_bf16 v189, v171, v11
    v_dot2c_f32_bf16 v190, v175, v15
    buffer_load_dwordx4 v[164:167], v2, s[16:19], s24 offen offset:0 nt
    buffer_load_dwordx4 v[168:171], v2, s[16:19], s24 offen offset:128 nt
    buffer_load_dwordx4 v[172:175], v2, s[16:19], s24 offen offset:256 nt
    s_add_u32 s24, s24, 3072
    v_add_f32 v188, v188, v189
    v_add_f32 v188, v188, v190
    s_nop 1
    v_add_f32_dpp v189, v188, v188 quad_perm:[1,0,3,2] row_mask:0xf bank_mask:0xf
    s_nop 1
    v_add_f32_dpp v188, v189, v189 quad_perm:[2,3,0,1] row_mask:0xf bank_mask:0xf
    s_nop 1
    v_add_f32_dpp v189, v188, v188 row_half_mirror row_mask:0xf bank_mask:0xf
    v_cvt_pk_bf16_f32 v189, v189, v189
    v_and_b32 v189, 0xffff0000, v189
    v_mul_f32 v85, s37, v189
    v_cvt_pk_bf16_f32 v85, v85, v85
    v_and_b32 v85, 0xffff0000, v85
    s_waitcnt vmcnt(12)
    v_mov_b32 v188, 0
    v_mov_b32 v189, 0
    v_mov_b32 v190, 0
    v_dot2c_f32_bf16 v188, v176, v4
    v_dot2c_f32_bf16 v189, v180, v8
    v_dot2c_f32_bf16 v190, v184, v12
    v_dot2c_f32_bf16 v188, v177, v5
    v_dot2c_f32_bf16 v189, v181, v9
    v_dot2c_f32_bf16 v190, v185, v13
    v_dot2c_f32_bf16 v188, v178, v6
    v_dot2c_f32_bf16 v189, v182, v10
    v_dot2c_f32_bf16 v190, v186, v14
    v_dot2c_f32_bf16 v188, v179, v7
    v_dot2c_f32_bf16 v189, v183, v11
    v_dot2c_f32_bf16 v190, v187, v15
    buffer_load_dwordx4 v[176:179], v2, s[16:19], s24 offen offset:0 nt
    buffer_load_dwordx4 v[180:183], v2, s[16:19], s24 offen offset:128 nt
    buffer_load_dwordx4 v[184:187], v2, s[16:19], s24 offen offset:256 nt
    s_add_u32 s24, s24, 3072
    v_add_f32 v188, v188, v189
    v_add_f32 v188, v188, v190
    s_nop 1
    v_add_f32_dpp v189, v188, v188 quad_perm:[1,0,3,2] row_mask:0xf bank_mask:0xf
    s_nop 1
    v_add_f32_dpp v188, v189, v189 quad_perm:[2,3,0,1] row_mask:0xf bank_mask:0xf
    s_nop 1
    v_add_f32_dpp v189, v188, v188 row_half_mirror row_mask:0xf bank_mask:0xf
    v_cvt_pk_bf16_f32 v189, v189, v189
    v_and_b32 v189, 0xffff0000, v189
    v_mul_f32 v86, s37, v189
    v_cvt_pk_bf16_f32 v86, v86, v86
    v_and_b32 v86, 0xffff0000, v86
    s_waitcnt vmcnt(12)
    v_mov_b32 v188, 0
    v_mov_b32 v189, 0
    v_mov_b32 v190, 0
    v_dot2c_f32_bf16 v188, v128, v4
    v_dot2c_f32_bf16 v189, v132, v8
    v_dot2c_f32_bf16 v190, v136, v12
    v_dot2c_f32_bf16 v188, v129, v5
    v_dot2c_f32_bf16 v189, v133, v9
    v_dot2c_f32_bf16 v190, v137, v13
    v_dot2c_f32_bf16 v188, v130, v6
    v_dot2c_f32_bf16 v189, v134, v10
    v_dot2c_f32_bf16 v190, v138, v14
    v_dot2c_f32_bf16 v188, v131, v7
    v_dot2c_f32_bf16 v189, v135, v11
    v_dot2c_f32_bf16 v190, v139, v15
    buffer_load_dwordx4 v[128:131], v2, s[16:19], s24 offen offset:0 nt
    buffer_load_dwordx4 v[132:135], v2, s[16:19], s24 offen offset:128 nt
    buffer_load_dwordx4 v[136:139], v2, s[16:19], s24 offen offset:256 nt
    s_add_u32 s24, s24, 3072
    v_add_f32 v188, v188, v189
    v_add_f32 v188, v188, v190
    s_nop 1
    v_add_f32_dpp v189, v188, v188 quad_perm:[1,0,3,2] row_mask:0xf bank_mask:0xf
    s_nop 1
    v_add_f32_dpp v188, v189, v189 quad_perm:[2,3,0,1] row_mask:0xf bank_mask:0xf
    s_nop 1
    v_add_f32_dpp v189, v188, v188 row_half_mirror row_mask:0xf bank_mask:0xf
    v_cvt_pk_bf16_f32 v189, v189, v189
    v_and_b32 v189, 0xffff0000, v189
    v_mul_f32 v87, s37, v189
    v_cvt_pk_bf16_f32 v87, v87, v87
    v_and_b32 v87, 0xffff0000, v87
    s_waitcnt vmcnt(12)
    v_mov_b32 v188, 0
    v_mov_b32 v189, 0
    v_mov_b32 v190, 0
    v_dot2c_f32_bf16 v188, v140, v4
    v_dot2c_f32_bf16 v189, v144, v8
    v_dot2c_f32_bf16 v190, v148, v12
    v_dot2c_f32_bf16 v188, v141, v5
    v_dot2c_f32_bf16 v189, v145, v9
    v_dot2c_f32_bf16 v190, v149, v13
    v_dot2c_f32_bf16 v188, v142, v6
    v_dot2c_f32_bf16 v189, v146, v10
    v_dot2c_f32_bf16 v190, v150, v14
    v_dot2c_f32_bf16 v188, v143, v7
    v_dot2c_f32_bf16 v189, v147, v11
    v_dot2c_f32_bf16 v190, v151, v15
    buffer_load_dwordx4 v[140:143], v2, s[16:19], s24 offen offset:0 nt
    buffer_load_dwordx4 v[144:147], v2, s[16:19], s24 offen offset:128 nt
    buffer_load_dwordx4 v[148:151], v2, s[16:19], s24 offen offset:256 nt
    s_add_u32 s24, s24, 3072
    v_add_f32 v188, v188, v189
    v_add_f32 v188, v188, v190
    s_nop 1
    v_add_f32_dpp v189, v188, v188 quad_perm:[1,0,3,2] row_mask:0xf bank_mask:0xf
    s_nop 1
    v_add_f32_dpp v188, v189, v189 quad_perm:[2,3,0,1] row_mask:0xf bank_mask:0xf
    s_nop 1
    v_add_f32_dpp v189, v188, v188 row_half_mirror row_mask:0xf bank_mask:0xf
    v_cvt_pk_bf16_f32 v189, v189, v189
    v_and_b32 v189, 0xffff0000, v189
    v_mul_f32 v88, s37, v189
    v_cvt_pk_bf16_f32 v88, v88, v88
    v_and_b32 v88, 0xffff0000, v88
    s_waitcnt vmcnt(12)
    v_mov_b32 v188, 0
    v_mov_b32 v189, 0
    v_mov_b32 v190, 0
    v_dot2c_f32_bf16 v188, v152, v4
    v_dot2c_f32_bf16 v189, v156, v8
    v_dot2c_f32_bf16 v190, v160, v12
    v_dot2c_f32_bf16 v188, v153, v5
    v_dot2c_f32_bf16 v189, v157, v9
    v_dot2c_f32_bf16 v190, v161, v13
    v_dot2c_f32_bf16 v188, v154, v6
    v_dot2c_f32_bf16 v189, v158, v10
    v_dot2c_f32_bf16 v190, v162, v14
    v_dot2c_f32_bf16 v188, v155, v7
    v_dot2c_f32_bf16 v189, v159, v11
    v_dot2c_f32_bf16 v190, v163, v15
    buffer_load_dwordx4 v[152:155], v2, s[16:19], s24 offen offset:0 nt
    buffer_load_dwordx4 v[156:159], v2, s[16:19], s24 offen offset:128 nt
    buffer_load_dwordx4 v[160:163], v2, s[16:19], s24 offen offset:256 nt
    s_add_u32 s24, s24, 3072
    v_add_f32 v188, v188, v189
    v_add_f32 v188, v188, v190
    s_nop 1
    v_add_f32_dpp v189, v188, v188 quad_perm:[1,0,3,2] row_mask:0xf bank_mask:0xf
    s_nop 1
    v_add_f32_dpp v188, v189, v189 quad_perm:[2,3,0,1] row_mask:0xf bank_mask:0xf
    s_nop 1
    v_add_f32_dpp v189, v188, v188 row_half_mirror row_mask:0xf bank_mask:0xf
    v_cvt_pk_bf16_f32 v189, v189, v189
    v_and_b32 v189, 0xffff0000, v189
    v_mul_f32 v89, s37, v189
    v_cvt_pk_bf16_f32 v89, v89, v89
    v_and_b32 v89, 0xffff0000, v89
    s_waitcnt vmcnt(12)
    v_mov_b32 v188, 0
    v_mov_b32 v189, 0
    v_mov_b32 v190, 0
    v_dot2c_f32_bf16 v188, v164, v4
    v_dot2c_f32_bf16 v189, v168, v8
    v_dot2c_f32_bf16 v190, v172, v12
    v_dot2c_f32_bf16 v188, v165, v5
    v_dot2c_f32_bf16 v189, v169, v9
    v_dot2c_f32_bf16 v190, v173, v13
    v_dot2c_f32_bf16 v188, v166, v6
    v_dot2c_f32_bf16 v189, v170, v10
    v_dot2c_f32_bf16 v190, v174, v14
    v_dot2c_f32_bf16 v188, v167, v7
    v_dot2c_f32_bf16 v189, v171, v11
    v_dot2c_f32_bf16 v190, v175, v15
    buffer_load_dwordx4 v[164:167], v2, s[16:19], s24 offen offset:0 nt
    buffer_load_dwordx4 v[168:171], v2, s[16:19], s24 offen offset:128 nt
    buffer_load_dwordx4 v[172:175], v2, s[16:19], s24 offen offset:256 nt
    s_mov_b32 s24, 100663296
    v_add_f32 v188, v188, v189
    v_add_f32 v188, v188, v190
    s_nop 1
    v_add_f32_dpp v189, v188, v188 quad_perm:[1,0,3,2] row_mask:0xf bank_mask:0xf
    s_nop 1
    v_add_f32_dpp v188, v189, v189 quad_perm:[2,3,0,1] row_mask:0xf bank_mask:0xf
    s_nop 1
    v_add_f32_dpp v189, v188, v188 row_half_mirror row_mask:0xf bank_mask:0xf
    v_cvt_pk_bf16_f32 v189, v189, v189
    v_and_b32 v189, 0xffff0000, v189
    v_mul_f32 v90, s37, v189
    v_cvt_pk_bf16_f32 v90, v90, v90
    v_and_b32 v90, 0xffff0000, v90
    s_waitcnt vmcnt(12)
    v_mov_b32 v188, 0
    v_mov_b32 v189, 0
    v_mov_b32 v190, 0
    v_dot2c_f32_bf16 v188, v176, v4
    v_dot2c_f32_bf16 v189, v180, v8
    v_dot2c_f32_bf16 v190, v184, v12
    v_dot2c_f32_bf16 v188, v177, v5
    v_dot2c_f32_bf16 v189, v181, v9
    v_dot2c_f32_bf16 v190, v185, v13
    v_dot2c_f32_bf16 v188, v178, v6
    v_dot2c_f32_bf16 v189, v182, v10
    v_dot2c_f32_bf16 v190, v186, v14
    v_dot2c_f32_bf16 v188, v179, v7
    v_dot2c_f32_bf16 v189, v183, v11
    v_dot2c_f32_bf16 v190, v187, v15
    buffer_load_dwordx4 v[176:179], v2, s[16:19], s24 offen offset:0 nt
    buffer_load_dwordx4 v[180:183], v2, s[16:19], s24 offen offset:128 nt
    buffer_load_dwordx4 v[184:187], v2, s[16:19], s24 offen offset:256 nt
    s_add_u32 s24, s24, 3072
    v_add_f32 v188, v188, v189
    v_add_f32 v188, v188, v190
    s_nop 1
    v_add_f32_dpp v189, v188, v188 quad_perm:[1,0,3,2] row_mask:0xf bank_mask:0xf
    s_nop 1
    v_add_f32_dpp v188, v189, v189 quad_perm:[2,3,0,1] row_mask:0xf bank_mask:0xf
    s_nop 1
    v_add_f32_dpp v189, v188, v188 row_half_mirror row_mask:0xf bank_mask:0xf
    v_cvt_pk_bf16_f32 v189, v189, v189
    v_and_b32 v189, 0xffff0000, v189
    v_mul_f32 v91, s37, v189
    v_cvt_pk_bf16_f32 v91, v91, v91
    v_and_b32 v91, 0xffff0000, v91
    s_waitcnt vmcnt(12)
    v_mov_b32 v188, 0
    v_mov_b32 v189, 0
    v_mov_b32 v190, 0
    v_dot2c_f32_bf16 v188, v128, v4
    v_dot2c_f32_bf16 v189, v132, v8
    v_dot2c_f32_bf16 v190, v136, v12
    v_dot2c_f32_bf16 v188, v129, v5
    v_dot2c_f32_bf16 v189, v133, v9
    v_dot2c_f32_bf16 v190, v137, v13
    v_dot2c_f32_bf16 v188, v130, v6
    v_dot2c_f32_bf16 v189, v134, v10
    v_dot2c_f32_bf16 v190, v138, v14
    v_dot2c_f32_bf16 v188, v131, v7
    v_dot2c_f32_bf16 v189, v135, v11
    v_dot2c_f32_bf16 v190, v139, v15
    buffer_load_dwordx4 v[128:131], v2, s[16:19], s24 offen offset:0 nt
    buffer_load_dwordx4 v[132:135], v2, s[16:19], s24 offen offset:128 nt
    buffer_load_dwordx4 v[136:139], v2, s[16:19], s24 offen offset:256 nt
    s_add_u32 s24, s24, 3072
    v_add_f32 v188, v188, v189
    v_add_f32 v188, v188, v190
    s_nop 1
    v_add_f32_dpp v189, v188, v188 quad_perm:[1,0,3,2] row_mask:0xf bank_mask:0xf
    s_nop 1
    v_add_f32_dpp v188, v189, v189 quad_perm:[2,3,0,1] row_mask:0xf bank_mask:0xf
    s_nop 1
    v_add_f32_dpp v189, v188, v188 row_half_mirror row_mask:0xf bank_mask:0xf
    v_cvt_pk_bf16_f32 v189, v189, v189
    v_and_b32 v189, 0xffff0000, v189
    v_mul_f32 v92, s37, v189
    v_cvt_pk_bf16_f32 v92, v92, v92
    v_and_b32 v92, 0xffff0000, v92
    s_waitcnt vmcnt(12)
    v_mov_b32 v188, 0
    v_mov_b32 v189, 0
    v_mov_b32 v190, 0
    v_dot2c_f32_bf16 v188, v140, v4
    v_dot2c_f32_bf16 v189, v144, v8
    v_dot2c_f32_bf16 v190, v148, v12
    v_dot2c_f32_bf16 v188, v141, v5
    v_dot2c_f32_bf16 v189, v145, v9
    v_dot2c_f32_bf16 v190, v149, v13
    v_dot2c_f32_bf16 v188, v142, v6
    v_dot2c_f32_bf16 v189, v146, v10
    v_dot2c_f32_bf16 v190, v150, v14
    v_dot2c_f32_bf16 v188, v143, v7
    v_dot2c_f32_bf16 v189, v147, v11
    v_dot2c_f32_bf16 v190, v151, v15
    buffer_load_dwordx4 v[140:143], v2, s[16:19], s24 offen offset:0 nt
    buffer_load_dwordx4 v[144:147], v2, s[16:19], s24 offen offset:128 nt
    buffer_load_dwordx4 v[148:151], v2, s[16:19], s24 offen offset:256 nt
    s_add_u32 s24, s24, 3072
    v_add_f32 v188, v188, v189
    v_add_f32 v188, v188, v190
    s_nop 1
    v_add_f32_dpp v189, v188, v188 quad_perm:[1,0,3,2] row_mask:0xf bank_mask:0xf
    s_nop 1
    v_add_f32_dpp v188, v189, v189 quad_perm:[2,3,0,1] row_mask:0xf bank_mask:0xf
    s_nop 1
    v_add_f32_dpp v189, v188, v188 row_half_mirror row_mask:0xf bank_mask:0xf
    v_cvt_pk_bf16_f32 v189, v189, v189
    v_and_b32 v189, 0xffff0000, v189
    v_mul_f32 v93, s37, v189
    v_cvt_pk_bf16_f32 v93, v93, v93
    v_and_b32 v93, 0xffff0000, v93
    s_waitcnt vmcnt(12)
    v_mov_b32 v188, 0
    v_mov_b32 v189, 0
    v_mov_b32 v190, 0
    v_dot2c_f32_bf16 v188, v152, v4
    v_dot2c_f32_bf16 v189, v156, v8
    v_dot2c_f32_bf16 v190, v160, v12
    v_dot2c_f32_bf16 v188, v153, v5
    v_dot2c_f32_bf16 v189, v157, v9
    v_dot2c_f32_bf16 v190, v161, v13
    v_dot2c_f32_bf16 v188, v154, v6
    v_dot2c_f32_bf16 v189, v158, v10
    v_dot2c_f32_bf16 v190, v162, v14
    v_dot2c_f32_bf16 v188, v155, v7
    v_dot2c_f32_bf16 v189, v159, v11
    v_dot2c_f32_bf16 v190, v163, v15
    buffer_load_dwordx4 v[152:155], v2, s[16:19], s24 offen offset:0 nt
    buffer_load_dwordx4 v[156:159], v2, s[16:19], s24 offen offset:128 nt
    buffer_load_dwordx4 v[160:163], v2, s[16:19], s24 offen offset:256 nt
    s_add_u32 s24, s24, 3072
    v_add_f32 v188, v188, v189
    v_add_f32 v188, v188, v190
    s_nop 1
    v_add_f32_dpp v189, v188, v188 quad_perm:[1,0,3,2] row_mask:0xf bank_mask:0xf
    s_nop 1
    v_add_f32_dpp v188, v189, v189 quad_perm:[2,3,0,1] row_mask:0xf bank_mask:0xf
    s_nop 1
    v_add_f32_dpp v189, v188, v188 row_half_mirror row_mask:0xf bank_mask:0xf
    v_cvt_pk_bf16_f32 v189, v189, v189
    v_and_b32 v189, 0xffff0000, v189
    v_mul_f32 v94, s37, v189
    v_cvt_pk_bf16_f32 v94, v94, v94
    v_and_b32 v94, 0xffff0000, v94
    s_waitcnt vmcnt(12)
    v_mov_b32 v188, 0
    v_mov_b32 v189, 0
    v_mov_b32 v190, 0
    v_dot2c_f32_bf16 v188, v164, v4
    v_dot2c_f32_bf16 v189, v168, v8
    v_dot2c_f32_bf16 v190, v172, v12
    v_dot2c_f32_bf16 v188, v165, v5
    v_dot2c_f32_bf16 v189, v169, v9
    v_dot2c_f32_bf16 v190, v173, v13
    v_dot2c_f32_bf16 v188, v166, v6
    v_dot2c_f32_bf16 v189, v170, v10
    v_dot2c_f32_bf16 v190, v174, v14
    v_dot2c_f32_bf16 v188, v167, v7
    v_dot2c_f32_bf16 v189, v171, v11
    v_dot2c_f32_bf16 v190, v175, v15
    buffer_load_dwordx4 v[164:167], v2, s[16:19], s24 offen offset:0 nt
    buffer_load_dwordx4 v[168:171], v2, s[16:19], s24 offen offset:128 nt
    buffer_load_dwordx4 v[172:175], v2, s[16:19], s24 offen offset:256 nt
    s_add_u32 s24, s24, 3072
    v_add_f32 v188, v188, v189
    v_add_f32 v188, v188, v190
    s_nop 1
    v_add_f32_dpp v189, v188, v188 quad_perm:[1,0,3,2] row_mask:0xf bank_mask:0xf
    s_nop 1
    v_add_f32_dpp v188, v189, v189 quad_perm:[2,3,0,1] row_mask:0xf bank_mask:0xf
    s_nop 1
    v_add_f32_dpp v189, v188, v188 row_half_mirror row_mask:0xf bank_mask:0xf
    v_cvt_pk_bf16_f32 v189, v189, v189
    v_and_b32 v189, 0xffff0000, v189
    v_mul_f32 v95, s37, v189
    v_cvt_pk_bf16_f32 v95, v95, v95
    v_and_b32 v95, 0xffff0000, v95
    v_max3_f32 v188, v64, v65, v66
    v_max3_f32 v188, v188, v67, v68
    v_max3_f32 v188, v188, v69, v70
    v_max3_f32 v188, v188, v71, v72
    v_max3_f32 v188, v188, v73, v74
    v_max3_f32 v188, v188, v75, v76
    v_max3_f32 v188, v188, v77, v78
    v_max3_f32 v188, v188, v79, v80
    v_max3_f32 v188, v188, v81, v82
    v_max3_f32 v188, v188, v83, v84
    v_max3_f32 v188, v188, v85, v86
    v_max3_f32 v188, v188, v87, v88
    v_max3_f32 v188, v188, v89, v90
    v_max3_f32 v188, v188, v91, v92
    v_max3_f32 v188, v188, v93, v94
    v_max_f32 v188, v188, v95
    s_nop 1
    v_max_f32_dpp v189, v188, v188 row_ror:8 row_mask:0xf bank_mask:0xf
    s_nop 1
    v_readlane_b32 s44, v189, 0
    v_readlane_b32 s45, v189, 16
    v_readlane_b32 s46, v189, 32
    v_readlane_b32 s47, v189, 48
    s_nop 1
    v_mov_b32 v189, s44
    v_max_f32 v189, s45, v189
    v_max_f32 v189, s46, v189
    v_max_f32 v189, s47, v189
    v_mov_b32 v190, 0
    v_sub_f32 v188, v64, v189
    v_mul_f32 v188, s36, v188
    v_exp_f32 v188, v188
    s_nop 0
    v_add_f32 v190, v190, v188
    v_sub_f32 v188, v65, v189
    v_mul_f32 v188, s36, v188
    v_exp_f32 v188, v188
    s_nop 0
    v_add_f32 v190, v190, v188
    v_sub_f32 v188, v66, v189
    v_mul_f32 v188, s36, v188
    v_exp_f32 v188, v188
    s_nop 0
    v_add_f32 v190, v190, v188
    v_sub_f32 v188, v67, v189
    v_mul_f32 v188, s36, v188
    v_exp_f32 v188, v188
    s_nop 0
    v_add_f32 v190, v190, v188
    v_sub_f32 v188, v68, v189
    v_mul_f32 v188, s36, v188
    v_exp_f32 v188, v188
    s_nop 0
    v_add_f32 v190, v190, v188
    v_sub_f32 v188, v69, v189
    v_mul_f32 v188, s36, v188
    v_exp_f32 v188, v188
    s_nop 0
    v_add_f32 v190, v190, v188
    v_sub_f32 v188, v70, v189
    v_mul_f32 v188, s36, v188
    v_exp_f32 v188, v188
    s_nop 0
    v_add_f32 v190, v190, v188
    v_sub_f32 v188, v71, v189
    v_mul_f32 v188, s36, v188
    v_exp_f32 v188, v188
    s_nop 0
    v_add_f32 v190, v190, v188
    v_sub_f32 v188, v72, v189
    v_mul_f32 v188, s36, v188
    v_exp_f32 v188, v188
    s_nop 0
    v_add_f32 v190, v190, v188
    v_sub_f32 v188, v73, v189
    v_mul_f32 v188, s36, v188
    v_exp_f32 v188, v188
    s_nop 0
    v_add_f32 v190, v190, v188
    v_sub_f32 v188, v74, v189
    v_mul_f32 v188, s36, v188
    v_exp_f32 v188, v188
    s_nop 0
    v_add_f32 v190, v190, v188
    v_sub_f32 v188, v75, v189
    v_mul_f32 v188, s36, v188
    v_exp_f32 v188, v188
    s_nop 0
    v_add_f32 v190, v190, v188
    v_sub_f32 v188, v76, v189
    v_mul_f32 v188, s36, v188
    v_exp_f32 v188, v188
    s_nop 0
    v_add_f32 v190, v190, v188
    v_sub_f32 v188, v77, v189
    v_mul_f32 v188, s36, v188
    v_exp_f32 v188, v188
    s_nop 0
    v_add_f32 v190, v190, v188
    v_sub_f32 v188, v78, v189
    v_mul_f32 v188, s36, v188
    v_exp_f32 v188, v188
    s_nop 0
    v_add_f32 v190, v190, v188
    v_sub_f32 v188, v79, v189
    v_mul_f32 v188, s36, v188
    v_exp_f32 v188, v188
    s_nop 0
    v_add_f32 v190, v190, v188
    v_sub_f32 v188, v80, v189
    v_mul_f32 v188, s36, v188
    v_exp_f32 v188, v188
    s_nop 0
    v_add_f32 v190, v190, v188
    v_sub_f32 v188, v81, v189
    v_mul_f32 v188, s36, v188
    v_exp_f32 v188, v188
    s_nop 0
    v_add_f32 v190, v190, v188
    v_sub_f32 v188, v82, v189
    v_mul_f32 v188, s36, v188
    v_exp_f32 v188, v188
    s_nop 0
    v_add_f32 v190, v190, v188
    v_sub_f32 v188, v83, v189
    v_mul_f32 v188, s36, v188
    v_exp_f32 v188, v188
    s_nop 0
    v_add_f32 v190, v190, v188
    v_sub_f32 v188, v84, v189
    v_mul_f32 v188, s36, v188
    v_exp_f32 v188, v188
    s_nop 0
    v_add_f32 v190, v190, v188
    v_sub_f32 v188, v85, v189
    v_mul_f32 v188, s36, v188
    v_exp_f32 v188, v188
    s_nop 0
    v_add_f32 v190, v190, v188
    v_sub_f32 v188, v86, v189
    v_mul_f32 v188, s36, v188
    v_exp_f32 v188, v188
    s_nop 0
    v_add_f32 v190, v190, v188
    v_sub_f32 v188, v87, v189
    v_mul_f32 v188, s36, v188
    v_exp_f32 v188, v188
    s_nop 0
    v_add_f32 v190, v190, v188
    v_sub_f32 v188, v88, v189
    v_mul_f32 v188, s36, v188
    v_exp_f32 v188, v188
    s_nop 0
    v_add_f32 v190, v190, v188
    v_sub_f32 v188, v89, v189
    v_mul_f32 v188, s36, v188
    v_exp_f32 v188, v188
    s_nop 0
    v_add_f32 v190, v190, v188
    v_sub_f32 v188, v90, v189
    v_mul_f32 v188, s36, v188
    v_exp_f32 v188, v188
    s_nop 0
    v_add_f32 v190, v190, v188
    v_sub_f32 v188, v91, v189
    v_mul_f32 v188, s36, v188
    v_exp_f32 v188, v188
    s_nop 0
    v_add_f32 v190, v190, v188
    v_sub_f32 v188, v92, v189
    v_mul_f32 v188, s36, v188
    v_exp_f32 v188, v188
    s_nop 0
    v_add_f32 v190, v190, v188
    v_sub_f32 v188, v93, v189
    v_mul_f32 v188, s36, v188
    v_exp_f32 v188, v188
    s_nop 0
    v_add_f32 v190, v190, v188
    v_sub_f32 v188, v94, v189
    v_mul_f32 v188, s36, v188
    v_exp_f32 v188, v188
    s_nop 0
    v_add_f32 v190, v190, v188
    v_sub_f32 v188, v95, v189
    v_mul_f32 v188, s36, v188
    v_exp_f32 v188, v188
    s_nop 0
    v_add_f32 v190, v190, v188
    s_nop 1
    v_add_f32_dpp v191, v190, v190 row_ror:8 row_mask:0xf bank_mask:0xf
    s_nop 1
    v_readlane_b32 s44, v191, 0
    v_readlane_b32 s45, v191, 16
    v_readlane_b32 s46, v191, 32
    v_readlane_b32 s47, v191, 48
    s_nop 1
    v_mov_b32 v191, s44
    v_add_f32 v191, s45, v191
    v_add_f32 v191, s46, v191
    v_add_f32 v191, s47, v191
    v_or_b32 v190, 1, v189
    v_or_b32 v191, 1, v191
    s_lshl_b32 s13, s12, 3
    s_add_u32 s13, s13, s42
    v_mov_b32 v194, s13
    s_mov_b64 s[40:41], exec
    s_mov_b64 exec, 1
    global_store_dwordx2 v194, v[190:191], s[88:89] offset:32 sc1
    s_mov_b64 exec, s[40:41]

    ds_read_b128 v[4:7], v3 offset:5504
    ds_read_b128 v[8:11], v3 offset:5632
    ds_read_b128 v[12:15], v3 offset:5760
    s_waitcnt lgkmcnt(0)
    s_waitcnt vmcnt(13)
    v_mov_b32 v188, 0
    v_mov_b32 v189, 0
    v_mov_b32 v190, 0
    v_dot2c_f32_bf16 v188, v176, v4
    v_dot2c_f32_bf16 v189, v180, v8
    v_dot2c_f32_bf16 v190, v184, v12
    v_dot2c_f32_bf16 v188, v177, v5
    v_dot2c_f32_bf16 v189, v181, v9
    v_dot2c_f32_bf16 v190, v185, v13
    v_dot2c_f32_bf16 v188, v178, v6
    v_dot2c_f32_bf16 v189, v182, v10
    v_dot2c_f32_bf16 v190, v186, v14
    v_dot2c_f32_bf16 v188, v179, v7
    v_dot2c_f32_bf16 v189, v183, v11
    v_dot2c_f32_bf16 v190, v187, v15
    buffer_load_dwordx4 v[176:179], v2, s[16:19], s24 offen offset:0 nt
    buffer_load_dwordx4 v[180:183], v2, s[16:19], s24 offen offset:128 nt
    buffer_load_dwordx4 v[184:187], v2, s[16:19], s24 offen offset:256 nt
    s_add_u32 s24, s24, 3072
    v_add_f32 v188, v188, v189
    v_add_f32 v188, v188, v190
    s_nop 1
    v_add_f32_dpp v189, v188, v188 quad_perm:[1,0,3,2] row_mask:0xf bank_mask:0xf
    s_nop 1
    v_add_f32_dpp v188, v189, v189 quad_perm:[2,3,0,1] row_mask:0xf bank_mask:0xf
    s_nop 1
    v_add_f32_dpp v189, v188, v188 row_half_mirror row_mask:0xf bank_mask:0xf
    v_cvt_pk_bf16_f32 v189, v189, v189
    v_and_b32 v189, 0xffff0000, v189
    v_mul_f32 v96, s37, v189
    v_cvt_pk_bf16_f32 v96, v96, v96
    v_and_b32 v96, 0xffff0000, v96
    s_waitcnt vmcnt(13)
    v_mov_b32 v188, 0
    v_mov_b32 v189, 0
    v_mov_b32 v190, 0
    v_dot2c_f32_bf16 v188, v128, v4
    v_dot2c_f32_bf16 v189, v132, v8
    v_dot2c_f32_bf16 v190, v136, v12
    v_dot2c_f32_bf16 v188, v129, v5
    v_dot2c_f32_bf16 v189, v133, v9
    v_dot2c_f32_bf16 v190, v137, v13
    v_dot2c_f32_bf16 v188, v130, v6
    v_dot2c_f32_bf16 v189, v134, v10
    v_dot2c_f32_bf16 v190, v138, v14
    v_dot2c_f32_bf16 v188, v131, v7
    v_dot2c_f32_bf16 v189, v135, v11
    v_dot2c_f32_bf16 v190, v139, v15
    buffer_load_dwordx4 v[128:131], v2, s[16:19], s24 offen offset:0 nt
    buffer_load_dwordx4 v[132:135], v2, s[16:19], s24 offen offset:128 nt
    buffer_load_dwordx4 v[136:139], v2, s[16:19], s24 offen offset:256 nt
    s_add_u32 s24, s24, 3072
    v_add_f32 v188, v188, v189
    v_add_f32 v188, v188, v190
    s_nop 1
    v_add_f32_dpp v189, v188, v188 quad_perm:[1,0,3,2] row_mask:0xf bank_mask:0xf
    s_nop 1
    v_add_f32_dpp v188, v189, v189 quad_perm:[2,3,0,1] row_mask:0xf bank_mask:0xf
    s_nop 1
    v_add_f32_dpp v189, v188, v188 row_half_mirror row_mask:0xf bank_mask:0xf
    v_cvt_pk_bf16_f32 v189, v189, v189
    v_and_b32 v189, 0xffff0000, v189
    v_mul_f32 v97, s37, v189
    v_cvt_pk_bf16_f32 v97, v97, v97
    v_and_b32 v97, 0xffff0000, v97
    s_waitcnt vmcnt(13)
    v_mov_b32 v188, 0
    v_mov_b32 v189, 0
    v_mov_b32 v190, 0
    v_dot2c_f32_bf16 v188, v140, v4
    v_dot2c_f32_bf16 v189, v144, v8
    v_dot2c_f32_bf16 v190, v148, v12
    v_dot2c_f32_bf16 v188, v141, v5
    v_dot2c_f32_bf16 v189, v145, v9
    v_dot2c_f32_bf16 v190, v149, v13
    v_dot2c_f32_bf16 v188, v142, v6
    v_dot2c_f32_bf16 v189, v146, v10
    v_dot2c_f32_bf16 v190, v150, v14
    v_dot2c_f32_bf16 v188, v143, v7
    v_dot2c_f32_bf16 v189, v147, v11
    v_dot2c_f32_bf16 v190, v151, v15
    buffer_load_dwordx4 v[140:143], v2, s[16:19], s24 offen offset:0 nt
    buffer_load_dwordx4 v[144:147], v2, s[16:19], s24 offen offset:128 nt
    buffer_load_dwordx4 v[148:151], v2, s[16:19], s24 offen offset:256 nt
    s_add_u32 s24, s24, 3072
    v_add_f32 v188, v188, v189
    v_add_f32 v188, v188, v190
    s_nop 1
    v_add_f32_dpp v189, v188, v188 quad_perm:[1,0,3,2] row_mask:0xf bank_mask:0xf
    s_nop 1
    v_add_f32_dpp v188, v189, v189 quad_perm:[2,3,0,1] row_mask:0xf bank_mask:0xf
    s_nop 1
    v_add_f32_dpp v189, v188, v188 row_half_mirror row_mask:0xf bank_mask:0xf
    v_cvt_pk_bf16_f32 v189, v189, v189
    v_and_b32 v189, 0xffff0000, v189
    v_mul_f32 v98, s37, v189
    v_cvt_pk_bf16_f32 v98, v98, v98
    v_and_b32 v98, 0xffff0000, v98
    s_waitcnt vmcnt(13)
    v_mov_b32 v188, 0
    v_mov_b32 v189, 0
    v_mov_b32 v190, 0
    v_dot2c_f32_bf16 v188, v152, v4
    v_dot2c_f32_bf16 v189, v156, v8
    v_dot2c_f32_bf16 v190, v160, v12
    v_dot2c_f32_bf16 v188, v153, v5
    v_dot2c_f32_bf16 v189, v157, v9
    v_dot2c_f32_bf16 v190, v161, v13
    v_dot2c_f32_bf16 v188, v154, v6
    v_dot2c_f32_bf16 v189, v158, v10
    v_dot2c_f32_bf16 v190, v162, v14
    v_dot2c_f32_bf16 v188, v155, v7
    v_dot2c_f32_bf16 v189, v159, v11
    v_dot2c_f32_bf16 v190, v163, v15
    buffer_load_dwordx4 v[152:155], v2, s[16:19], s24 offen offset:0 nt
    buffer_load_dwordx4 v[156:159], v2, s[16:19], s24 offen offset:128 nt
    buffer_load_dwordx4 v[160:163], v2, s[16:19], s24 offen offset:256 nt
    s_add_u32 s24, s24, 3072
    v_add_f32 v188, v188, v189
    v_add_f32 v188, v188, v190
    s_nop 1
    v_add_f32_dpp v189, v188, v188 quad_perm:[1,0,3,2] row_mask:0xf bank_mask:0xf
    s_nop 1
    v_add_f32_dpp v188, v189, v189 quad_perm:[2,3,0,1] row_mask:0xf bank_mask:0xf
    s_nop 1
    v_add_f32_dpp v189, v188, v188 row_half_mirror row_mask:0xf bank_mask:0xf
    v_cvt_pk_bf16_f32 v189, v189, v189
    v_and_b32 v189, 0xffff0000, v189
    v_mul_f32 v99, s37, v189
    v_cvt_pk_bf16_f32 v99, v99, v99
    v_and_b32 v99, 0xffff0000, v99
    s_waitcnt vmcnt(13)
    v_mov_b32 v188, 0
    v_mov_b32 v189, 0
    v_mov_b32 v190, 0
    v_dot2c_f32_bf16 v188, v164, v4
    v_dot2c_f32_bf16 v189, v168, v8
    v_dot2c_f32_bf16 v190, v172, v12
    v_dot2c_f32_bf16 v188, v165, v5
    v_dot2c_f32_bf16 v189, v169, v9
    v_dot2c_f32_bf16 v190, v173, v13
    v_dot2c_f32_bf16 v188, v166, v6
    v_dot2c_f32_bf16 v189, v170, v10
    v_dot2c_f32_bf16 v190, v174, v14
    v_dot2c_f32_bf16 v188, v167, v7
    v_dot2c_f32_bf16 v189, v171, v11
    v_dot2c_f32_bf16 v190, v175, v15
    buffer_load_dwordx4 v[164:167], v2, s[16:19], s24 offen offset:0 nt
    buffer_load_dwordx4 v[168:171], v2, s[16:19], s24 offen offset:128 nt
    buffer_load_dwordx4 v[172:175], v2, s[16:19], s24 offen offset:256 nt
    s_add_u32 s24, s24, 3072
    v_add_f32 v188, v188, v189
    v_add_f32 v188, v188, v190
    s_nop 1
    v_add_f32_dpp v189, v188, v188 quad_perm:[1,0,3,2] row_mask:0xf bank_mask:0xf
    s_nop 1
    v_add_f32_dpp v188, v189, v189 quad_perm:[2,3,0,1] row_mask:0xf bank_mask:0xf
    s_nop 1
    v_add_f32_dpp v189, v188, v188 row_half_mirror row_mask:0xf bank_mask:0xf
    v_cvt_pk_bf16_f32 v189, v189, v189
    v_and_b32 v189, 0xffff0000, v189
    v_mul_f32 v100, s37, v189
    v_cvt_pk_bf16_f32 v100, v100, v100
    v_and_b32 v100, 0xffff0000, v100
    s_waitcnt vmcnt(12)
    v_mov_b32 v188, 0
    v_mov_b32 v189, 0
    v_mov_b32 v190, 0
    v_dot2c_f32_bf16 v188, v176, v4
    v_dot2c_f32_bf16 v189, v180, v8
    v_dot2c_f32_bf16 v190, v184, v12
    v_dot2c_f32_bf16 v188, v177, v5
    v_dot2c_f32_bf16 v189, v181, v9
    v_dot2c_f32_bf16 v190, v185, v13
    v_dot2c_f32_bf16 v188, v178, v6
    v_dot2c_f32_bf16 v189, v182, v10
    v_dot2c_f32_bf16 v190, v186, v14
    v_dot2c_f32_bf16 v188, v179, v7
    v_dot2c_f32_bf16 v189, v183, v11
    v_dot2c_f32_bf16 v190, v187, v15
    buffer_load_dwordx4 v[176:179], v2, s[16:19], s24 offen offset:0 nt
    buffer_load_dwordx4 v[180:183], v2, s[16:19], s24 offen offset:128 nt
    buffer_load_dwordx4 v[184:187], v2, s[16:19], s24 offen offset:256 nt
    s_add_u32 s24, s24, 3072
    v_add_f32 v188, v188, v189
    v_add_f32 v188, v188, v190
    s_nop 1
    v_add_f32_dpp v189, v188, v188 quad_perm:[1,0,3,2] row_mask:0xf bank_mask:0xf
    s_nop 1
    v_add_f32_dpp v188, v189, v189 quad_perm:[2,3,0,1] row_mask:0xf bank_mask:0xf
    s_nop 1
    v_add_f32_dpp v189, v188, v188 row_half_mirror row_mask:0xf bank_mask:0xf
    v_cvt_pk_bf16_f32 v189, v189, v189
    v_and_b32 v189, 0xffff0000, v189
    v_mul_f32 v101, s37, v189
    v_cvt_pk_bf16_f32 v101, v101, v101
    v_and_b32 v101, 0xffff0000, v101
    s_waitcnt vmcnt(12)
    v_mov_b32 v188, 0
    v_mov_b32 v189, 0
    v_mov_b32 v190, 0
    v_dot2c_f32_bf16 v188, v128, v4
    v_dot2c_f32_bf16 v189, v132, v8
    v_dot2c_f32_bf16 v190, v136, v12
    v_dot2c_f32_bf16 v188, v129, v5
    v_dot2c_f32_bf16 v189, v133, v9
    v_dot2c_f32_bf16 v190, v137, v13
    v_dot2c_f32_bf16 v188, v130, v6
    v_dot2c_f32_bf16 v189, v134, v10
    v_dot2c_f32_bf16 v190, v138, v14
    v_dot2c_f32_bf16 v188, v131, v7
    v_dot2c_f32_bf16 v189, v135, v11
    v_dot2c_f32_bf16 v190, v139, v15
    buffer_load_dwordx4 v[128:131], v2, s[16:19], s24 offen offset:0 nt
    buffer_load_dwordx4 v[132:135], v2, s[16:19], s24 offen offset:128 nt
    buffer_load_dwordx4 v[136:139], v2, s[16:19], s24 offen offset:256 nt
    s_add_u32 s24, s24, 3072
    v_add_f32 v188, v188, v189
    v_add_f32 v188, v188, v190
    s_nop 1
    v_add_f32_dpp v189, v188, v188 quad_perm:[1,0,3,2] row_mask:0xf bank_mask:0xf
    s_nop 1
    v_add_f32_dpp v188, v189, v189 quad_perm:[2,3,0,1] row_mask:0xf bank_mask:0xf
    s_nop 1
    v_add_f32_dpp v189, v188, v188 row_half_mirror row_mask:0xf bank_mask:0xf
    v_cvt_pk_bf16_f32 v189, v189, v189
    v_and_b32 v189, 0xffff0000, v189
    v_mul_f32 v102, s37, v189
    v_cvt_pk_bf16_f32 v102, v102, v102
    v_and_b32 v102, 0xffff0000, v102
    s_waitcnt vmcnt(12)
    v_mov_b32 v188, 0
    v_mov_b32 v189, 0
    v_mov_b32 v190, 0
    v_dot2c_f32_bf16 v188, v140, v4
    v_dot2c_f32_bf16 v189, v144, v8
    v_dot2c_f32_bf16 v190, v148, v12
    v_dot2c_f32_bf16 v188, v141, v5
    v_dot2c_f32_bf16 v189, v145, v9
    v_dot2c_f32_bf16 v190, v149, v13
    v_dot2c_f32_bf16 v188, v142, v6
    v_dot2c_f32_bf16 v189, v146, v10
    v_dot2c_f32_bf16 v190, v150, v14
    v_dot2c_f32_bf16 v188, v143, v7
    v_dot2c_f32_bf16 v189, v147, v11
    v_dot2c_f32_bf16 v190, v151, v15
    buffer_load_dwordx4 v[140:143], v2, s[16:19], s24 offen offset:0 nt
    buffer_load_dwordx4 v[144:147], v2, s[16:19], s24 offen offset:128 nt
    buffer_load_dwordx4 v[148:151], v2, s[16:19], s24 offen offset:256 nt
    s_add_u32 s24, s24, 3072
    v_add_f32 v188, v188, v189
    v_add_f32 v188, v188, v190
    s_nop 1
    v_add_f32_dpp v189, v188, v188 quad_perm:[1,0,3,2] row_mask:0xf bank_mask:0xf
    s_nop 1
    v_add_f32_dpp v188, v189, v189 quad_perm:[2,3,0,1] row_mask:0xf bank_mask:0xf
    s_nop 1
    v_add_f32_dpp v189, v188, v188 row_half_mirror row_mask:0xf bank_mask:0xf
    v_cvt_pk_bf16_f32 v189, v189, v189
    v_and_b32 v189, 0xffff0000, v189
    v_mul_f32 v103, s37, v189
    v_cvt_pk_bf16_f32 v103, v103, v103
    v_and_b32 v103, 0xffff0000, v103
    s_waitcnt vmcnt(12)
    v_mov_b32 v188, 0
    v_mov_b32 v189, 0
    v_mov_b32 v190, 0
    v_dot2c_f32_bf16 v188, v152, v4
    v_dot2c_f32_bf16 v189, v156, v8
    v_dot2c_f32_bf16 v190, v160, v12
    v_dot2c_f32_bf16 v188, v153, v5
    v_dot2c_f32_bf16 v189, v157, v9
    v_dot2c_f32_bf16 v190, v161, v13
    v_dot2c_f32_bf16 v188, v154, v6
    v_dot2c_f32_bf16 v189, v158, v10
    v_dot2c_f32_bf16 v190, v162, v14
    v_dot2c_f32_bf16 v188, v155, v7
    v_dot2c_f32_bf16 v189, v159, v11
    v_dot2c_f32_bf16 v190, v163, v15
    buffer_load_dwordx4 v[152:155], v2, s[16:19], s24 offen offset:0 nt
    buffer_load_dwordx4 v[156:159], v2, s[16:19], s24 offen offset:128 nt
    buffer_load_dwordx4 v[160:163], v2, s[16:19], s24 offen offset:256 nt
    s_add_u32 s24, s24, 3072
    v_add_f32 v188, v188, v189
    v_add_f32 v188, v188, v190
    s_nop 1
    v_add_f32_dpp v189, v188, v188 quad_perm:[1,0,3,2] row_mask:0xf bank_mask:0xf
    s_nop 1
    v_add_f32_dpp v188, v189, v189 quad_perm:[2,3,0,1] row_mask:0xf bank_mask:0xf
    s_nop 1
    v_add_f32_dpp v189, v188, v188 row_half_mirror row_mask:0xf bank_mask:0xf
    v_cvt_pk_bf16_f32 v189, v189, v189
    v_and_b32 v189, 0xffff0000, v189
    v_mul_f32 v104, s37, v189
    v_cvt_pk_bf16_f32 v104, v104, v104
    v_and_b32 v104, 0xffff0000, v104
    s_waitcnt vmcnt(12)
    v_mov_b32 v188, 0
    v_mov_b32 v189, 0
    v_mov_b32 v190, 0
    v_dot2c_f32_bf16 v188, v164, v4
    v_dot2c_f32_bf16 v189, v168, v8
    v_dot2c_f32_bf16 v190, v172, v12
    v_dot2c_f32_bf16 v188, v165, v5
    v_dot2c_f32_bf16 v189, v169, v9
    v_dot2c_f32_bf16 v190, v173, v13
    v_dot2c_f32_bf16 v188, v166, v6
    v_dot2c_f32_bf16 v189, v170, v10
    v_dot2c_f32_bf16 v190, v174, v14
    v_dot2c_f32_bf16 v188, v167, v7
    v_dot2c_f32_bf16 v189, v171, v11
    v_dot2c_f32_bf16 v190, v175, v15
    buffer_load_dwordx4 v[164:167], v2, s[16:19], s24 offen offset:0 nt
    buffer_load_dwordx4 v[168:171], v2, s[16:19], s24 offen offset:128 nt
    buffer_load_dwordx4 v[172:175], v2, s[16:19], s24 offen offset:256 nt
    s_add_u32 s24, s24, 3072
    v_add_f32 v188, v188, v189
    v_add_f32 v188, v188, v190
    s_nop 1
    v_add_f32_dpp v189, v188, v188 quad_perm:[1,0,3,2] row_mask:0xf bank_mask:0xf
    s_nop 1
    v_add_f32_dpp v188, v189, v189 quad_perm:[2,3,0,1] row_mask:0xf bank_mask:0xf
    s_nop 1
    v_add_f32_dpp v189, v188, v188 row_half_mirror row_mask:0xf bank_mask:0xf
    v_cvt_pk_bf16_f32 v189, v189, v189
    v_and_b32 v189, 0xffff0000, v189
    v_mul_f32 v105, s37, v189
    v_cvt_pk_bf16_f32 v105, v105, v105
    v_and_b32 v105, 0xffff0000, v105
    s_waitcnt vmcnt(12)
    v_mov_b32 v188, 0
    v_mov_b32 v189, 0
    v_mov_b32 v190, 0
    v_dot2c_f32_bf16 v188, v176, v4
    v_dot2c_f32_bf16 v189, v180, v8
    v_dot2c_f32_bf16 v190, v184, v12
    v_dot2c_f32_bf16 v188, v177, v5
    v_dot2c_f32_bf16 v189, v181, v9
    v_dot2c_f32_bf16 v190, v185, v13
    v_dot2c_f32_bf16 v188, v178, v6
    v_dot2c_f32_bf16 v189, v182, v10
    v_dot2c_f32_bf16 v190, v186, v14
    v_dot2c_f32_bf16 v188, v179, v7
    v_dot2c_f32_bf16 v189, v183, v11
    v_dot2c_f32_bf16 v190, v187, v15
    buffer_load_dwordx4 v[176:179], v2, s[16:19], s24 offen offset:0 nt
    buffer_load_dwordx4 v[180:183], v2, s[16:19], s24 offen offset:128 nt
    buffer_load_dwordx4 v[184:187], v2, s[16:19], s24 offen offset:256 nt
    s_add_u32 s24, s24, 3072
    v_add_f32 v188, v188, v189
    v_add_f32 v188, v188, v190
    s_nop 1
    v_add_f32_dpp v189, v188, v188 quad_perm:[1,0,3,2] row_mask:0xf bank_mask:0xf
    s_nop 1
    v_add_f32_dpp v188, v189, v189 quad_perm:[2,3,0,1] row_mask:0xf bank_mask:0xf
    s_nop 1
    v_add_f32_dpp v189, v188, v188 row_half_mirror row_mask:0xf bank_mask:0xf
    v_cvt_pk_bf16_f32 v189, v189, v189
    v_and_b32 v189, 0xffff0000, v189
    v_mul_f32 v106, s37, v189
    v_cvt_pk_bf16_f32 v106, v106, v106
    v_and_b32 v106, 0xffff0000, v106
    s_waitcnt vmcnt(12)
    v_mov_b32 v188, 0
    v_mov_b32 v189, 0
    v_mov_b32 v190, 0
    v_dot2c_f32_bf16 v188, v128, v4
    v_dot2c_f32_bf16 v189, v132, v8
    v_dot2c_f32_bf16 v190, v136, v12
    v_dot2c_f32_bf16 v188, v129, v5
    v_dot2c_f32_bf16 v189, v133, v9
    v_dot2c_f32_bf16 v190, v137, v13
    v_dot2c_f32_bf16 v188, v130, v6
    v_dot2c_f32_bf16 v189, v134, v10
    v_dot2c_f32_bf16 v190, v138, v14
    v_dot2c_f32_bf16 v188, v131, v7
    v_dot2c_f32_bf16 v189, v135, v11
    v_dot2c_f32_bf16 v190, v139, v15
    buffer_load_dwordx4 v[128:131], v2, s[16:19], s24 offen offset:0 nt
    buffer_load_dwordx4 v[132:135], v2, s[16:19], s24 offen offset:128 nt
    buffer_load_dwordx4 v[136:139], v2, s[16:19], s24 offen offset:256 nt
    s_add_u32 s24, s24, 3072
    v_add_f32 v188, v188, v189
    v_add_f32 v188, v188, v190
    s_nop 1
    v_add_f32_dpp v189, v188, v188 quad_perm:[1,0,3,2] row_mask:0xf bank_mask:0xf
    s_nop 1
    v_add_f32_dpp v188, v189, v189 quad_perm:[2,3,0,1] row_mask:0xf bank_mask:0xf
    s_nop 1
    v_add_f32_dpp v189, v188, v188 row_half_mirror row_mask:0xf bank_mask:0xf
    v_cvt_pk_bf16_f32 v189, v189, v189
    v_and_b32 v189, 0xffff0000, v189
    v_mul_f32 v107, s37, v189
    v_cvt_pk_bf16_f32 v107, v107, v107
    v_and_b32 v107, 0xffff0000, v107
    s_waitcnt vmcnt(12)
    v_mov_b32 v188, 0
    v_mov_b32 v189, 0
    v_mov_b32 v190, 0
    v_dot2c_f32_bf16 v188, v140, v4
    v_dot2c_f32_bf16 v189, v144, v8
    v_dot2c_f32_bf16 v190, v148, v12
    v_dot2c_f32_bf16 v188, v141, v5
    v_dot2c_f32_bf16 v189, v145, v9
    v_dot2c_f32_bf16 v190, v149, v13
    v_dot2c_f32_bf16 v188, v142, v6
    v_dot2c_f32_bf16 v189, v146, v10
    v_dot2c_f32_bf16 v190, v150, v14
    v_dot2c_f32_bf16 v188, v143, v7
    v_dot2c_f32_bf16 v189, v147, v11
    v_dot2c_f32_bf16 v190, v151, v15
    buffer_load_dwordx4 v[140:143], v2, s[16:19], s24 offen offset:0 nt
    buffer_load_dwordx4 v[144:147], v2, s[16:19], s24 offen offset:128 nt
    buffer_load_dwordx4 v[148:151], v2, s[16:19], s24 offen offset:256 nt
    s_add_u32 s24, s24, 3072
    v_add_f32 v188, v188, v189
    v_add_f32 v188, v188, v190
    s_nop 1
    v_add_f32_dpp v189, v188, v188 quad_perm:[1,0,3,2] row_mask:0xf bank_mask:0xf
    s_nop 1
    v_add_f32_dpp v188, v189, v189 quad_perm:[2,3,0,1] row_mask:0xf bank_mask:0xf
    s_nop 1
    v_add_f32_dpp v189, v188, v188 row_half_mirror row_mask:0xf bank_mask:0xf
    v_cvt_pk_bf16_f32 v189, v189, v189
    v_and_b32 v189, 0xffff0000, v189
    v_mul_f32 v108, s37, v189
    v_cvt_pk_bf16_f32 v108, v108, v108
    v_and_b32 v108, 0xffff0000, v108
    s_waitcnt vmcnt(12)
    v_mov_b32 v188, 0
    v_mov_b32 v189, 0
    v_mov_b32 v190, 0
    v_dot2c_f32_bf16 v188, v152, v4
    v_dot2c_f32_bf16 v189, v156, v8
    v_dot2c_f32_bf16 v190, v160, v12
    v_dot2c_f32_bf16 v188, v153, v5
    v_dot2c_f32_bf16 v189, v157, v9
    v_dot2c_f32_bf16 v190, v161, v13
    v_dot2c_f32_bf16 v188, v154, v6
    v_dot2c_f32_bf16 v189, v158, v10
    v_dot2c_f32_bf16 v190, v162, v14
    v_dot2c_f32_bf16 v188, v155, v7
    v_dot2c_f32_bf16 v189, v159, v11
    v_dot2c_f32_bf16 v190, v163, v15
    buffer_load_dwordx4 v[152:155], v2, s[16:19], s24 offen offset:0 nt
    buffer_load_dwordx4 v[156:159], v2, s[16:19], s24 offen offset:128 nt
    buffer_load_dwordx4 v[160:163], v2, s[16:19], s24 offen offset:256 nt
    s_add_u32 s24, s24, 3072
    v_add_f32 v188, v188, v189
    v_add_f32 v188, v188, v190
    s_nop 1
    v_add_f32_dpp v189, v188, v188 quad_perm:[1,0,3,2] row_mask:0xf bank_mask:0xf
    s_nop 1
    v_add_f32_dpp v188, v189, v189 quad_perm:[2,3,0,1] row_mask:0xf bank_mask:0xf
    s_nop 1
    v_add_f32_dpp v189, v188, v188 row_half_mirror row_mask:0xf bank_mask:0xf
    v_cvt_pk_bf16_f32 v189, v189, v189
    v_and_b32 v189, 0xffff0000, v189
    v_mul_f32 v109, s37, v189
    v_cvt_pk_bf16_f32 v109, v109, v109
    v_and_b32 v109, 0xffff0000, v109
    s_waitcnt vmcnt(12)
    v_mov_b32 v188, 0
    v_mov_b32 v189, 0
    v_mov_b32 v190, 0
    v_dot2c_f32_bf16 v188, v164, v4
    v_dot2c_f32_bf16 v189, v168, v8
    v_dot2c_f32_bf16 v190, v172, v12
    v_dot2c_f32_bf16 v188, v165, v5
    v_dot2c_f32_bf16 v189, v169, v9
    v_dot2c_f32_bf16 v190, v173, v13
    v_dot2c_f32_bf16 v188, v166, v6
    v_dot2c_f32_bf16 v189, v170, v10
    v_dot2c_f32_bf16 v190, v174, v14
    v_dot2c_f32_bf16 v188, v167, v7
    v_dot2c_f32_bf16 v189, v171, v11
    v_dot2c_f32_bf16 v190, v175, v15
    buffer_load_dwordx4 v[164:167], v2, s[16:19], s24 offen offset:0 nt
    buffer_load_dwordx4 v[168:171], v2, s[16:19], s24 offen offset:128 nt
    buffer_load_dwordx4 v[172:175], v2, s[16:19], s24 offen offset:256 nt
    s_add_u32 s24, s24, 3072
    v_add_f32 v188, v188, v189
    v_add_f32 v188, v188, v190
    s_nop 1
    v_add_f32_dpp v189, v188, v188 quad_perm:[1,0,3,2] row_mask:0xf bank_mask:0xf
    s_nop 1
    v_add_f32_dpp v188, v189, v189 quad_perm:[2,3,0,1] row_mask:0xf bank_mask:0xf
    s_nop 1
    v_add_f32_dpp v189, v188, v188 row_half_mirror row_mask:0xf bank_mask:0xf
    v_cvt_pk_bf16_f32 v189, v189, v189
    v_and_b32 v189, 0xffff0000, v189
    v_mul_f32 v110, s37, v189
    v_cvt_pk_bf16_f32 v110, v110, v110
    v_and_b32 v110, 0xffff0000, v110
    s_waitcnt vmcnt(12)
    v_mov_b32 v188, 0
    v_mov_b32 v189, 0
    v_mov_b32 v190, 0
    v_dot2c_f32_bf16 v188, v176, v4
    v_dot2c_f32_bf16 v189, v180, v8
    v_dot2c_f32_bf16 v190, v184, v12
    v_dot2c_f32_bf16 v188, v177, v5
    v_dot2c_f32_bf16 v189, v181, v9
    v_dot2c_f32_bf16 v190, v185, v13
    v_dot2c_f32_bf16 v188, v178, v6
    v_dot2c_f32_bf16 v189, v182, v10
    v_dot2c_f32_bf16 v190, v186, v14
    v_dot2c_f32_bf16 v188, v179, v7
    v_dot2c_f32_bf16 v189, v183, v11
    v_dot2c_f32_bf16 v190, v187, v15
    buffer_load_dwordx4 v[176:179], v2, s[16:19], s24 offen offset:0 nt
    buffer_load_dwordx4 v[180:183], v2, s[16:19], s24 offen offset:128 nt
    buffer_load_dwordx4 v[184:187], v2, s[16:19], s24 offen offset:256 nt
    s_add_u32 s24, s24, 3072
    v_add_f32 v188, v188, v189
    v_add_f32 v188, v188, v190
    s_nop 1
    v_add_f32_dpp v189, v188, v188 quad_perm:[1,0,3,2] row_mask:0xf bank_mask:0xf
    s_nop 1
    v_add_f32_dpp v188, v189, v189 quad_perm:[2,3,0,1] row_mask:0xf bank_mask:0xf
    s_nop 1
    v_add_f32_dpp v189, v188, v188 row_half_mirror row_mask:0xf bank_mask:0xf
    v_cvt_pk_bf16_f32 v189, v189, v189
    v_and_b32 v189, 0xffff0000, v189
    v_mul_f32 v111, s37, v189
    v_cvt_pk_bf16_f32 v111, v111, v111
    v_and_b32 v111, 0xffff0000, v111
    s_waitcnt vmcnt(12)
    v_mov_b32 v188, 0
    v_mov_b32 v189, 0
    v_mov_b32 v190, 0
    v_dot2c_f32_bf16 v188, v128, v4
    v_dot2c_f32_bf16 v189, v132, v8
    v_dot2c_f32_bf16 v190, v136, v12
    v_dot2c_f32_bf16 v188, v129, v5
    v_dot2c_f32_bf16 v189, v133, v9
    v_dot2c_f32_bf16 v190, v137, v13
    v_dot2c_f32_bf16 v188, v130, v6
    v_dot2c_f32_bf16 v189, v134, v10
    v_dot2c_f32_bf16 v190, v138, v14
    v_dot2c_f32_bf16 v188, v131, v7
    v_dot2c_f32_bf16 v189, v135, v11
    v_dot2c_f32_bf16 v190, v139, v15
    buffer_load_dwordx4 v[128:131], v2, s[16:19], s24 offen offset:0 nt
    buffer_load_dwordx4 v[132:135], v2, s[16:19], s24 offen offset:128 nt
    buffer_load_dwordx4 v[136:139], v2, s[16:19], s24 offen offset:256 nt
    s_add_u32 s24, s24, 3072
    v_add_f32 v188, v188, v189
    v_add_f32 v188, v188, v190
    s_nop 1
    v_add_f32_dpp v189, v188, v188 quad_perm:[1,0,3,2] row_mask:0xf bank_mask:0xf
    s_nop 1
    v_add_f32_dpp v188, v189, v189 quad_perm:[2,3,0,1] row_mask:0xf bank_mask:0xf
    s_nop 1
    v_add_f32_dpp v189, v188, v188 row_half_mirror row_mask:0xf bank_mask:0xf
    v_cvt_pk_bf16_f32 v189, v189, v189
    v_and_b32 v189, 0xffff0000, v189
    v_mul_f32 v112, s37, v189
    v_cvt_pk_bf16_f32 v112, v112, v112
    v_and_b32 v112, 0xffff0000, v112
    s_waitcnt vmcnt(12)
    v_mov_b32 v188, 0
    v_mov_b32 v189, 0
    v_mov_b32 v190, 0
    v_dot2c_f32_bf16 v188, v140, v4
    v_dot2c_f32_bf16 v189, v144, v8
    v_dot2c_f32_bf16 v190, v148, v12
    v_dot2c_f32_bf16 v188, v141, v5
    v_dot2c_f32_bf16 v189, v145, v9
    v_dot2c_f32_bf16 v190, v149, v13
    v_dot2c_f32_bf16 v188, v142, v6
    v_dot2c_f32_bf16 v189, v146, v10
    v_dot2c_f32_bf16 v190, v150, v14
    v_dot2c_f32_bf16 v188, v143, v7
    v_dot2c_f32_bf16 v189, v147, v11
    v_dot2c_f32_bf16 v190, v151, v15
    buffer_load_dwordx4 v[140:143], v2, s[16:19], s24 offen offset:0 nt
    buffer_load_dwordx4 v[144:147], v2, s[16:19], s24 offen offset:128 nt
    buffer_load_dwordx4 v[148:151], v2, s[16:19], s24 offen offset:256 nt
    s_add_u32 s24, s24, 3072
    v_add_f32 v188, v188, v189
    v_add_f32 v188, v188, v190
    s_nop 1
    v_add_f32_dpp v189, v188, v188 quad_perm:[1,0,3,2] row_mask:0xf bank_mask:0xf
    s_nop 1
    v_add_f32_dpp v188, v189, v189 quad_perm:[2,3,0,1] row_mask:0xf bank_mask:0xf
    s_nop 1
    v_add_f32_dpp v189, v188, v188 row_half_mirror row_mask:0xf bank_mask:0xf
    v_cvt_pk_bf16_f32 v189, v189, v189
    v_and_b32 v189, 0xffff0000, v189
    v_mul_f32 v113, s37, v189
    v_cvt_pk_bf16_f32 v113, v113, v113
    v_and_b32 v113, 0xffff0000, v113
    s_waitcnt vmcnt(12)
    v_mov_b32 v188, 0
    v_mov_b32 v189, 0
    v_mov_b32 v190, 0
    v_dot2c_f32_bf16 v188, v152, v4
    v_dot2c_f32_bf16 v189, v156, v8
    v_dot2c_f32_bf16 v190, v160, v12
    v_dot2c_f32_bf16 v188, v153, v5
    v_dot2c_f32_bf16 v189, v157, v9
    v_dot2c_f32_bf16 v190, v161, v13
    v_dot2c_f32_bf16 v188, v154, v6
    v_dot2c_f32_bf16 v189, v158, v10
    v_dot2c_f32_bf16 v190, v162, v14
    v_dot2c_f32_bf16 v188, v155, v7
    v_dot2c_f32_bf16 v189, v159, v11
    v_dot2c_f32_bf16 v190, v163, v15
    buffer_load_dwordx4 v[152:155], v2, s[16:19], s24 offen offset:0 nt
    buffer_load_dwordx4 v[156:159], v2, s[16:19], s24 offen offset:128 nt
    buffer_load_dwordx4 v[160:163], v2, s[16:19], s24 offen offset:256 nt
    s_add_u32 s24, s24, 3072
    v_add_f32 v188, v188, v189
    v_add_f32 v188, v188, v190
    s_nop 1
    v_add_f32_dpp v189, v188, v188 quad_perm:[1,0,3,2] row_mask:0xf bank_mask:0xf
    s_nop 1
    v_add_f32_dpp v188, v189, v189 quad_perm:[2,3,0,1] row_mask:0xf bank_mask:0xf
    s_nop 1
    v_add_f32_dpp v189, v188, v188 row_half_mirror row_mask:0xf bank_mask:0xf
    v_cvt_pk_bf16_f32 v189, v189, v189
    v_and_b32 v189, 0xffff0000, v189
    v_mul_f32 v114, s37, v189
    v_cvt_pk_bf16_f32 v114, v114, v114
    v_and_b32 v114, 0xffff0000, v114
    s_waitcnt vmcnt(12)
    v_mov_b32 v188, 0
    v_mov_b32 v189, 0
    v_mov_b32 v190, 0
    v_dot2c_f32_bf16 v188, v164, v4
    v_dot2c_f32_bf16 v189, v168, v8
    v_dot2c_f32_bf16 v190, v172, v12
    v_dot2c_f32_bf16 v188, v165, v5
    v_dot2c_f32_bf16 v189, v169, v9
    v_dot2c_f32_bf16 v190, v173, v13
    v_dot2c_f32_bf16 v188, v166, v6
    v_dot2c_f32_bf16 v189, v170, v10
    v_dot2c_f32_bf16 v190, v174, v14
    v_dot2c_f32_bf16 v188, v167, v7
    v_dot2c_f32_bf16 v189, v171, v11
    v_dot2c_f32_bf16 v190, v175, v15
    buffer_load_dwordx4 v[164:167], v2, s[16:19], s24 offen offset:0 nt
    buffer_load_dwordx4 v[168:171], v2, s[16:19], s24 offen offset:128 nt
    buffer_load_dwordx4 v[172:175], v2, s[16:19], s24 offen offset:256 nt
    s_add_u32 s24, s24, 3072
    v_add_f32 v188, v188, v189
    v_add_f32 v188, v188, v190
    s_nop 1
    v_add_f32_dpp v189, v188, v188 quad_perm:[1,0,3,2] row_mask:0xf bank_mask:0xf
    s_nop 1
    v_add_f32_dpp v188, v189, v189 quad_perm:[2,3,0,1] row_mask:0xf bank_mask:0xf
    s_nop 1
    v_add_f32_dpp v189, v188, v188 row_half_mirror row_mask:0xf bank_mask:0xf
    v_cvt_pk_bf16_f32 v189, v189, v189
    v_and_b32 v189, 0xffff0000, v189
    v_mul_f32 v115, s37, v189
    v_cvt_pk_bf16_f32 v115, v115, v115
    v_and_b32 v115, 0xffff0000, v115
    s_waitcnt vmcnt(12)
    v_mov_b32 v188, 0
    v_mov_b32 v189, 0
    v_mov_b32 v190, 0
    v_dot2c_f32_bf16 v188, v176, v4
    v_dot2c_f32_bf16 v189, v180, v8
    v_dot2c_f32_bf16 v190, v184, v12
    v_dot2c_f32_bf16 v188, v177, v5
    v_dot2c_f32_bf16 v189, v181, v9
    v_dot2c_f32_bf16 v190, v185, v13
    v_dot2c_f32_bf16 v188, v178, v6
    v_dot2c_f32_bf16 v189, v182, v10
    v_dot2c_f32_bf16 v190, v186, v14
    v_dot2c_f32_bf16 v188, v179, v7
    v_dot2c_f32_bf16 v189, v183, v11
    v_dot2c_f32_bf16 v190, v187, v15
    buffer_load_dwordx4 v[176:179], v2, s[16:19], s24 offen offset:0 nt
    buffer_load_dwordx4 v[180:183], v2, s[16:19], s24 offen offset:128 nt
    buffer_load_dwordx4 v[184:187], v2, s[16:19], s24 offen offset:256 nt
    s_add_u32 s24, s24, 3072
    v_add_f32 v188, v188, v189
    v_add_f32 v188, v188, v190
    s_nop 1
    v_add_f32_dpp v189, v188, v188 quad_perm:[1,0,3,2] row_mask:0xf bank_mask:0xf
    s_nop 1
    v_add_f32_dpp v188, v189, v189 quad_perm:[2,3,0,1] row_mask:0xf bank_mask:0xf
    s_nop 1
    v_add_f32_dpp v189, v188, v188 row_half_mirror row_mask:0xf bank_mask:0xf
    v_cvt_pk_bf16_f32 v189, v189, v189
    v_and_b32 v189, 0xffff0000, v189
    v_mul_f32 v116, s37, v189
    v_cvt_pk_bf16_f32 v116, v116, v116
    v_and_b32 v116, 0xffff0000, v116
    global_load_dwordx2 v[192:193], v195, s[88:89] offset:32 sc1
    s_waitcnt vmcnt(13)
    v_mov_b32 v188, 0
    v_mov_b32 v189, 0
    v_mov_b32 v190, 0
    v_dot2c_f32_bf16 v188, v128, v4
    v_dot2c_f32_bf16 v189, v132, v8
    v_dot2c_f32_bf16 v190, v136, v12
    v_dot2c_f32_bf16 v188, v129, v5
    v_dot2c_f32_bf16 v189, v133, v9
    v_dot2c_f32_bf16 v190, v137, v13
    v_dot2c_f32_bf16 v188, v130, v6
    v_dot2c_f32_bf16 v189, v134, v10
    v_dot2c_f32_bf16 v190, v138, v14
    v_dot2c_f32_bf16 v188, v131, v7
    v_dot2c_f32_bf16 v189, v135, v11
    v_dot2c_f32_bf16 v190, v139, v15
    buffer_load_dwordx4 v[128:131], v2, s[16:19], s24 offen offset:0 nt
    buffer_load_dwordx4 v[132:135], v2, s[16:19], s24 offen offset:128 nt
    buffer_load_dwordx4 v[136:139], v2, s[16:19], s24 offen offset:256 nt
    s_add_u32 s24, s24, 3072
    v_add_f32 v188, v188, v189
    v_add_f32 v188, v188, v190
    s_nop 1
    v_add_f32_dpp v189, v188, v188 quad_perm:[1,0,3,2] row_mask:0xf bank_mask:0xf
    s_nop 1
    v_add_f32_dpp v188, v189, v189 quad_perm:[2,3,0,1] row_mask:0xf bank_mask:0xf
    s_nop 1
    v_add_f32_dpp v189, v188, v188 row_half_mirror row_mask:0xf bank_mask:0xf
    v_cvt_pk_bf16_f32 v189, v189, v189
    v_and_b32 v189, 0xffff0000, v189
    v_mul_f32 v117, s37, v189
    v_cvt_pk_bf16_f32 v117, v117, v117
    v_and_b32 v117, 0xffff0000, v117
    s_waitcnt vmcnt(13)
    v_mov_b32 v188, 0
    v_mov_b32 v189, 0
    v_mov_b32 v190, 0
    v_dot2c_f32_bf16 v188, v140, v4
    v_dot2c_f32_bf16 v189, v144, v8
    v_dot2c_f32_bf16 v190, v148, v12
    v_dot2c_f32_bf16 v188, v141, v5
    v_dot2c_f32_bf16 v189, v145, v9
    v_dot2c_f32_bf16 v190, v149, v13
    v_dot2c_f32_bf16 v188, v142, v6
    v_dot2c_f32_bf16 v189, v146, v10
    v_dot2c_f32_bf16 v190, v150, v14
    v_dot2c_f32_bf16 v188, v143, v7
    v_dot2c_f32_bf16 v189, v147, v11
    v_dot2c_f32_bf16 v190, v151, v15
    buffer_load_dwordx4 v[140:143], v2, s[16:19], s24 offen offset:0 nt
    buffer_load_dwordx4 v[144:147], v2, s[16:19], s24 offen offset:128 nt
    buffer_load_dwordx4 v[148:151], v2, s[16:19], s24 offen offset:256 nt
    s_add_u32 s24, s24, 3072
    v_add_f32 v188, v188, v189
    v_add_f32 v188, v188, v190
    s_nop 1
    v_add_f32_dpp v189, v188, v188 quad_perm:[1,0,3,2] row_mask:0xf bank_mask:0xf
    s_nop 1
    v_add_f32_dpp v188, v189, v189 quad_perm:[2,3,0,1] row_mask:0xf bank_mask:0xf
    s_nop 1
    v_add_f32_dpp v189, v188, v188 row_half_mirror row_mask:0xf bank_mask:0xf
    v_cvt_pk_bf16_f32 v189, v189, v189
    v_and_b32 v189, 0xffff0000, v189
    v_mul_f32 v118, s37, v189
    v_cvt_pk_bf16_f32 v118, v118, v118
    v_and_b32 v118, 0xffff0000, v118
    s_waitcnt vmcnt(13)
    v_mov_b32 v188, 0
    v_mov_b32 v189, 0
    v_mov_b32 v190, 0
    v_dot2c_f32_bf16 v188, v152, v4
    v_dot2c_f32_bf16 v189, v156, v8
    v_dot2c_f32_bf16 v190, v160, v12
    v_dot2c_f32_bf16 v188, v153, v5
    v_dot2c_f32_bf16 v189, v157, v9
    v_dot2c_f32_bf16 v190, v161, v13
    v_dot2c_f32_bf16 v188, v154, v6
    v_dot2c_f32_bf16 v189, v158, v10
    v_dot2c_f32_bf16 v190, v162, v14
    v_dot2c_f32_bf16 v188, v155, v7
    v_dot2c_f32_bf16 v189, v159, v11
    v_dot2c_f32_bf16 v190, v163, v15
    buffer_load_dwordx4 v[152:155], v2, s[16:19], s24 offen offset:0 nt
    buffer_load_dwordx4 v[156:159], v2, s[16:19], s24 offen offset:128 nt
    buffer_load_dwordx4 v[160:163], v2, s[16:19], s24 offen offset:256 nt
    s_add_u32 s24, s24, 3072
    v_add_f32 v188, v188, v189
    v_add_f32 v188, v188, v190
    s_nop 1
    v_add_f32_dpp v189, v188, v188 quad_perm:[1,0,3,2] row_mask:0xf bank_mask:0xf
    s_nop 1
    v_add_f32_dpp v188, v189, v189 quad_perm:[2,3,0,1] row_mask:0xf bank_mask:0xf
    s_nop 1
    v_add_f32_dpp v189, v188, v188 row_half_mirror row_mask:0xf bank_mask:0xf
    v_cvt_pk_bf16_f32 v189, v189, v189
    v_and_b32 v189, 0xffff0000, v189
    v_mul_f32 v119, s37, v189
    v_cvt_pk_bf16_f32 v119, v119, v119
    v_and_b32 v119, 0xffff0000, v119
    s_waitcnt vmcnt(13)
    v_mov_b32 v188, 0
    v_mov_b32 v189, 0
    v_mov_b32 v190, 0
    v_dot2c_f32_bf16 v188, v164, v4
    v_dot2c_f32_bf16 v189, v168, v8
    v_dot2c_f32_bf16 v190, v172, v12
    v_dot2c_f32_bf16 v188, v165, v5
    v_dot2c_f32_bf16 v189, v169, v9
    v_dot2c_f32_bf16 v190, v173, v13
    v_dot2c_f32_bf16 v188, v166, v6
    v_dot2c_f32_bf16 v189, v170, v10
    v_dot2c_f32_bf16 v190, v174, v14
    v_dot2c_f32_bf16 v188, v167, v7
    v_dot2c_f32_bf16 v189, v171, v11
    v_dot2c_f32_bf16 v190, v175, v15
    buffer_load_dwordx4 v[164:167], v2, s[16:19], s24 offen offset:0 nt
    buffer_load_dwordx4 v[168:171], v2, s[16:19], s24 offen offset:128 nt
    buffer_load_dwordx4 v[172:175], v2, s[16:19], s24 offen offset:256 nt
    s_add_u32 s24, s24, 3072
    v_add_f32 v188, v188, v189
    v_add_f32 v188, v188, v190
    s_nop 1
    v_add_f32_dpp v189, v188, v188 quad_perm:[1,0,3,2] row_mask:0xf bank_mask:0xf
    s_nop 1
    v_add_f32_dpp v188, v189, v189 quad_perm:[2,3,0,1] row_mask:0xf bank_mask:0xf
    s_nop 1
    v_add_f32_dpp v189, v188, v188 row_half_mirror row_mask:0xf bank_mask:0xf
    v_cvt_pk_bf16_f32 v189, v189, v189
    v_and_b32 v189, 0xffff0000, v189
    v_mul_f32 v120, s37, v189
    v_cvt_pk_bf16_f32 v120, v120, v120
    v_and_b32 v120, 0xffff0000, v120
    s_waitcnt vmcnt(13)
    v_mov_b32 v188, 0
    v_mov_b32 v189, 0
    v_mov_b32 v190, 0
    v_dot2c_f32_bf16 v188, v176, v4
    v_dot2c_f32_bf16 v189, v180, v8
    v_dot2c_f32_bf16 v190, v184, v12
    v_dot2c_f32_bf16 v188, v177, v5
    v_dot2c_f32_bf16 v189, v181, v9
    v_dot2c_f32_bf16 v190, v185, v13
    v_dot2c_f32_bf16 v188, v178, v6
    v_dot2c_f32_bf16 v189, v182, v10
    v_dot2c_f32_bf16 v190, v186, v14
    v_dot2c_f32_bf16 v188, v179, v7
    v_dot2c_f32_bf16 v189, v183, v11
    v_dot2c_f32_bf16 v190, v187, v15
    buffer_load_dwordx4 v[176:179], v2, s[16:19], s24 offen offset:0 nt
    buffer_load_dwordx4 v[180:183], v2, s[16:19], s24 offen offset:128 nt
    buffer_load_dwordx4 v[184:187], v2, s[16:19], s24 offen offset:256 nt
    s_add_u32 s24, s24, 3072
    v_add_f32 v188, v188, v189
    v_add_f32 v188, v188, v190
    s_nop 1
    v_add_f32_dpp v189, v188, v188 quad_perm:[1,0,3,2] row_mask:0xf bank_mask:0xf
    s_nop 1
    v_add_f32_dpp v188, v189, v189 quad_perm:[2,3,0,1] row_mask:0xf bank_mask:0xf
    s_nop 1
    v_add_f32_dpp v189, v188, v188 row_half_mirror row_mask:0xf bank_mask:0xf
    v_cvt_pk_bf16_f32 v189, v189, v189
    v_and_b32 v189, 0xffff0000, v189
    v_mul_f32 v121, s37, v189
    v_cvt_pk_bf16_f32 v121, v121, v121
    v_and_b32 v121, 0xffff0000, v121
    s_waitcnt vmcnt(12)
    v_mov_b32 v188, 0
    v_mov_b32 v189, 0
    v_mov_b32 v190, 0
    v_dot2c_f32_bf16 v188, v128, v4
    v_dot2c_f32_bf16 v189, v132, v8
    v_dot2c_f32_bf16 v190, v136, v12
    v_dot2c_f32_bf16 v188, v129, v5
    v_dot2c_f32_bf16 v189, v133, v9
    v_dot2c_f32_bf16 v190, v137, v13
    v_dot2c_f32_bf16 v188, v130, v6
    v_dot2c_f32_bf16 v189, v134, v10
    v_dot2c_f32_bf16 v190, v138, v14
    v_dot2c_f32_bf16 v188, v131, v7
    v_dot2c_f32_bf16 v189, v135, v11
    v_dot2c_f32_bf16 v190, v139, v15
    buffer_load_dwordx4 v[128:131], v2, s[16:19], s24 offen offset:0 nt
    buffer_load_dwordx4 v[132:135], v2, s[16:19], s24 offen offset:128 nt
    buffer_load_dwordx4 v[136:139], v2, s[16:19], s24 offen offset:256 nt
    s_mov_b32 s24, 100663296
    v_add_f32 v188, v188, v189
    v_add_f32 v188, v188, v190
    s_nop 1
    v_add_f32_dpp v189, v188, v188 quad_perm:[1,0,3,2] row_mask:0xf bank_mask:0xf
    s_nop 1
    v_add_f32_dpp v188, v189, v189 quad_perm:[2,3,0,1] row_mask:0xf bank_mask:0xf
    s_nop 1
    v_add_f32_dpp v189, v188, v188 row_half_mirror row_mask:0xf bank_mask:0xf
    v_cvt_pk_bf16_f32 v189, v189, v189
    v_and_b32 v189, 0xffff0000, v189
    v_mul_f32 v122, s37, v189
    v_cvt_pk_bf16_f32 v122, v122, v122
    v_and_b32 v122, 0xffff0000, v122
    s_waitcnt vmcnt(12)
    v_mov_b32 v188, 0
    v_mov_b32 v189, 0
    v_mov_b32 v190, 0
    v_dot2c_f32_bf16 v188, v140, v4
    v_dot2c_f32_bf16 v189, v144, v8
    v_dot2c_f32_bf16 v190, v148, v12
    v_dot2c_f32_bf16 v188, v141, v5
    v_dot2c_f32_bf16 v189, v145, v9
    v_dot2c_f32_bf16 v190, v149, v13
    v_dot2c_f32_bf16 v188, v142, v6
    v_dot2c_f32_bf16 v189, v146, v10
    v_dot2c_f32_bf16 v190, v150, v14
    v_dot2c_f32_bf16 v188, v143, v7
    v_dot2c_f32_bf16 v189, v147, v11
    v_dot2c_f32_bf16 v190, v151, v15
    buffer_load_dwordx4 v[140:143], v2, s[20:23], s25 offen offset:0 nt
    buffer_load_dwordx4 v[144:147], v2, s[20:23], s25 offen offset:128 nt
    buffer_load_dwordx4 v[148:151], v2, s[20:23], s25 offen offset:256 nt
    s_add_u32 s25, s25, 3072
    v_add_f32 v188, v188, v189
    v_add_f32 v188, v188, v190
    s_nop 1
    v_add_f32_dpp v189, v188, v188 quad_perm:[1,0,3,2] row_mask:0xf bank_mask:0xf
    s_nop 1
    v_add_f32_dpp v188, v189, v189 quad_perm:[2,3,0,1] row_mask:0xf bank_mask:0xf
    s_nop 1
    v_add_f32_dpp v189, v188, v188 row_half_mirror row_mask:0xf bank_mask:0xf
    v_cvt_pk_bf16_f32 v189, v189, v189
    v_and_b32 v189, 0xffff0000, v189
    v_mul_f32 v123, s37, v189
    v_cvt_pk_bf16_f32 v123, v123, v123
    v_and_b32 v123, 0xffff0000, v123
    s_waitcnt vmcnt(12)
    v_mov_b32 v188, 0
    v_mov_b32 v189, 0
    v_mov_b32 v190, 0
    v_dot2c_f32_bf16 v188, v152, v4
    v_dot2c_f32_bf16 v189, v156, v8
    v_dot2c_f32_bf16 v190, v160, v12
    v_dot2c_f32_bf16 v188, v153, v5
    v_dot2c_f32_bf16 v189, v157, v9
    v_dot2c_f32_bf16 v190, v161, v13
    v_dot2c_f32_bf16 v188, v154, v6
    v_dot2c_f32_bf16 v189, v158, v10
    v_dot2c_f32_bf16 v190, v162, v14
    v_dot2c_f32_bf16 v188, v155, v7
    v_dot2c_f32_bf16 v189, v159, v11
    v_dot2c_f32_bf16 v190, v163, v15
    buffer_load_dwordx4 v[152:155], v2, s[20:23], s25 offen offset:0 nt
    buffer_load_dwordx4 v[156:159], v2, s[20:23], s25 offen offset:128 nt
    buffer_load_dwordx4 v[160:163], v2, s[20:23], s25 offen offset:256 nt
    s_add_u32 s25, s25, 3072
    v_add_f32 v188, v188, v189
    v_add_f32 v188, v188, v190
    s_nop 1
    v_add_f32_dpp v189, v188, v188 quad_perm:[1,0,3,2] row_mask:0xf bank_mask:0xf
    s_nop 1
    v_add_f32_dpp v188, v189, v189 quad_perm:[2,3,0,1] row_mask:0xf bank_mask:0xf
    s_nop 1
    v_add_f32_dpp v189, v188, v188 row_half_mirror row_mask:0xf bank_mask:0xf
    v_cvt_pk_bf16_f32 v189, v189, v189
    v_and_b32 v189, 0xffff0000, v189
    v_mul_f32 v124, s37, v189
    v_cvt_pk_bf16_f32 v124, v124, v124
    v_and_b32 v124, 0xffff0000, v124
    s_waitcnt vmcnt(12)
    v_mov_b32 v188, 0
    v_mov_b32 v189, 0
    v_mov_b32 v190, 0
    v_dot2c_f32_bf16 v188, v164, v4
    v_dot2c_f32_bf16 v189, v168, v8
    v_dot2c_f32_bf16 v190, v172, v12
    v_dot2c_f32_bf16 v188, v165, v5
    v_dot2c_f32_bf16 v189, v169, v9
    v_dot2c_f32_bf16 v190, v173, v13
    v_dot2c_f32_bf16 v188, v166, v6
    v_dot2c_f32_bf16 v189, v170, v10
    v_dot2c_f32_bf16 v190, v174, v14
    v_dot2c_f32_bf16 v188, v167, v7
    v_dot2c_f32_bf16 v189, v171, v11
    v_dot2c_f32_bf16 v190, v175, v15
    buffer_load_dwordx4 v[164:167], v2, s[20:23], s25 offen offset:0 nt
    buffer_load_dwordx4 v[168:171], v2, s[20:23], s25 offen offset:128 nt
    buffer_load_dwordx4 v[172:175], v2, s[20:23], s25 offen offset:256 nt
    s_add_u32 s25, s25, 3072
    v_add_f32 v188, v188, v189
    v_add_f32 v188, v188, v190
    s_nop 1
    v_add_f32_dpp v189, v188, v188 quad_perm:[1,0,3,2] row_mask:0xf bank_mask:0xf
    s_nop 1
    v_add_f32_dpp v188, v189, v189 quad_perm:[2,3,0,1] row_mask:0xf bank_mask:0xf
    s_nop 1
    v_add_f32_dpp v189, v188, v188 row_half_mirror row_mask:0xf bank_mask:0xf
    v_cvt_pk_bf16_f32 v189, v189, v189
    v_and_b32 v189, 0xffff0000, v189
    v_mul_f32 v125, s37, v189
    v_cvt_pk_bf16_f32 v125, v125, v125
    v_and_b32 v125, 0xffff0000, v125
    s_waitcnt vmcnt(12)
    v_mov_b32 v188, 0
    v_mov_b32 v189, 0
    v_mov_b32 v190, 0
    v_dot2c_f32_bf16 v188, v176, v4
    v_dot2c_f32_bf16 v189, v180, v8
    v_dot2c_f32_bf16 v190, v184, v12
    v_dot2c_f32_bf16 v188, v177, v5
    v_dot2c_f32_bf16 v189, v181, v9
    v_dot2c_f32_bf16 v190, v185, v13
    v_dot2c_f32_bf16 v188, v178, v6
    v_dot2c_f32_bf16 v189, v182, v10
    v_dot2c_f32_bf16 v190, v186, v14
    v_dot2c_f32_bf16 v188, v179, v7
    v_dot2c_f32_bf16 v189, v183, v11
    v_dot2c_f32_bf16 v190, v187, v15
    buffer_load_dwordx4 v[176:179], v2, s[20:23], s25 offen offset:0 nt
    buffer_load_dwordx4 v[180:183], v2, s[20:23], s25 offen offset:128 nt
    buffer_load_dwordx4 v[184:187], v2, s[20:23], s25 offen offset:256 nt
    s_add_u32 s25, s25, 3072
    v_add_f32 v188, v188, v189
    v_add_f32 v188, v188, v190
    s_nop 1
    v_add_f32_dpp v189, v188, v188 quad_perm:[1,0,3,2] row_mask:0xf bank_mask:0xf
    s_nop 1
    v_add_f32_dpp v188, v189, v189 quad_perm:[2,3,0,1] row_mask:0xf bank_mask:0xf
    s_nop 1
    v_add_f32_dpp v189, v188, v188 row_half_mirror row_mask:0xf bank_mask:0xf
    v_cvt_pk_bf16_f32 v189, v189, v189
    v_and_b32 v189, 0xffff0000, v189
    v_mul_f32 v126, s37, v189
    v_cvt_pk_bf16_f32 v126, v126, v126
    v_and_b32 v126, 0xffff0000, v126
    s_waitcnt vmcnt(12)
    v_mov_b32 v188, 0
    v_mov_b32 v189, 0
    v_mov_b32 v190, 0
    v_dot2c_f32_bf16 v188, v128, v4
    v_dot2c_f32_bf16 v189, v132, v8
    v_dot2c_f32_bf16 v190, v136, v12
    v_dot2c_f32_bf16 v188, v129, v5
    v_dot2c_f32_bf16 v189, v133, v9
    v_dot2c_f32_bf16 v190, v137, v13
    v_dot2c_f32_bf16 v188, v130, v6
    v_dot2c_f32_bf16 v189, v134, v10
    v_dot2c_f32_bf16 v190, v138, v14
    v_dot2c_f32_bf16 v188, v131, v7
    v_dot2c_f32_bf16 v189, v135, v11
    v_dot2c_f32_bf16 v190, v139, v15
    buffer_load_dwordx4 v[128:131], v2, s[20:23], s25 offen offset:0 nt
    buffer_load_dwordx4 v[132:135], v2, s[20:23], s25 offen offset:128 nt
    buffer_load_dwordx4 v[136:139], v2, s[20:23], s25 offen offset:256 nt
    s_add_u32 s25, s25, 3072
    v_add_f32 v188, v188, v189
    v_add_f32 v188, v188, v190
    s_nop 1
    v_add_f32_dpp v189, v188, v188 quad_perm:[1,0,3,2] row_mask:0xf bank_mask:0xf
    s_nop 1
    v_add_f32_dpp v188, v189, v189 quad_perm:[2,3,0,1] row_mask:0xf bank_mask:0xf
    s_nop 1
    v_add_f32_dpp v189, v188, v188 row_half_mirror row_mask:0xf bank_mask:0xf
    v_cvt_pk_bf16_f32 v189, v189, v189
    v_and_b32 v189, 0xffff0000, v189
    v_mul_f32 v127, s37, v189
    v_cvt_pk_bf16_f32 v127, v127, v127
    v_and_b32 v127, 0xffff0000, v127
    v_max3_f32 v188, v96, v97, v98
    v_max3_f32 v188, v188, v99, v100
    v_max3_f32 v188, v188, v101, v102
    v_max3_f32 v188, v188, v103, v104
    v_max3_f32 v188, v188, v105, v106
    v_max3_f32 v188, v188, v107, v108
    v_max3_f32 v188, v188, v109, v110
    v_max3_f32 v188, v188, v111, v112
    v_max3_f32 v188, v188, v113, v114
    v_max3_f32 v188, v188, v115, v116
    v_max3_f32 v188, v188, v117, v118
    v_max3_f32 v188, v188, v119, v120
    v_max3_f32 v188, v188, v121, v122
    v_max3_f32 v188, v188, v123, v124
    v_max3_f32 v188, v188, v125, v126
    v_max_f32 v188, v188, v127
    s_nop 1
    v_max_f32_dpp v189, v188, v188 row_ror:8 row_mask:0xf bank_mask:0xf
    s_nop 1
    v_readlane_b32 s44, v189, 0
    v_readlane_b32 s45, v189, 16
    v_readlane_b32 s46, v189, 32
    v_readlane_b32 s47, v189, 48
    s_nop 1
    v_mov_b32 v189, s44
    v_max_f32 v189, s45, v189
    v_max_f32 v189, s46, v189
    v_max_f32 v189, s47, v189
    v_mov_b32 v190, 0
    v_sub_f32 v188, v96, v189
    v_mul_f32 v188, s36, v188
    v_exp_f32 v188, v188
    s_nop 0
    v_add_f32 v190, v190, v188
    v_sub_f32 v188, v97, v189
    v_mul_f32 v188, s36, v188
    v_exp_f32 v188, v188
    s_nop 0
    v_add_f32 v190, v190, v188
    v_sub_f32 v188, v98, v189
    v_mul_f32 v188, s36, v188
    v_exp_f32 v188, v188
    s_nop 0
    v_add_f32 v190, v190, v188
    v_sub_f32 v188, v99, v189
    v_mul_f32 v188, s36, v188
    v_exp_f32 v188, v188
    s_nop 0
    v_add_f32 v190, v190, v188
    v_sub_f32 v188, v100, v189
    v_mul_f32 v188, s36, v188
    v_exp_f32 v188, v188
    s_nop 0
    v_add_f32 v190, v190, v188
    v_sub_f32 v188, v101, v189
    v_mul_f32 v188, s36, v188
    v_exp_f32 v188, v188
    s_nop 0
    v_add_f32 v190, v190, v188
    v_sub_f32 v188, v102, v189
    v_mul_f32 v188, s36, v188
    v_exp_f32 v188, v188
    s_nop 0
    v_add_f32 v190, v190, v188
    v_sub_f32 v188, v103, v189
    v_mul_f32 v188, s36, v188
    v_exp_f32 v188, v188
    s_nop 0
    v_add_f32 v190, v190, v188
    v_sub_f32 v188, v104, v189
    v_mul_f32 v188, s36, v188
    v_exp_f32 v188, v188
    s_nop 0
    v_add_f32 v190, v190, v188
    v_sub_f32 v188, v105, v189
    v_mul_f32 v188, s36, v188
    v_exp_f32 v188, v188
    s_nop 0
    v_add_f32 v190, v190, v188
    v_sub_f32 v188, v106, v189
    v_mul_f32 v188, s36, v188
    v_exp_f32 v188, v188
    s_nop 0
    v_add_f32 v190, v190, v188
    v_sub_f32 v188, v107, v189
    v_mul_f32 v188, s36, v188
    v_exp_f32 v188, v188
    s_nop 0
    v_add_f32 v190, v190, v188
    v_sub_f32 v188, v108, v189
    v_mul_f32 v188, s36, v188
    v_exp_f32 v188, v188
    s_nop 0
    v_add_f32 v190, v190, v188
    v_sub_f32 v188, v109, v189
    v_mul_f32 v188, s36, v188
    v_exp_f32 v188, v188
    s_nop 0
    v_add_f32 v190, v190, v188
    v_sub_f32 v188, v110, v189
    v_mul_f32 v188, s36, v188
    v_exp_f32 v188, v188
    s_nop 0
    v_add_f32 v190, v190, v188
    v_sub_f32 v188, v111, v189
    v_mul_f32 v188, s36, v188
    v_exp_f32 v188, v188
    s_nop 0
    v_add_f32 v190, v190, v188
    v_sub_f32 v188, v112, v189
    v_mul_f32 v188, s36, v188
    v_exp_f32 v188, v188
    s_nop 0
    v_add_f32 v190, v190, v188
    v_sub_f32 v188, v113, v189
    v_mul_f32 v188, s36, v188
    v_exp_f32 v188, v188
    s_nop 0
    v_add_f32 v190, v190, v188
    v_sub_f32 v188, v114, v189
    v_mul_f32 v188, s36, v188
    v_exp_f32 v188, v188
    s_nop 0
    v_add_f32 v190, v190, v188
    v_sub_f32 v188, v115, v189
    v_mul_f32 v188, s36, v188
    v_exp_f32 v188, v188
    s_nop 0
    v_add_f32 v190, v190, v188
    v_sub_f32 v188, v116, v189
    v_mul_f32 v188, s36, v188
    v_exp_f32 v188, v188
    s_nop 0
    v_add_f32 v190, v190, v188
    v_sub_f32 v188, v117, v189
    v_mul_f32 v188, s36, v188
    v_exp_f32 v188, v188
    s_nop 0
    v_add_f32 v190, v190, v188
    v_sub_f32 v188, v118, v189
    v_mul_f32 v188, s36, v188
    v_exp_f32 v188, v188
    s_nop 0
    v_add_f32 v190, v190, v188
    v_sub_f32 v188, v119, v189
    v_mul_f32 v188, s36, v188
    v_exp_f32 v188, v188
    s_nop 0
    v_add_f32 v190, v190, v188
    v_sub_f32 v188, v120, v189
    v_mul_f32 v188, s36, v188
    v_exp_f32 v188, v188
    s_nop 0
    v_add_f32 v190, v190, v188
    v_sub_f32 v188, v121, v189
    v_mul_f32 v188, s36, v188
    v_exp_f32 v188, v188
    s_nop 0
    v_add_f32 v190, v190, v188
    v_sub_f32 v188, v122, v189
    v_mul_f32 v188, s36, v188
    v_exp_f32 v188, v188
    s_nop 0
    v_add_f32 v190, v190, v188
    v_sub_f32 v188, v123, v189
    v_mul_f32 v188, s36, v188
    v_exp_f32 v188, v188
    s_nop 0
    v_add_f32 v190, v190, v188
    v_sub_f32 v188, v124, v189
    v_mul_f32 v188, s36, v188
    v_exp_f32 v188, v188
    s_nop 0
    v_add_f32 v190, v190, v188
    v_sub_f32 v188, v125, v189
    v_mul_f32 v188, s36, v188
    v_exp_f32 v188, v188
    s_nop 0
    v_add_f32 v190, v190, v188
    v_sub_f32 v188, v126, v189
    v_mul_f32 v188, s36, v188
    v_exp_f32 v188, v188
    s_nop 0
    v_add_f32 v190, v190, v188
    v_sub_f32 v188, v127, v189
    v_mul_f32 v188, s36, v188
    v_exp_f32 v188, v188
    s_nop 0
    v_add_f32 v190, v190, v188
    s_nop 1
    v_add_f32_dpp v191, v190, v190 row_ror:8 row_mask:0xf bank_mask:0xf
    s_nop 1
    v_readlane_b32 s44, v191, 0
    v_readlane_b32 s45, v191, 16
    v_readlane_b32 s46, v191, 32
    v_readlane_b32 s47, v191, 48
    s_nop 1
    v_mov_b32 v191, s44
    v_add_f32 v191, s45, v191
    v_add_f32 v191, s46, v191
    v_add_f32 v191, s47, v191
    v_or_b32 v190, 1, v189
    v_or_b32 v191, 1, v191
    s_lshl_b32 s13, s12, 3
    s_add_u32 s13, s13, s42
    v_mov_b32 v194, s13
    s_mov_b64 s[40:41], exec
    s_mov_b64 exec, 1
    global_store_dwordx2 v194, v[190:191], s[88:89] offset:64 sc1
    s_mov_b64 exec, s[40:41]

    s_waitcnt vmcnt(34)
    v_and_b32 v188, 1, v192
    v_and_b32 v188, v188, v193
    v_cmp_eq_u32 vcc, 1, v188
    s_nop 1
    s_cmp_eq_u64 vcc, exec
    s_cbranch_scc1 L_ST0_OK
L_ST0:
    global_load_dwordx2 v[192:193], v195, s[88:89] offset:32 sc1
    s_waitcnt vmcnt(0)
    v_and_b32 v188, 1, v192
    v_and_b32 v188, v188, v193
    v_cmp_eq_u32 vcc, 1, v188
    s_nop 1
    s_cmp_eq_u64 vcc, exec
    s_cbranch_scc1 L_ST0_OK
    s_sleep 1
    s_branch L_ST0
L_ST0_OK:
    v_and_b32 v192, -2, v192
    v_mov_b32 v188, v192
    s_nop 1
    v_max_f32_dpp v189, v188, v188 quad_perm:[1,0,3,2] row_mask:0xf bank_mask:0xf
    s_nop 1
    v_max_f32_dpp v188, v189, v189 quad_perm:[2,3,0,1] row_mask:0xf bank_mask:0xf
    s_nop 1
    v_max_f32_dpp v189, v188, v188 row_half_mirror row_mask:0xf bank_mask:0xf
    s_nop 1
    v_max_f32_dpp v188, v189, v189 row_mirror row_mask:0xf bank_mask:0xf
    s_nop 1
    v_readlane_b32 s44, v188, 0
    v_readlane_b32 s45, v188, 16
    v_readlane_b32 s46, v188, 32
    v_readlane_b32 s47, v188, 48
    s_nop 1
    v_mov_b32 v188, s44
    v_max_f32 v188, s45, v188
    v_max_f32 v188, s46, v188
    v_max_f32 v188, s47, v188
    v_sub_f32 v189, v192, v188
    v_mul_f32 v189, s36, v189
    v_exp_f32 v189, v189
    s_nop 0
    v_mul_f32 v189, v189, v193
    s_nop 1
    v_add_f32_dpp v190, v189, v189 quad_perm:[1,0,3,2] row_mask:0xf bank_mask:0xf
    s_nop 1
    v_add_f32_dpp v189, v190, v190 quad_perm:[2,3,0,1] row_mask:0xf bank_mask:0xf
    s_nop 1
    v_add_f32_dpp v190, v189, v189 row_half_mirror row_mask:0xf bank_mask:0xf
    s_nop 1
    v_add_f32_dpp v189, v190, v190 row_mirror row_mask:0xf bank_mask:0xf
    s_nop 1
    v_readlane_b32 s44, v189, 0
    v_readlane_b32 s45, v189, 16
    v_readlane_b32 s46, v189, 32
    v_readlane_b32 s47, v189, 48
    s_nop 1
    v_mov_b32 v189, s44
    v_add_f32 v189, s45, v189
    v_add_f32 v189, s46, v189
    v_add_f32 v189, s47, v189
    v_mul_f32 v189, 0.5, v189
    v_rcp_f32 v190, v189
    s_nop 0
    v_fma_f32 v191, -v189, v190, 1.0
    v_fma_f32 v190, v191, v190, v190
    v_sub_f32 v189, v64, v188
    v_mul_f32 v189, s36, v189
    v_exp_f32 v189, v189
    s_nop 0
    v_mul_f32 v189, v189, v190
    v_cvt_pk_bf16_f32 v64, v189, 0
    v_sub_f32 v189, v65, v188
    v_mul_f32 v189, s36, v189
    v_exp_f32 v189, v189
    s_nop 0
    v_mul_f32 v189, v189, v190
    v_cvt_pk_bf16_f32 v65, v189, 0
    v_sub_f32 v189, v66, v188
    v_mul_f32 v189, s36, v189
    v_exp_f32 v189, v189
    s_nop 0
    v_mul_f32 v189, v189, v190
    v_cvt_pk_bf16_f32 v66, v189, 0
    v_sub_f32 v189, v67, v188
    v_mul_f32 v189, s36, v189
    v_exp_f32 v189, v189
    s_nop 0
    v_mul_f32 v189, v189, v190
    v_cvt_pk_bf16_f32 v67, v189, 0
    v_sub_f32 v189, v68, v188
    v_mul_f32 v189, s36, v189
    v_exp_f32 v189, v189
    s_nop 0
    v_mul_f32 v189, v189, v190
    v_cvt_pk_bf16_f32 v68, v189, 0
    v_sub_f32 v189, v69, v188
    v_mul_f32 v189, s36, v189
    v_exp_f32 v189, v189
    s_nop 0
    v_mul_f32 v189, v189, v190
    v_cvt_pk_bf16_f32 v69, v189, 0
    v_sub_f32 v189, v70, v188
    v_mul_f32 v189, s36, v189
    v_exp_f32 v189, v189
    s_nop 0
    v_mul_f32 v189, v189, v190
    v_cvt_pk_bf16_f32 v70, v189, 0
    v_sub_f32 v189, v71, v188
    v_mul_f32 v189, s36, v189
    v_exp_f32 v189, v189
    s_nop 0
    v_mul_f32 v189, v189, v190
    v_cvt_pk_bf16_f32 v71, v189, 0
    v_sub_f32 v189, v72, v188
    v_mul_f32 v189, s36, v189
    v_exp_f32 v189, v189
    s_nop 0
    v_mul_f32 v189, v189, v190
    v_cvt_pk_bf16_f32 v72, v189, 0
    v_sub_f32 v189, v73, v188
    v_mul_f32 v189, s36, v189
    v_exp_f32 v189, v189
    s_nop 0
    v_mul_f32 v189, v189, v190
    v_cvt_pk_bf16_f32 v73, v189, 0
    v_sub_f32 v189, v74, v188
    v_mul_f32 v189, s36, v189
    v_exp_f32 v189, v189
    s_nop 0
    v_mul_f32 v189, v189, v190
    v_cvt_pk_bf16_f32 v74, v189, 0
    v_sub_f32 v189, v75, v188
    v_mul_f32 v189, s36, v189
    v_exp_f32 v189, v189
    s_nop 0
    v_mul_f32 v189, v189, v190
    v_cvt_pk_bf16_f32 v75, v189, 0
    v_sub_f32 v189, v76, v188
    v_mul_f32 v189, s36, v189
    v_exp_f32 v189, v189
    s_nop 0
    v_mul_f32 v189, v189, v190
    v_cvt_pk_bf16_f32 v76, v189, 0
    v_sub_f32 v189, v77, v188
    v_mul_f32 v189, s36, v189
    v_exp_f32 v189, v189
    s_nop 0
    v_mul_f32 v189, v189, v190
    v_cvt_pk_bf16_f32 v77, v189, 0
    v_sub_f32 v189, v78, v188
    v_mul_f32 v189, s36, v189
    v_exp_f32 v189, v189
    s_nop 0
    v_mul_f32 v189, v189, v190
    v_cvt_pk_bf16_f32 v78, v189, 0
    v_sub_f32 v189, v79, v188
    v_mul_f32 v189, s36, v189
    v_exp_f32 v189, v189
    s_nop 0
    v_mul_f32 v189, v189, v190
    v_cvt_pk_bf16_f32 v79, v189, 0
    v_sub_f32 v189, v80, v188
    v_mul_f32 v189, s36, v189
    v_exp_f32 v189, v189
    s_nop 0
    v_mul_f32 v189, v189, v190
    v_cvt_pk_bf16_f32 v80, v189, 0
    v_sub_f32 v189, v81, v188
    v_mul_f32 v189, s36, v189
    v_exp_f32 v189, v189
    s_nop 0
    v_mul_f32 v189, v189, v190
    v_cvt_pk_bf16_f32 v81, v189, 0
    v_sub_f32 v189, v82, v188
    v_mul_f32 v189, s36, v189
    v_exp_f32 v189, v189
    s_nop 0
    v_mul_f32 v189, v189, v190
    v_cvt_pk_bf16_f32 v82, v189, 0
    v_sub_f32 v189, v83, v188
    v_mul_f32 v189, s36, v189
    v_exp_f32 v189, v189
    s_nop 0
    v_mul_f32 v189, v189, v190
    v_cvt_pk_bf16_f32 v83, v189, 0
    v_sub_f32 v189, v84, v188
    v_mul_f32 v189, s36, v189
    v_exp_f32 v189, v189
    s_nop 0
    v_mul_f32 v189, v189, v190
    v_cvt_pk_bf16_f32 v84, v189, 0
    v_sub_f32 v189, v85, v188
    v_mul_f32 v189, s36, v189
    v_exp_f32 v189, v189
    s_nop 0
    v_mul_f32 v189, v189, v190
    v_cvt_pk_bf16_f32 v85, v189, 0
    v_sub_f32 v189, v86, v188
    v_mul_f32 v189, s36, v189
    v_exp_f32 v189, v189
    s_nop 0
    v_mul_f32 v189, v189, v190
    v_cvt_pk_bf16_f32 v86, v189, 0
    v_sub_f32 v189, v87, v188
    v_mul_f32 v189, s36, v189
    v_exp_f32 v189, v189
    s_nop 0
    v_mul_f32 v189, v189, v190
    v_cvt_pk_bf16_f32 v87, v189, 0
    v_sub_f32 v189, v88, v188
    v_mul_f32 v189, s36, v189
    v_exp_f32 v189, v189
    s_nop 0
    v_mul_f32 v189, v189, v190
    v_cvt_pk_bf16_f32 v88, v189, 0
    v_sub_f32 v189, v89, v188
    v_mul_f32 v189, s36, v189
    v_exp_f32 v189, v189
    s_nop 0
    v_mul_f32 v189, v189, v190
    v_cvt_pk_bf16_f32 v89, v189, 0
    v_sub_f32 v189, v90, v188
    v_mul_f32 v189, s36, v189
    v_exp_f32 v189, v189
    s_nop 0
    v_mul_f32 v189, v189, v190
    v_cvt_pk_bf16_f32 v90, v189, 0
    v_sub_f32 v189, v91, v188
    v_mul_f32 v189, s36, v189
    v_exp_f32 v189, v189
    s_nop 0
    v_mul_f32 v189, v189, v190
    v_cvt_pk_bf16_f32 v91, v189, 0
    v_sub_f32 v189, v92, v188
    v_mul_f32 v189, s36, v189
    v_exp_f32 v189, v189
    s_nop 0
    v_mul_f32 v189, v189, v190
    v_cvt_pk_bf16_f32 v92, v189, 0
    v_sub_f32 v189, v93, v188
    v_mul_f32 v189, s36, v189
    v_exp_f32 v189, v189
    s_nop 0
    v_mul_f32 v189, v189, v190
    v_cvt_pk_bf16_f32 v93, v189, 0
    v_sub_f32 v189, v94, v188
    v_mul_f32 v189, s36, v189
    v_exp_f32 v189, v189
    s_nop 0
    v_mul_f32 v189, v189, v190
    v_cvt_pk_bf16_f32 v94, v189, 0
    v_sub_f32 v189, v95, v188
    v_mul_f32 v189, s36, v189
    v_exp_f32 v189, v189
    s_nop 0
    v_mul_f32 v189, v189, v190
    v_cvt_pk_bf16_f32 v95, v189, 0
    v_mul_u32_u24 v4, 205, v0
    v_lshrrev_b32 v4, 14, v4
    v_mul_u32_u24 v5, 80, v4
    v_sub_u32 v5, v0, v5
    s_mul_i32 s13, s14, 192
    s_mul_i32 s43, s11, 24
    s_add_u32 s13, s13, s43
    v_lshl_add_u32 v6, v4, 3, s13
    v_mul_u32_u24 v6, 1280, v6
    v_lshl_add_u32 v6, v5, 4, v6
    s_and_b32 s43, s2, 7
    s_mul_i32 s43, s43, 24
    s_lshr_b32 s49, s2, 3
    s_min_u32 s13, s49, 23
    s_add_u32 s43, s43, s13
    s_cmp_lt_u32 s49, 24
    s_cselect_b32 s49, s43, 255
    s_lshl_b32 s13, s43, 4
    v_mul_u32_u24 v7, 3072, v0
    v_add_u32 v7, s13, v7
    v_add_u32 v8, 786432, v7
    v_add_u32 v9, 512, v0
    v_min_u32 v9, 639, v9
    v_mul_u32_u24 v9, 3072, v9
    v_add_u32 v9, s13, v9
    s_mul_i32 s13, s43, 10240
    v_lshl_add_u32 v10, v5, 4, s13
    s_mov_b32 s27, 0

    v_mov_b32 v16, 0
    v_mov_b32 v17, 0
    v_mov_b32 v18, 0
    v_mov_b32 v19, 0
    v_mov_b32 v20, 0
    v_mov_b32 v21, 0
    v_mov_b32 v22, 0
    v_mov_b32 v23, 0
    v_mov_b32 v24, 0
    v_mov_b32 v25, 0
    v_mov_b32 v26, 0
    v_mov_b32 v27, 0
    v_mov_b32 v28, 0
    v_mov_b32 v29, 0
    v_mov_b32 v30, 0
    v_mov_b32 v31, 0
    v_mov_b32 v32, 0
    v_mov_b32 v33, 0
    v_mov_b32 v34, 0
    v_mov_b32 v35, 0
    v_mov_b32 v36, 0
    v_mov_b32 v37, 0
    v_mov_b32 v38, 0
    v_mov_b32 v39, 0
    v_mov_b32 v40, 0
    v_mov_b32 v41, 0
    v_mov_b32 v42, 0
    v_mov_b32 v43, 0
    v_mov_b32 v44, 0
    v_mov_b32 v45, 0
    v_mov_b32 v46, 0
    v_mov_b32 v47, 0
    v_mov_b32 v48, 0
    v_mov_b32 v49, 0
    v_mov_b32 v50, 0
    v_mov_b32 v51, 0
    v_mov_b32 v52, 0
    v_mov_b32 v53, 0
    v_mov_b32 v54, 0
    v_mov_b32 v55, 0
    v_mov_b32 v56, 0
    v_mov_b32 v57, 0
    v_mov_b32 v58, 0
    v_mov_b32 v59, 0
    v_mov_b32 v60, 0
    v_mov_b32 v61, 0
    v_mov_b32 v62, 0
    v_mov_b32 v63, 0
    s_waitcnt vmcnt(13)
    v_lshlrev_b32 v188, 16, v64
    v_dot2c_f32_bf16 v16, v140, v64
    v_dot2c_f32_bf16 v17, v140, v188
    v_dot2c_f32_bf16 v18, v141, v64
    v_dot2c_f32_bf16 v19, v141, v188
    v_dot2c_f32_bf16 v20, v142, v64
    v_dot2c_f32_bf16 v21, v142, v188
    v_dot2c_f32_bf16 v22, v143, v64
    v_dot2c_f32_bf16 v23, v143, v188
    v_dot2c_f32_bf16 v24, v144, v64
    v_dot2c_f32_bf16 v25, v144, v188
    v_dot2c_f32_bf16 v26, v145, v64
    v_dot2c_f32_bf16 v27, v145, v188
    v_dot2c_f32_bf16 v28, v146, v64
    v_dot2c_f32_bf16 v29, v146, v188
    v_dot2c_f32_bf16 v30, v147, v64
    v_dot2c_f32_bf16 v31, v147, v188
    v_dot2c_f32_bf16 v32, v148, v64
    v_dot2c_f32_bf16 v33, v148, v188
    v_dot2c_f32_bf16 v34, v149, v64
    v_dot2c_f32_bf16 v35, v149, v188
    v_dot2c_f32_bf16 v36, v150, v64
    v_dot2c_f32_bf16 v37, v150, v188
    v_dot2c_f32_bf16 v38, v151, v64
    v_dot2c_f32_bf16 v39, v151, v188
    buffer_load_dwordx4 v[140:143], v2, s[20:23], s25 offen offset:0 nt
    buffer_load_dwordx4 v[144:147], v2, s[20:23], s25 offen offset:128 nt
    buffer_load_dwordx4 v[148:151], v2, s[20:23], s25 offen offset:256 nt
    s_add_u32 s25, s25, 3072
    s_waitcnt vmcnt(13)
    v_lshlrev_b32 v188, 16, v65
    v_dot2c_f32_bf16 v16, v152, v65
    v_dot2c_f32_bf16 v17, v152, v188
    v_dot2c_f32_bf16 v18, v153, v65
    v_dot2c_f32_bf16 v19, v153, v188
    v_dot2c_f32_bf16 v20, v154, v65
    v_dot2c_f32_bf16 v21, v154, v188
    v_dot2c_f32_bf16 v22, v155, v65
    v_dot2c_f32_bf16 v23, v155, v188
    v_dot2c_f32_bf16 v24, v156, v65
    v_dot2c_f32_bf16 v25, v156, v188
    v_dot2c_f32_bf16 v26, v157, v65
    v_dot2c_f32_bf16 v27, v157, v188
    v_dot2c_f32_bf16 v28, v158, v65
    v_dot2c_f32_bf16 v29, v158, v188
    v_dot2c_f32_bf16 v30, v159, v65
    v_dot2c_f32_bf16 v31, v159, v188
    v_dot2c_f32_bf16 v32, v160, v65
    v_dot2c_f32_bf16 v33, v160, v188
    v_dot2c_f32_bf16 v34, v161, v65
    v_dot2c_f32_bf16 v35, v161, v188
    v_dot2c_f32_bf16 v36, v162, v65
    v_dot2c_f32_bf16 v37, v162, v188
    v_dot2c_f32_bf16 v38, v163, v65
    v_dot2c_f32_bf16 v39, v163, v188
    buffer_load_dwordx4 v[152:155], v2, s[20:23], s25 offen offset:0 nt
    buffer_load_dwordx4 v[156:159], v2, s[20:23], s25 offen offset:128 nt
    buffer_load_dwordx4 v[160:163], v2, s[20:23], s25 offen offset:256 nt
    s_add_u32 s25, s25, 3072
    s_waitcnt vmcnt(13)
    v_lshlrev_b32 v188, 16, v66
    v_dot2c_f32_bf16 v16, v164, v66
    v_dot2c_f32_bf16 v17, v164, v188
    v_dot2c_f32_bf16 v18, v165, v66
    v_dot2c_f32_bf16 v19, v165, v188
    v_dot2c_f32_bf16 v20, v166, v66
    v_dot2c_f32_bf16 v21, v166, v188
    v_dot2c_f32_bf16 v22, v167, v66
    v_dot2c_f32_bf16 v23, v167, v188
    v_dot2c_f32_bf16 v24, v168, v66
    v_dot2c_f32_bf16 v25, v168, v188
    v_dot2c_f32_bf16 v26, v169, v66
    v_dot2c_f32_bf16 v27, v169, v188
    v_dot2c_f32_bf16 v28, v170, v66
    v_dot2c_f32_bf16 v29, v170, v188
    v_dot2c_f32_bf16 v30, v171, v66
    v_dot2c_f32_bf16 v31, v171, v188
    v_dot2c_f32_bf16 v32, v172, v66
    v_dot2c_f32_bf16 v33, v172, v188
    v_dot2c_f32_bf16 v34, v173, v66
    v_dot2c_f32_bf16 v35, v173, v188
    v_dot2c_f32_bf16 v36, v174, v66
    v_dot2c_f32_bf16 v37, v174, v188
    v_dot2c_f32_bf16 v38, v175, v66
    v_dot2c_f32_bf16 v39, v175, v188
    buffer_load_dwordx4 v[164:167], v2, s[20:23], s25 offen offset:0 nt
    buffer_load_dwordx4 v[168:171], v2, s[20:23], s25 offen offset:128 nt
    buffer_load_dwordx4 v[172:175], v2, s[20:23], s25 offen offset:256 nt
    s_add_u32 s25, s25, 3072
    s_waitcnt vmcnt(13)
    v_lshlrev_b32 v188, 16, v67
    v_dot2c_f32_bf16 v16, v176, v67
    v_dot2c_f32_bf16 v17, v176, v188
    v_dot2c_f32_bf16 v18, v177, v67
    v_dot2c_f32_bf16 v19, v177, v188
    v_dot2c_f32_bf16 v20, v178, v67
    v_dot2c_f32_bf16 v21, v178, v188
    v_dot2c_f32_bf16 v22, v179, v67
    v_dot2c_f32_bf16 v23, v179, v188
    v_dot2c_f32_bf16 v24, v180, v67
    v_dot2c_f32_bf16 v25, v180, v188
    v_dot2c_f32_bf16 v26, v181, v67
    v_dot2c_f32_bf16 v27, v181, v188
    v_dot2c_f32_bf16 v28, v182, v67
    v_dot2c_f32_bf16 v29, v182, v188
    v_dot2c_f32_bf16 v30, v183, v67
    v_dot2c_f32_bf16 v31, v183, v188
    v_dot2c_f32_bf16 v32, v184, v67
    v_dot2c_f32_bf16 v33, v184, v188
    v_dot2c_f32_bf16 v34, v185, v67
    v_dot2c_f32_bf16 v35, v185, v188
    v_dot2c_f32_bf16 v36, v186, v67
    v_dot2c_f32_bf16 v37, v186, v188
    v_dot2c_f32_bf16 v38, v187, v67
    v_dot2c_f32_bf16 v39, v187, v188
    buffer_load_dwordx4 v[176:179], v2, s[20:23], s25 offen offset:0 nt
    buffer_load_dwordx4 v[180:183], v2, s[20:23], s25 offen offset:128 nt
    buffer_load_dwordx4 v[184:187], v2, s[20:23], s25 offen offset:256 nt
    s_add_u32 s25, s25, 3072
    s_waitcnt vmcnt(13)
    v_lshlrev_b32 v188, 16, v68
    v_dot2c_f32_bf16 v16, v128, v68
    v_dot2c_f32_bf16 v17, v128, v188
    v_dot2c_f32_bf16 v18, v129, v68
    v_dot2c_f32_bf16 v19, v129, v188
    v_dot2c_f32_bf16 v20, v130, v68
    v_dot2c_f32_bf16 v21, v130, v188
    v_dot2c_f32_bf16 v22, v131, v68
    v_dot2c_f32_bf16 v23, v131, v188
    v_dot2c_f32_bf16 v24, v132, v68
    v_dot2c_f32_bf16 v25, v132, v188
    v_dot2c_f32_bf16 v26, v133, v68
    v_dot2c_f32_bf16 v27, v133, v188
    v_dot2c_f32_bf16 v28, v134, v68
    v_dot2c_f32_bf16 v29, v134, v188
    v_dot2c_f32_bf16 v30, v135, v68
    v_dot2c_f32_bf16 v31, v135, v188
    v_dot2c_f32_bf16 v32, v136, v68
    v_dot2c_f32_bf16 v33, v136, v188
    v_dot2c_f32_bf16 v34, v137, v68
    v_dot2c_f32_bf16 v35, v137, v188
    v_dot2c_f32_bf16 v36, v138, v68
    v_dot2c_f32_bf16 v37, v138, v188
    v_dot2c_f32_bf16 v38, v139, v68
    v_dot2c_f32_bf16 v39, v139, v188
    buffer_load_dwordx4 v[128:131], v2, s[20:23], s25 offen offset:0 nt
    buffer_load_dwordx4 v[132:135], v2, s[20:23], s25 offen offset:128 nt
    buffer_load_dwordx4 v[136:139], v2, s[20:23], s25 offen offset:256 nt
    s_add_u32 s25, s25, 3072
    s_cmp_lg_u32 s12, 0
    s_cbranch_scc1 L_NOCL
    v_and_b32 v189, 31, v0
    v_lshlrev_b32 v189, 2, v189
    global_load_dword v12, v189, s[86:87] sc1
L_NOCL:
    s_waitcnt vmcnt(12)
    v_lshlrev_b32 v188, 16, v69
    v_dot2c_f32_bf16 v16, v140, v69
    v_dot2c_f32_bf16 v17, v140, v188
    v_dot2c_f32_bf16 v18, v141, v69
    v_dot2c_f32_bf16 v19, v141, v188
    v_dot2c_f32_bf16 v20, v142, v69
    v_dot2c_f32_bf16 v21, v142, v188
    v_dot2c_f32_bf16 v22, v143, v69
    v_dot2c_f32_bf16 v23, v143, v188
    v_dot2c_f32_bf16 v24, v144, v69
    v_dot2c_f32_bf16 v25, v144, v188
    v_dot2c_f32_bf16 v26, v145, v69
    v_dot2c_f32_bf16 v27, v145, v188
    v_dot2c_f32_bf16 v28, v146, v69
    v_dot2c_f32_bf16 v29, v146, v188
    v_dot2c_f32_bf16 v30, v147, v69
    v_dot2c_f32_bf16 v31, v147, v188
    v_dot2c_f32_bf16 v32, v148, v69
    v_dot2c_f32_bf16 v33, v148, v188
    v_dot2c_f32_bf16 v34, v149, v69
    v_dot2c_f32_bf16 v35, v149, v188
    v_dot2c_f32_bf16 v36, v150, v69
    v_dot2c_f32_bf16 v37, v150, v188
    v_dot2c_f32_bf16 v38, v151, v69
    v_dot2c_f32_bf16 v39, v151, v188
    buffer_load_dwordx4 v[140:143], v2, s[20:23], s25 offen offset:0 nt
    buffer_load_dwordx4 v[144:147], v2, s[20:23], s25 offen offset:128 nt
    buffer_load_dwordx4 v[148:151], v2, s[20:23], s25 offen offset:256 nt
    s_add_u32 s25, s25, 3072
    s_waitcnt vmcnt(12)
    v_lshlrev_b32 v188, 16, v70
    v_dot2c_f32_bf16 v16, v152, v70
    v_dot2c_f32_bf16 v17, v152, v188
    v_dot2c_f32_bf16 v18, v153, v70
    v_dot2c_f32_bf16 v19, v153, v188
    v_dot2c_f32_bf16 v20, v154, v70
    v_dot2c_f32_bf16 v21, v154, v188
    v_dot2c_f32_bf16 v22, v155, v70
    v_dot2c_f32_bf16 v23, v155, v188
    v_dot2c_f32_bf16 v24, v156, v70
    v_dot2c_f32_bf16 v25, v156, v188
    v_dot2c_f32_bf16 v26, v157, v70
    v_dot2c_f32_bf16 v27, v157, v188
    v_dot2c_f32_bf16 v28, v158, v70
    v_dot2c_f32_bf16 v29, v158, v188
    v_dot2c_f32_bf16 v30, v159, v70
    v_dot2c_f32_bf16 v31, v159, v188
    v_dot2c_f32_bf16 v32, v160, v70
    v_dot2c_f32_bf16 v33, v160, v188
    v_dot2c_f32_bf16 v34, v161, v70
    v_dot2c_f32_bf16 v35, v161, v188
    v_dot2c_f32_bf16 v36, v162, v70
    v_dot2c_f32_bf16 v37, v162, v188
    v_dot2c_f32_bf16 v38, v163, v70
    v_dot2c_f32_bf16 v39, v163, v188
    buffer_load_dwordx4 v[152:155], v2, s[20:23], s25 offen offset:0 nt
    buffer_load_dwordx4 v[156:159], v2, s[20:23], s25 offen offset:128 nt
    buffer_load_dwordx4 v[160:163], v2, s[20:23], s25 offen offset:256 nt
    s_add_u32 s25, s25, 3072
    s_waitcnt vmcnt(12)
    v_lshlrev_b32 v188, 16, v71
    v_dot2c_f32_bf16 v16, v164, v71
    v_dot2c_f32_bf16 v17, v164, v188
    v_dot2c_f32_bf16 v18, v165, v71
    v_dot2c_f32_bf16 v19, v165, v188
    v_dot2c_f32_bf16 v20, v166, v71
    v_dot2c_f32_bf16 v21, v166, v188
    v_dot2c_f32_bf16 v22, v167, v71
    v_dot2c_f32_bf16 v23, v167, v188
    v_dot2c_f32_bf16 v24, v168, v71
    v_dot2c_f32_bf16 v25, v168, v188
    v_dot2c_f32_bf16 v26, v169, v71
    v_dot2c_f32_bf16 v27, v169, v188
    v_dot2c_f32_bf16 v28, v170, v71
    v_dot2c_f32_bf16 v29, v170, v188
    v_dot2c_f32_bf16 v30, v171, v71
    v_dot2c_f32_bf16 v31, v171, v188
    v_dot2c_f32_bf16 v32, v172, v71
    v_dot2c_f32_bf16 v33, v172, v188
    v_dot2c_f32_bf16 v34, v173, v71
    v_dot2c_f32_bf16 v35, v173, v188
    v_dot2c_f32_bf16 v36, v174, v71
    v_dot2c_f32_bf16 v37, v174, v188
    v_dot2c_f32_bf16 v38, v175, v71
    v_dot2c_f32_bf16 v39, v175, v188
    buffer_load_dwordx4 v[164:167], v2, s[20:23], s25 offen offset:0 nt
    buffer_load_dwordx4 v[168:171], v2, s[20:23], s25 offen offset:128 nt
    buffer_load_dwordx4 v[172:175], v2, s[20:23], s25 offen offset:256 nt
    s_add_u32 s25, s25, 3072
    s_waitcnt vmcnt(12)
    v_lshlrev_b32 v188, 16, v72
    v_dot2c_f32_bf16 v16, v176, v72
    v_dot2c_f32_bf16 v17, v176, v188
    v_dot2c_f32_bf16 v18, v177, v72
    v_dot2c_f32_bf16 v19, v177, v188
    v_dot2c_f32_bf16 v20, v178, v72
    v_dot2c_f32_bf16 v21, v178, v188
    v_dot2c_f32_bf16 v22, v179, v72
    v_dot2c_f32_bf16 v23, v179, v188
    v_dot2c_f32_bf16 v24, v180, v72
    v_dot2c_f32_bf16 v25, v180, v188
    v_dot2c_f32_bf16 v26, v181, v72
    v_dot2c_f32_bf16 v27, v181, v188
    v_dot2c_f32_bf16 v28, v182, v72
    v_dot2c_f32_bf16 v29, v182, v188
    v_dot2c_f32_bf16 v30, v183, v72
    v_dot2c_f32_bf16 v31, v183, v188
    v_dot2c_f32_bf16 v32, v184, v72
    v_dot2c_f32_bf16 v33, v184, v188
    v_dot2c_f32_bf16 v34, v185, v72
    v_dot2c_f32_bf16 v35, v185, v188
    v_dot2c_f32_bf16 v36, v186, v72
    v_dot2c_f32_bf16 v37, v186, v188
    v_dot2c_f32_bf16 v38, v187, v72
    v_dot2c_f32_bf16 v39, v187, v188
    buffer_load_dwordx4 v[176:179], v2, s[20:23], s25 offen offset:0 nt
    buffer_load_dwordx4 v[180:183], v2, s[20:23], s25 offen offset:128 nt
    buffer_load_dwordx4 v[184:187], v2, s[20:23], s25 offen offset:256 nt
    s_add_u32 s25, s25, 3072
    s_waitcnt vmcnt(12)
    v_lshlrev_b32 v188, 16, v73
    v_dot2c_f32_bf16 v16, v128, v73
    v_dot2c_f32_bf16 v17, v128, v188
    v_dot2c_f32_bf16 v18, v129, v73
    v_dot2c_f32_bf16 v19, v129, v188
    v_dot2c_f32_bf16 v20, v130, v73
    v_dot2c_f32_bf16 v21, v130, v188
    v_dot2c_f32_bf16 v22, v131, v73
    v_dot2c_f32_bf16 v23, v131, v188
    v_dot2c_f32_bf16 v24, v132, v73
    v_dot2c_f32_bf16 v25, v132, v188
    v_dot2c_f32_bf16 v26, v133, v73
    v_dot2c_f32_bf16 v27, v133, v188
    v_dot2c_f32_bf16 v28, v134, v73
    v_dot2c_f32_bf16 v29, v134, v188
    v_dot2c_f32_bf16 v30, v135, v73
    v_dot2c_f32_bf16 v31, v135, v188
    v_dot2c_f32_bf16 v32, v136, v73
    v_dot2c_f32_bf16 v33, v136, v188
    v_dot2c_f32_bf16 v34, v137, v73
    v_dot2c_f32_bf16 v35, v137, v188
    v_dot2c_f32_bf16 v36, v138, v73
    v_dot2c_f32_bf16 v37, v138, v188
    v_dot2c_f32_bf16 v38, v139, v73
    v_dot2c_f32_bf16 v39, v139, v188
    buffer_load_dwordx4 v[128:131], v2, s[20:23], s25 offen offset:0 nt
    buffer_load_dwordx4 v[132:135], v2, s[20:23], s25 offen offset:128 nt
    buffer_load_dwordx4 v[136:139], v2, s[20:23], s25 offen offset:256 nt
    s_add_u32 s25, s25, 3072
    s_waitcnt vmcnt(12)
    v_lshlrev_b32 v188, 16, v74
    v_dot2c_f32_bf16 v16, v140, v74
    v_dot2c_f32_bf16 v17, v140, v188
    v_dot2c_f32_bf16 v18, v141, v74
    v_dot2c_f32_bf16 v19, v141, v188
    v_dot2c_f32_bf16 v20, v142, v74
    v_dot2c_f32_bf16 v21, v142, v188
    v_dot2c_f32_bf16 v22, v143, v74
    v_dot2c_f32_bf16 v23, v143, v188
    v_dot2c_f32_bf16 v24, v144, v74
    v_dot2c_f32_bf16 v25, v144, v188
    v_dot2c_f32_bf16 v26, v145, v74
    v_dot2c_f32_bf16 v27, v145, v188
    v_dot2c_f32_bf16 v28, v146, v74
    v_dot2c_f32_bf16 v29, v146, v188
    v_dot2c_f32_bf16 v30, v147, v74
    v_dot2c_f32_bf16 v31, v147, v188
    v_dot2c_f32_bf16 v32, v148, v74
    v_dot2c_f32_bf16 v33, v148, v188
    v_dot2c_f32_bf16 v34, v149, v74
    v_dot2c_f32_bf16 v35, v149, v188
    v_dot2c_f32_bf16 v36, v150, v74
    v_dot2c_f32_bf16 v37, v150, v188
    v_dot2c_f32_bf16 v38, v151, v74
    v_dot2c_f32_bf16 v39, v151, v188
    buffer_load_dwordx4 v[140:143], v2, s[20:23], s25 offen offset:0 nt
    buffer_load_dwordx4 v[144:147], v2, s[20:23], s25 offen offset:128 nt
    buffer_load_dwordx4 v[148:151], v2, s[20:23], s25 offen offset:256 nt
    s_add_u32 s25, s25, 3072
    s_waitcnt vmcnt(12)
    v_lshlrev_b32 v188, 16, v75
    v_dot2c_f32_bf16 v16, v152, v75
    v_dot2c_f32_bf16 v17, v152, v188
    v_dot2c_f32_bf16 v18, v153, v75
    v_dot2c_f32_bf16 v19, v153, v188
    v_dot2c_f32_bf16 v20, v154, v75
    v_dot2c_f32_bf16 v21, v154, v188
    v_dot2c_f32_bf16 v22, v155, v75
    v_dot2c_f32_bf16 v23, v155, v188
    v_dot2c_f32_bf16 v24, v156, v75
    v_dot2c_f32_bf16 v25, v156, v188
    v_dot2c_f32_bf16 v26, v157, v75
    v_dot2c_f32_bf16 v27, v157, v188
    v_dot2c_f32_bf16 v28, v158, v75
    v_dot2c_f32_bf16 v29, v158, v188
    v_dot2c_f32_bf16 v30, v159, v75
    v_dot2c_f32_bf16 v31, v159, v188
    v_dot2c_f32_bf16 v32, v160, v75
    v_dot2c_f32_bf16 v33, v160, v188
    v_dot2c_f32_bf16 v34, v161, v75
    v_dot2c_f32_bf16 v35, v161, v188
    v_dot2c_f32_bf16 v36, v162, v75
    v_dot2c_f32_bf16 v37, v162, v188
    v_dot2c_f32_bf16 v38, v163, v75
    v_dot2c_f32_bf16 v39, v163, v188
    buffer_load_dwordx4 v[152:155], v2, s[20:23], s25 offen offset:0 nt
    buffer_load_dwordx4 v[156:159], v2, s[20:23], s25 offen offset:128 nt
    buffer_load_dwordx4 v[160:163], v2, s[20:23], s25 offen offset:256 nt
    s_add_u32 s25, s25, 3072
    s_waitcnt vmcnt(12)
    v_lshlrev_b32 v188, 16, v76
    v_dot2c_f32_bf16 v16, v164, v76
    v_dot2c_f32_bf16 v17, v164, v188
    v_dot2c_f32_bf16 v18, v165, v76
    v_dot2c_f32_bf16 v19, v165, v188
    v_dot2c_f32_bf16 v20, v166, v76
    v_dot2c_f32_bf16 v21, v166, v188
    v_dot2c_f32_bf16 v22, v167, v76
    v_dot2c_f32_bf16 v23, v167, v188
    v_dot2c_f32_bf16 v24, v168, v76
    v_dot2c_f32_bf16 v25, v168, v188
    v_dot2c_f32_bf16 v26, v169, v76
    v_dot2c_f32_bf16 v27, v169, v188
    v_dot2c_f32_bf16 v28, v170, v76
    v_dot2c_f32_bf16 v29, v170, v188
    v_dot2c_f32_bf16 v30, v171, v76
    v_dot2c_f32_bf16 v31, v171, v188
    v_dot2c_f32_bf16 v32, v172, v76
    v_dot2c_f32_bf16 v33, v172, v188
    v_dot2c_f32_bf16 v34, v173, v76
    v_dot2c_f32_bf16 v35, v173, v188
    v_dot2c_f32_bf16 v36, v174, v76
    v_dot2c_f32_bf16 v37, v174, v188
    v_dot2c_f32_bf16 v38, v175, v76
    v_dot2c_f32_bf16 v39, v175, v188
    buffer_load_dwordx4 v[164:167], v2, s[20:23], s25 offen offset:0 nt
    buffer_load_dwordx4 v[168:171], v2, s[20:23], s25 offen offset:128 nt
    buffer_load_dwordx4 v[172:175], v2, s[20:23], s25 offen offset:256 nt
    s_add_u32 s25, s25, 3072
    s_waitcnt vmcnt(12)
    v_lshlrev_b32 v188, 16, v77
    v_dot2c_f32_bf16 v16, v176, v77
    v_dot2c_f32_bf16 v17, v176, v188
    v_dot2c_f32_bf16 v18, v177, v77
    v_dot2c_f32_bf16 v19, v177, v188
    v_dot2c_f32_bf16 v20, v178, v77
    v_dot2c_f32_bf16 v21, v178, v188
    v_dot2c_f32_bf16 v22, v179, v77
    v_dot2c_f32_bf16 v23, v179, v188
    v_dot2c_f32_bf16 v24, v180, v77
    v_dot2c_f32_bf16 v25, v180, v188
    v_dot2c_f32_bf16 v26, v181, v77
    v_dot2c_f32_bf16 v27, v181, v188
    v_dot2c_f32_bf16 v28, v182, v77
    v_dot2c_f32_bf16 v29, v182, v188
    v_dot2c_f32_bf16 v30, v183, v77
    v_dot2c_f32_bf16 v31, v183, v188
    v_dot2c_f32_bf16 v32, v184, v77
    v_dot2c_f32_bf16 v33, v184, v188
    v_dot2c_f32_bf16 v34, v185, v77
    v_dot2c_f32_bf16 v35, v185, v188
    v_dot2c_f32_bf16 v36, v186, v77
    v_dot2c_f32_bf16 v37, v186, v188
    v_dot2c_f32_bf16 v38, v187, v77
    v_dot2c_f32_bf16 v39, v187, v188
    buffer_load_dwordx4 v[176:179], v2, s[20:23], s25 offen offset:0 nt
    buffer_load_dwordx4 v[180:183], v2, s[20:23], s25 offen offset:128 nt
    buffer_load_dwordx4 v[184:187], v2, s[20:23], s25 offen offset:256 nt
    s_add_u32 s25, s25, 3072
    s_waitcnt vmcnt(12)
    v_lshlrev_b32 v188, 16, v78
    v_dot2c_f32_bf16 v16, v128, v78
    v_dot2c_f32_bf16 v17, v128, v188
    v_dot2c_f32_bf16 v18, v129, v78
    v_dot2c_f32_bf16 v19, v129, v188
    v_dot2c_f32_bf16 v20, v130, v78
    v_dot2c_f32_bf16 v21, v130, v188
    v_dot2c_f32_bf16 v22, v131, v78
    v_dot2c_f32_bf16 v23, v131, v188
    v_dot2c_f32_bf16 v24, v132, v78
    v_dot2c_f32_bf16 v25, v132, v188
    v_dot2c_f32_bf16 v26, v133, v78
    v_dot2c_f32_bf16 v27, v133, v188
    v_dot2c_f32_bf16 v28, v134, v78
    v_dot2c_f32_bf16 v29, v134, v188
    v_dot2c_f32_bf16 v30, v135, v78
    v_dot2c_f32_bf16 v31, v135, v188
    v_dot2c_f32_bf16 v32, v136, v78
    v_dot2c_f32_bf16 v33, v136, v188
    v_dot2c_f32_bf16 v34, v137, v78
    v_dot2c_f32_bf16 v35, v137, v188
    v_dot2c_f32_bf16 v36, v138, v78
    v_dot2c_f32_bf16 v37, v138, v188
    v_dot2c_f32_bf16 v38, v139, v78
    v_dot2c_f32_bf16 v39, v139, v188
    buffer_load_dwordx4 v[128:131], v2, s[20:23], s25 offen offset:0 nt
    buffer_load_dwordx4 v[132:135], v2, s[20:23], s25 offen offset:128 nt
    buffer_load_dwordx4 v[136:139], v2, s[20:23], s25 offen offset:256 nt
    s_add_u32 s25, s25, 3072
    s_waitcnt vmcnt(12)
    v_lshlrev_b32 v188, 16, v79
    v_dot2c_f32_bf16 v16, v140, v79
    v_dot2c_f32_bf16 v17, v140, v188
    v_dot2c_f32_bf16 v18, v141, v79
    v_dot2c_f32_bf16 v19, v141, v188
    v_dot2c_f32_bf16 v20, v142, v79
    v_dot2c_f32_bf16 v21, v142, v188
    v_dot2c_f32_bf16 v22, v143, v79
    v_dot2c_f32_bf16 v23, v143, v188
    v_dot2c_f32_bf16 v24, v144, v79
    v_dot2c_f32_bf16 v25, v144, v188
    v_dot2c_f32_bf16 v26, v145, v79
    v_dot2c_f32_bf16 v27, v145, v188
    v_dot2c_f32_bf16 v28, v146, v79
    v_dot2c_f32_bf16 v29, v146, v188
    v_dot2c_f32_bf16 v30, v147, v79
    v_dot2c_f32_bf16 v31, v147, v188
    v_dot2c_f32_bf16 v32, v148, v79
    v_dot2c_f32_bf16 v33, v148, v188
    v_dot2c_f32_bf16 v34, v149, v79
    v_dot2c_f32_bf16 v35, v149, v188
    v_dot2c_f32_bf16 v36, v150, v79
    v_dot2c_f32_bf16 v37, v150, v188
    v_dot2c_f32_bf16 v38, v151, v79
    v_dot2c_f32_bf16 v39, v151, v188
    buffer_load_dwordx4 v[140:143], v2, s[20:23], s25 offen offset:0 nt
    buffer_load_dwordx4 v[144:147], v2, s[20:23], s25 offen offset:128 nt
    buffer_load_dwordx4 v[148:151], v2, s[20:23], s25 offen offset:256 nt
    s_add_u32 s25, s25, 3072
    s_waitcnt vmcnt(12)
    v_lshlrev_b32 v188, 16, v80
    v_dot2c_f32_bf16 v16, v152, v80
    v_dot2c_f32_bf16 v17, v152, v188
    v_dot2c_f32_bf16 v18, v153, v80
    v_dot2c_f32_bf16 v19, v153, v188
    v_dot2c_f32_bf16 v20, v154, v80
    v_dot2c_f32_bf16 v21, v154, v188
    v_dot2c_f32_bf16 v22, v155, v80
    v_dot2c_f32_bf16 v23, v155, v188
    v_dot2c_f32_bf16 v24, v156, v80
    v_dot2c_f32_bf16 v25, v156, v188
    v_dot2c_f32_bf16 v26, v157, v80
    v_dot2c_f32_bf16 v27, v157, v188
    v_dot2c_f32_bf16 v28, v158, v80
    v_dot2c_f32_bf16 v29, v158, v188
    v_dot2c_f32_bf16 v30, v159, v80
    v_dot2c_f32_bf16 v31, v159, v188
    v_dot2c_f32_bf16 v32, v160, v80
    v_dot2c_f32_bf16 v33, v160, v188
    v_dot2c_f32_bf16 v34, v161, v80
    v_dot2c_f32_bf16 v35, v161, v188
    v_dot2c_f32_bf16 v36, v162, v80
    v_dot2c_f32_bf16 v37, v162, v188
    v_dot2c_f32_bf16 v38, v163, v80
    v_dot2c_f32_bf16 v39, v163, v188
    buffer_load_dwordx4 v[152:155], v2, s[20:23], s25 offen offset:0 nt
    buffer_load_dwordx4 v[156:159], v2, s[20:23], s25 offen offset:128 nt
    buffer_load_dwordx4 v[160:163], v2, s[20:23], s25 offen offset:256 nt
    s_add_u32 s25, s25, 3072
    s_waitcnt vmcnt(12)
    v_lshlrev_b32 v188, 16, v81
    v_dot2c_f32_bf16 v16, v164, v81
    v_dot2c_f32_bf16 v17, v164, v188
    v_dot2c_f32_bf16 v18, v165, v81
    v_dot2c_f32_bf16 v19, v165, v188
    v_dot2c_f32_bf16 v20, v166, v81
    v_dot2c_f32_bf16 v21, v166, v188
    v_dot2c_f32_bf16 v22, v167, v81
    v_dot2c_f32_bf16 v23, v167, v188
    v_dot2c_f32_bf16 v24, v168, v81
    v_dot2c_f32_bf16 v25, v168, v188
    v_dot2c_f32_bf16 v26, v169, v81
    v_dot2c_f32_bf16 v27, v169, v188
    v_dot2c_f32_bf16 v28, v170, v81
    v_dot2c_f32_bf16 v29, v170, v188
    v_dot2c_f32_bf16 v30, v171, v81
    v_dot2c_f32_bf16 v31, v171, v188
    v_dot2c_f32_bf16 v32, v172, v81
    v_dot2c_f32_bf16 v33, v172, v188
    v_dot2c_f32_bf16 v34, v173, v81
    v_dot2c_f32_bf16 v35, v173, v188
    v_dot2c_f32_bf16 v36, v174, v81
    v_dot2c_f32_bf16 v37, v174, v188
    v_dot2c_f32_bf16 v38, v175, v81
    v_dot2c_f32_bf16 v39, v175, v188
    buffer_load_dwordx4 v[164:167], v2, s[20:23], s25 offen offset:0 nt
    buffer_load_dwordx4 v[168:171], v2, s[20:23], s25 offen offset:128 nt
    buffer_load_dwordx4 v[172:175], v2, s[20:23], s25 offen offset:256 nt
    s_add_u32 s25, s25, 3072
    s_waitcnt vmcnt(12)
    v_lshlrev_b32 v188, 16, v82
    v_dot2c_f32_bf16 v16, v176, v82
    v_dot2c_f32_bf16 v17, v176, v188
    v_dot2c_f32_bf16 v18, v177, v82
    v_dot2c_f32_bf16 v19, v177, v188
    v_dot2c_f32_bf16 v20, v178, v82
    v_dot2c_f32_bf16 v21, v178, v188
    v_dot2c_f32_bf16 v22, v179, v82
    v_dot2c_f32_bf16 v23, v179, v188
    v_dot2c_f32_bf16 v24, v180, v82
    v_dot2c_f32_bf16 v25, v180, v188
    v_dot2c_f32_bf16 v26, v181, v82
    v_dot2c_f32_bf16 v27, v181, v188
    v_dot2c_f32_bf16 v28, v182, v82
    v_dot2c_f32_bf16 v29, v182, v188
    v_dot2c_f32_bf16 v30, v183, v82
    v_dot2c_f32_bf16 v31, v183, v188
    v_dot2c_f32_bf16 v32, v184, v82
    v_dot2c_f32_bf16 v33, v184, v188
    v_dot2c_f32_bf16 v34, v185, v82
    v_dot2c_f32_bf16 v35, v185, v188
    v_dot2c_f32_bf16 v36, v186, v82
    v_dot2c_f32_bf16 v37, v186, v188
    v_dot2c_f32_bf16 v38, v187, v82
    v_dot2c_f32_bf16 v39, v187, v188
    buffer_load_dwordx4 v[176:179], v2, s[20:23], s25 offen offset:0 nt
    buffer_load_dwordx4 v[180:183], v2, s[20:23], s25 offen offset:128 nt
    buffer_load_dwordx4 v[184:187], v2, s[20:23], s25 offen offset:256 nt
    s_add_u32 s25, s25, 3072
    s_waitcnt vmcnt(12)
    v_lshlrev_b32 v188, 16, v83
    v_dot2c_f32_bf16 v16, v128, v83
    v_dot2c_f32_bf16 v17, v128, v188
    v_dot2c_f32_bf16 v18, v129, v83
    v_dot2c_f32_bf16 v19, v129, v188
    v_dot2c_f32_bf16 v20, v130, v83
    v_dot2c_f32_bf16 v21, v130, v188
    v_dot2c_f32_bf16 v22, v131, v83
    v_dot2c_f32_bf16 v23, v131, v188
    v_dot2c_f32_bf16 v24, v132, v83
    v_dot2c_f32_bf16 v25, v132, v188
    v_dot2c_f32_bf16 v26, v133, v83
    v_dot2c_f32_bf16 v27, v133, v188
    v_dot2c_f32_bf16 v28, v134, v83
    v_dot2c_f32_bf16 v29, v134, v188
    v_dot2c_f32_bf16 v30, v135, v83
    v_dot2c_f32_bf16 v31, v135, v188
    v_dot2c_f32_bf16 v32, v136, v83
    v_dot2c_f32_bf16 v33, v136, v188
    v_dot2c_f32_bf16 v34, v137, v83
    v_dot2c_f32_bf16 v35, v137, v188
    v_dot2c_f32_bf16 v36, v138, v83
    v_dot2c_f32_bf16 v37, v138, v188
    v_dot2c_f32_bf16 v38, v139, v83
    v_dot2c_f32_bf16 v39, v139, v188
    buffer_load_dwordx4 v[128:131], v2, s[20:23], s25 offen offset:0 nt
    buffer_load_dwordx4 v[132:135], v2, s[20:23], s25 offen offset:128 nt
    buffer_load_dwordx4 v[136:139], v2, s[20:23], s25 offen offset:256 nt
    s_add_u32 s25, s25, 3072
    s_waitcnt vmcnt(12)
    v_lshlrev_b32 v188, 16, v84
    v_dot2c_f32_bf16 v16, v140, v84
    v_dot2c_f32_bf16 v17, v140, v188
    v_dot2c_f32_bf16 v18, v141, v84
    v_dot2c_f32_bf16 v19, v141, v188
    v_dot2c_f32_bf16 v20, v142, v84
    v_dot2c_f32_bf16 v21, v142, v188
    v_dot2c_f32_bf16 v22, v143, v84
    v_dot2c_f32_bf16 v23, v143, v188
    v_dot2c_f32_bf16 v24, v144, v84
    v_dot2c_f32_bf16 v25, v144, v188
    v_dot2c_f32_bf16 v26, v145, v84
    v_dot2c_f32_bf16 v27, v145, v188
    v_dot2c_f32_bf16 v28, v146, v84
    v_dot2c_f32_bf16 v29, v146, v188
    v_dot2c_f32_bf16 v30, v147, v84
    v_dot2c_f32_bf16 v31, v147, v188
    v_dot2c_f32_bf16 v32, v148, v84
    v_dot2c_f32_bf16 v33, v148, v188
    v_dot2c_f32_bf16 v34, v149, v84
    v_dot2c_f32_bf16 v35, v149, v188
    v_dot2c_f32_bf16 v36, v150, v84
    v_dot2c_f32_bf16 v37, v150, v188
    v_dot2c_f32_bf16 v38, v151, v84
    v_dot2c_f32_bf16 v39, v151, v188
    buffer_load_dwordx4 v[140:143], v2, s[20:23], s25 offen offset:0 nt
    buffer_load_dwordx4 v[144:147], v2, s[20:23], s25 offen offset:128 nt
    buffer_load_dwordx4 v[148:151], v2, s[20:23], s25 offen offset:256 nt
    s_add_u32 s25, s25, 3072
    global_load_dwordx2 v[192:193], v195, s[88:89] offset:64 sc1
    s_waitcnt vmcnt(13)
    v_lshlrev_b32 v188, 16, v85
    v_dot2c_f32_bf16 v16, v152, v85
    v_dot2c_f32_bf16 v17, v152, v188
    v_dot2c_f32_bf16 v18, v153, v85
    v_dot2c_f32_bf16 v19, v153, v188
    v_dot2c_f32_bf16 v20, v154, v85
    v_dot2c_f32_bf16 v21, v154, v188
    v_dot2c_f32_bf16 v22, v155, v85
    v_dot2c_f32_bf16 v23, v155, v188
    v_dot2c_f32_bf16 v24, v156, v85
    v_dot2c_f32_bf16 v25, v156, v188
    v_dot2c_f32_bf16 v26, v157, v85
    v_dot2c_f32_bf16 v27, v157, v188
    v_dot2c_f32_bf16 v28, v158, v85
    v_dot2c_f32_bf16 v29, v158, v188
    v_dot2c_f32_bf16 v30, v159, v85
    v_dot2c_f32_bf16 v31, v159, v188
    v_dot2c_f32_bf16 v32, v160, v85
    v_dot2c_f32_bf16 v33, v160, v188
    v_dot2c_f32_bf16 v34, v161, v85
    v_dot2c_f32_bf16 v35, v161, v188
    v_dot2c_f32_bf16 v36, v162, v85
    v_dot2c_f32_bf16 v37, v162, v188
    v_dot2c_f32_bf16 v38, v163, v85
    v_dot2c_f32_bf16 v39, v163, v188
    buffer_load_dwordx4 v[152:155], v2, s[20:23], s25 offen offset:0 nt
    buffer_load_dwordx4 v[156:159], v2, s[20:23], s25 offen offset:128 nt
    buffer_load_dwordx4 v[160:163], v2, s[20:23], s25 offen offset:256 nt
    s_add_u32 s25, s25, 3072
    s_waitcnt vmcnt(13)
    v_lshlrev_b32 v188, 16, v86
    v_dot2c_f32_bf16 v16, v164, v86
    v_dot2c_f32_bf16 v17, v164, v188
    v_dot2c_f32_bf16 v18, v165, v86
    v_dot2c_f32_bf16 v19, v165, v188
    v_dot2c_f32_bf16 v20, v166, v86
    v_dot2c_f32_bf16 v21, v166, v188
    v_dot2c_f32_bf16 v22, v167, v86
    v_dot2c_f32_bf16 v23, v167, v188
    v_dot2c_f32_bf16 v24, v168, v86
    v_dot2c_f32_bf16 v25, v168, v188
    v_dot2c_f32_bf16 v26, v169, v86
    v_dot2c_f32_bf16 v27, v169, v188
    v_dot2c_f32_bf16 v28, v170, v86
    v_dot2c_f32_bf16 v29, v170, v188
    v_dot2c_f32_bf16 v30, v171, v86
    v_dot2c_f32_bf16 v31, v171, v188
    v_dot2c_f32_bf16 v32, v172, v86
    v_dot2c_f32_bf16 v33, v172, v188
    v_dot2c_f32_bf16 v34, v173, v86
    v_dot2c_f32_bf16 v35, v173, v188
    v_dot2c_f32_bf16 v36, v174, v86
    v_dot2c_f32_bf16 v37, v174, v188
    v_dot2c_f32_bf16 v38, v175, v86
    v_dot2c_f32_bf16 v39, v175, v188
    buffer_load_dwordx4 v[164:167], v2, s[20:23], s25 offen offset:0 nt
    buffer_load_dwordx4 v[168:171], v2, s[20:23], s25 offen offset:128 nt
    buffer_load_dwordx4 v[172:175], v2, s[20:23], s25 offen offset:256 nt
    s_add_u32 s25, s25, 3072
    s_waitcnt vmcnt(13)
    v_lshlrev_b32 v188, 16, v87
    v_dot2c_f32_bf16 v16, v176, v87
    v_dot2c_f32_bf16 v17, v176, v188
    v_dot2c_f32_bf16 v18, v177, v87
    v_dot2c_f32_bf16 v19, v177, v188
    v_dot2c_f32_bf16 v20, v178, v87
    v_dot2c_f32_bf16 v21, v178, v188
    v_dot2c_f32_bf16 v22, v179, v87
    v_dot2c_f32_bf16 v23, v179, v188
    v_dot2c_f32_bf16 v24, v180, v87
    v_dot2c_f32_bf16 v25, v180, v188
    v_dot2c_f32_bf16 v26, v181, v87
    v_dot2c_f32_bf16 v27, v181, v188
    v_dot2c_f32_bf16 v28, v182, v87
    v_dot2c_f32_bf16 v29, v182, v188
    v_dot2c_f32_bf16 v30, v183, v87
    v_dot2c_f32_bf16 v31, v183, v188
    v_dot2c_f32_bf16 v32, v184, v87
    v_dot2c_f32_bf16 v33, v184, v188
    v_dot2c_f32_bf16 v34, v185, v87
    v_dot2c_f32_bf16 v35, v185, v188
    v_dot2c_f32_bf16 v36, v186, v87
    v_dot2c_f32_bf16 v37, v186, v188
    v_dot2c_f32_bf16 v38, v187, v87
    v_dot2c_f32_bf16 v39, v187, v188
    buffer_load_dwordx4 v[176:179], v2, s[20:23], s25 offen offset:0 nt
    buffer_load_dwordx4 v[180:183], v2, s[20:23], s25 offen offset:128 nt
    buffer_load_dwordx4 v[184:187], v2, s[20:23], s25 offen offset:256 nt
    s_add_u32 s25, s25, 3072
    s_waitcnt vmcnt(13)
    v_lshlrev_b32 v188, 16, v88
    v_dot2c_f32_bf16 v16, v128, v88
    v_dot2c_f32_bf16 v17, v128, v188
    v_dot2c_f32_bf16 v18, v129, v88
    v_dot2c_f32_bf16 v19, v129, v188
    v_dot2c_f32_bf16 v20, v130, v88
    v_dot2c_f32_bf16 v21, v130, v188
    v_dot2c_f32_bf16 v22, v131, v88
    v_dot2c_f32_bf16 v23, v131, v188
    v_dot2c_f32_bf16 v24, v132, v88
    v_dot2c_f32_bf16 v25, v132, v188
    v_dot2c_f32_bf16 v26, v133, v88
    v_dot2c_f32_bf16 v27, v133, v188
    v_dot2c_f32_bf16 v28, v134, v88
    v_dot2c_f32_bf16 v29, v134, v188
    v_dot2c_f32_bf16 v30, v135, v88
    v_dot2c_f32_bf16 v31, v135, v188
    v_dot2c_f32_bf16 v32, v136, v88
    v_dot2c_f32_bf16 v33, v136, v188
    v_dot2c_f32_bf16 v34, v137, v88
    v_dot2c_f32_bf16 v35, v137, v188
    v_dot2c_f32_bf16 v36, v138, v88
    v_dot2c_f32_bf16 v37, v138, v188
    v_dot2c_f32_bf16 v38, v139, v88
    v_dot2c_f32_bf16 v39, v139, v188
    buffer_load_dwordx4 v[128:131], v2, s[20:23], s25 offen offset:0 nt
    buffer_load_dwordx4 v[132:135], v2, s[20:23], s25 offen offset:128 nt
    buffer_load_dwordx4 v[136:139], v2, s[20:23], s25 offen offset:256 nt
    s_add_u32 s25, s25, 3072
    s_waitcnt vmcnt(13)
    v_lshlrev_b32 v188, 16, v89
    v_dot2c_f32_bf16 v16, v140, v89
    v_dot2c_f32_bf16 v17, v140, v188
    v_dot2c_f32_bf16 v18, v141, v89
    v_dot2c_f32_bf16 v19, v141, v188
    v_dot2c_f32_bf16 v20, v142, v89
    v_dot2c_f32_bf16 v21, v142, v188
    v_dot2c_f32_bf16 v22, v143, v89
    v_dot2c_f32_bf16 v23, v143, v188
    v_dot2c_f32_bf16 v24, v144, v89
    v_dot2c_f32_bf16 v25, v144, v188
    v_dot2c_f32_bf16 v26, v145, v89
    v_dot2c_f32_bf16 v27, v145, v188
    v_dot2c_f32_bf16 v28, v146, v89
    v_dot2c_f32_bf16 v29, v146, v188
    v_dot2c_f32_bf16 v30, v147, v89
    v_dot2c_f32_bf16 v31, v147, v188
    v_dot2c_f32_bf16 v32, v148, v89
    v_dot2c_f32_bf16 v33, v148, v188
    v_dot2c_f32_bf16 v34, v149, v89
    v_dot2c_f32_bf16 v35, v149, v188
    v_dot2c_f32_bf16 v36, v150, v89
    v_dot2c_f32_bf16 v37, v150, v188
    v_dot2c_f32_bf16 v38, v151, v89
    v_dot2c_f32_bf16 v39, v151, v188
    buffer_load_dwordx4 v[140:143], v2, s[20:23], s25 offen offset:0 nt
    buffer_load_dwordx4 v[144:147], v2, s[20:23], s25 offen offset:128 nt
    buffer_load_dwordx4 v[148:151], v2, s[20:23], s25 offen offset:256 nt
    s_add_u32 s25, s25, 3072
    s_waitcnt vmcnt(12)
    v_lshlrev_b32 v188, 16, v90
    v_dot2c_f32_bf16 v16, v152, v90
    v_dot2c_f32_bf16 v17, v152, v188
    v_dot2c_f32_bf16 v18, v153, v90
    v_dot2c_f32_bf16 v19, v153, v188
    v_dot2c_f32_bf16 v20, v154, v90
    v_dot2c_f32_bf16 v21, v154, v188
    v_dot2c_f32_bf16 v22, v155, v90
    v_dot2c_f32_bf16 v23, v155, v188
    v_dot2c_f32_bf16 v24, v156, v90
    v_dot2c_f32_bf16 v25, v156, v188
    v_dot2c_f32_bf16 v26, v157, v90
    v_dot2c_f32_bf16 v27, v157, v188
    v_dot2c_f32_bf16 v28, v158, v90
    v_dot2c_f32_bf16 v29, v158, v188
    v_dot2c_f32_bf16 v30, v159, v90
    v_dot2c_f32_bf16 v31, v159, v188
    v_dot2c_f32_bf16 v32, v160, v90
    v_dot2c_f32_bf16 v33, v160, v188
    v_dot2c_f32_bf16 v34, v161, v90
    v_dot2c_f32_bf16 v35, v161, v188
    v_dot2c_f32_bf16 v36, v162, v90
    v_dot2c_f32_bf16 v37, v162, v188
    v_dot2c_f32_bf16 v38, v163, v90
    v_dot2c_f32_bf16 v39, v163, v188
    buffer_load_dwordx4 v[152:155], v2, s[20:23], s25 offen offset:0 nt
    buffer_load_dwordx4 v[156:159], v2, s[20:23], s25 offen offset:128 nt
    buffer_load_dwordx4 v[160:163], v2, s[20:23], s25 offen offset:256 nt
    s_mov_b32 s25, 100663296
    s_waitcnt vmcnt(12)
    v_lshlrev_b32 v188, 16, v91
    v_dot2c_f32_bf16 v16, v164, v91
    v_dot2c_f32_bf16 v17, v164, v188
    v_dot2c_f32_bf16 v18, v165, v91
    v_dot2c_f32_bf16 v19, v165, v188
    v_dot2c_f32_bf16 v20, v166, v91
    v_dot2c_f32_bf16 v21, v166, v188
    v_dot2c_f32_bf16 v22, v167, v91
    v_dot2c_f32_bf16 v23, v167, v188
    v_dot2c_f32_bf16 v24, v168, v91
    v_dot2c_f32_bf16 v25, v168, v188
    v_dot2c_f32_bf16 v26, v169, v91
    v_dot2c_f32_bf16 v27, v169, v188
    v_dot2c_f32_bf16 v28, v170, v91
    v_dot2c_f32_bf16 v29, v170, v188
    v_dot2c_f32_bf16 v30, v171, v91
    v_dot2c_f32_bf16 v31, v171, v188
    v_dot2c_f32_bf16 v32, v172, v91
    v_dot2c_f32_bf16 v33, v172, v188
    v_dot2c_f32_bf16 v34, v173, v91
    v_dot2c_f32_bf16 v35, v173, v188
    v_dot2c_f32_bf16 v36, v174, v91
    v_dot2c_f32_bf16 v37, v174, v188
    v_dot2c_f32_bf16 v38, v175, v91
    v_dot2c_f32_bf16 v39, v175, v188
    buffer_load_dwordx4 v[164:167], v2, s[20:23], s25 offen offset:0 nt
    buffer_load_dwordx4 v[168:171], v2, s[20:23], s25 offen offset:128 nt
    buffer_load_dwordx4 v[172:175], v2, s[20:23], s25 offen offset:256 nt
    s_add_u32 s25, s25, 3072
    s_waitcnt vmcnt(12)
    v_lshlrev_b32 v188, 16, v92
    v_dot2c_f32_bf16 v16, v176, v92
    v_dot2c_f32_bf16 v17, v176, v188
    v_dot2c_f32_bf16 v18, v177, v92
    v_dot2c_f32_bf16 v19, v177, v188
    v_dot2c_f32_bf16 v20, v178, v92
    v_dot2c_f32_bf16 v21, v178, v188
    v_dot2c_f32_bf16 v22, v179, v92
    v_dot2c_f32_bf16 v23, v179, v188
    v_dot2c_f32_bf16 v24, v180, v92
    v_dot2c_f32_bf16 v25, v180, v188
    v_dot2c_f32_bf16 v26, v181, v92
    v_dot2c_f32_bf16 v27, v181, v188
    v_dot2c_f32_bf16 v28, v182, v92
    v_dot2c_f32_bf16 v29, v182, v188
    v_dot2c_f32_bf16 v30, v183, v92
    v_dot2c_f32_bf16 v31, v183, v188
    v_dot2c_f32_bf16 v32, v184, v92
    v_dot2c_f32_bf16 v33, v184, v188
    v_dot2c_f32_bf16 v34, v185, v92
    v_dot2c_f32_bf16 v35, v185, v188
    v_dot2c_f32_bf16 v36, v186, v92
    v_dot2c_f32_bf16 v37, v186, v188
    v_dot2c_f32_bf16 v38, v187, v92
    v_dot2c_f32_bf16 v39, v187, v188
    buffer_load_dwordx4 v[176:179], v2, s[20:23], s25 offen offset:0 nt
    buffer_load_dwordx4 v[180:183], v2, s[20:23], s25 offen offset:128 nt
    buffer_load_dwordx4 v[184:187], v2, s[20:23], s25 offen offset:256 nt
    s_add_u32 s25, s25, 3072
    s_waitcnt vmcnt(12)
    v_lshlrev_b32 v188, 16, v93
    v_dot2c_f32_bf16 v16, v128, v93
    v_dot2c_f32_bf16 v17, v128, v188
    v_dot2c_f32_bf16 v18, v129, v93
    v_dot2c_f32_bf16 v19, v129, v188
    v_dot2c_f32_bf16 v20, v130, v93
    v_dot2c_f32_bf16 v21, v130, v188
    v_dot2c_f32_bf16 v22, v131, v93
    v_dot2c_f32_bf16 v23, v131, v188
    v_dot2c_f32_bf16 v24, v132, v93
    v_dot2c_f32_bf16 v25, v132, v188
    v_dot2c_f32_bf16 v26, v133, v93
    v_dot2c_f32_bf16 v27, v133, v188
    v_dot2c_f32_bf16 v28, v134, v93
    v_dot2c_f32_bf16 v29, v134, v188
    v_dot2c_f32_bf16 v30, v135, v93
    v_dot2c_f32_bf16 v31, v135, v188
    v_dot2c_f32_bf16 v32, v136, v93
    v_dot2c_f32_bf16 v33, v136, v188
    v_dot2c_f32_bf16 v34, v137, v93
    v_dot2c_f32_bf16 v35, v137, v188
    v_dot2c_f32_bf16 v36, v138, v93
    v_dot2c_f32_bf16 v37, v138, v188
    v_dot2c_f32_bf16 v38, v139, v93
    v_dot2c_f32_bf16 v39, v139, v188
    buffer_load_dwordx4 v[128:131], v2, s[20:23], s25 offen offset:0 nt
    buffer_load_dwordx4 v[132:135], v2, s[20:23], s25 offen offset:128 nt
    buffer_load_dwordx4 v[136:139], v2, s[20:23], s25 offen offset:256 nt
    s_add_u32 s25, s25, 3072
    s_waitcnt vmcnt(12)
    v_lshlrev_b32 v188, 16, v94
    v_dot2c_f32_bf16 v16, v140, v94
    v_dot2c_f32_bf16 v17, v140, v188
    v_dot2c_f32_bf16 v18, v141, v94
    v_dot2c_f32_bf16 v19, v141, v188
    v_dot2c_f32_bf16 v20, v142, v94
    v_dot2c_f32_bf16 v21, v142, v188
    v_dot2c_f32_bf16 v22, v143, v94
    v_dot2c_f32_bf16 v23, v143, v188
    v_dot2c_f32_bf16 v24, v144, v94
    v_dot2c_f32_bf16 v25, v144, v188
    v_dot2c_f32_bf16 v26, v145, v94
    v_dot2c_f32_bf16 v27, v145, v188
    v_dot2c_f32_bf16 v28, v146, v94
    v_dot2c_f32_bf16 v29, v146, v188
    v_dot2c_f32_bf16 v30, v147, v94
    v_dot2c_f32_bf16 v31, v147, v188
    v_dot2c_f32_bf16 v32, v148, v94
    v_dot2c_f32_bf16 v33, v148, v188
    v_dot2c_f32_bf16 v34, v149, v94
    v_dot2c_f32_bf16 v35, v149, v188
    v_dot2c_f32_bf16 v36, v150, v94
    v_dot2c_f32_bf16 v37, v150, v188
    v_dot2c_f32_bf16 v38, v151, v94
    v_dot2c_f32_bf16 v39, v151, v188
    buffer_load_dwordx4 v[140:143], v2, s[20:23], s25 offen offset:0 nt
    buffer_load_dwordx4 v[144:147], v2, s[20:23], s25 offen offset:128 nt
    buffer_load_dwordx4 v[148:151], v2, s[20:23], s25 offen offset:256 nt
    s_add_u32 s25, s25, 3072
    s_waitcnt vmcnt(12)
    v_lshlrev_b32 v188, 16, v95
    v_dot2c_f32_bf16 v16, v152, v95
    v_dot2c_f32_bf16 v17, v152, v188
    v_dot2c_f32_bf16 v18, v153, v95
    v_dot2c_f32_bf16 v19, v153, v188
    v_dot2c_f32_bf16 v20, v154, v95
    v_dot2c_f32_bf16 v21, v154, v188
    v_dot2c_f32_bf16 v22, v155, v95
    v_dot2c_f32_bf16 v23, v155, v188
    v_dot2c_f32_bf16 v24, v156, v95
    v_dot2c_f32_bf16 v25, v156, v188
    v_dot2c_f32_bf16 v26, v157, v95
    v_dot2c_f32_bf16 v27, v157, v188
    v_dot2c_f32_bf16 v28, v158, v95
    v_dot2c_f32_bf16 v29, v158, v188
    v_dot2c_f32_bf16 v30, v159, v95
    v_dot2c_f32_bf16 v31, v159, v188
    v_dot2c_f32_bf16 v32, v160, v95
    v_dot2c_f32_bf16 v33, v160, v188
    v_dot2c_f32_bf16 v34, v161, v95
    v_dot2c_f32_bf16 v35, v161, v188
    v_dot2c_f32_bf16 v36, v162, v95
    v_dot2c_f32_bf16 v37, v162, v188
    v_dot2c_f32_bf16 v38, v163, v95
    v_dot2c_f32_bf16 v39, v163, v188
    buffer_load_dwordx4 v[152:155], v2, s[20:23], s25 offen offset:0 nt
    buffer_load_dwordx4 v[156:159], v2, s[20:23], s25 offen offset:128 nt
    buffer_load_dwordx4 v[160:163], v2, s[20:23], s25 offen offset:256 nt
    s_add_u32 s25, s25, 3072
    s_waitcnt vmcnt(33)
    v_and_b32 v188, 1, v192
    v_and_b32 v188, v188, v193
    v_cmp_eq_u32 vcc, 1, v188
    s_nop 1
    s_cmp_eq_u64 vcc, exec
    s_cbranch_scc1 L_ST1_OK
L_ST1:
    global_load_dwordx2 v[192:193], v195, s[88:89] offset:64 sc1
    s_waitcnt vmcnt(0)
    v_and_b32 v188, 1, v192
    v_and_b32 v188, v188, v193
    v_cmp_eq_u32 vcc, 1, v188
    s_nop 1
    s_cmp_eq_u64 vcc, exec
    s_cbranch_scc1 L_ST1_OK
    s_sleep 1
    s_branch L_ST1
L_ST1_OK:
    v_and_b32 v192, -2, v192
    v_mov_b32 v188, v192
    s_nop 1
    v_max_f32_dpp v189, v188, v188 quad_perm:[1,0,3,2] row_mask:0xf bank_mask:0xf
    s_nop 1
    v_max_f32_dpp v188, v189, v189 quad_perm:[2,3,0,1] row_mask:0xf bank_mask:0xf
    s_nop 1
    v_max_f32_dpp v189, v188, v188 row_half_mirror row_mask:0xf bank_mask:0xf
    s_nop 1
    v_max_f32_dpp v188, v189, v189 row_mirror row_mask:0xf bank_mask:0xf
    s_nop 1
    v_readlane_b32 s44, v188, 0
    v_readlane_b32 s45, v188, 16
    v_readlane_b32 s46, v188, 32
    v_readlane_b32 s47, v188, 48
    s_nop 1
    v_mov_b32 v188, s44
    v_max_f32 v188, s45, v188
    v_max_f32 v188, s46, v188
    v_max_f32 v188, s47, v188
    v_sub_f32 v189, v192, v188
    v_mul_f32 v189, s36, v189
    v_exp_f32 v189, v189
    s_nop 0
    v_mul_f32 v189, v189, v193
    s_nop 1
    v_add_f32_dpp v190, v189, v189 quad_perm:[1,0,3,2] row_mask:0xf bank_mask:0xf
    s_nop 1
    v_add_f32_dpp v189, v190, v190 quad_perm:[2,3,0,1] row_mask:0xf bank_mask:0xf
    s_nop 1
    v_add_f32_dpp v190, v189, v189 row_half_mirror row_mask:0xf bank_mask:0xf
    s_nop 1
    v_add_f32_dpp v189, v190, v190 row_mirror row_mask:0xf bank_mask:0xf
    s_nop 1
    v_readlane_b32 s44, v189, 0
    v_readlane_b32 s45, v189, 16
    v_readlane_b32 s46, v189, 32
    v_readlane_b32 s47, v189, 48
    s_nop 1
    v_mov_b32 v189, s44
    v_add_f32 v189, s45, v189
    v_add_f32 v189, s46, v189
    v_add_f32 v189, s47, v189
    v_mul_f32 v189, 0.5, v189
    v_rcp_f32 v190, v189
    s_nop 0
    v_fma_f32 v191, -v189, v190, 1.0
    v_fma_f32 v190, v191, v190, v190
    v_sub_f32 v189, v96, v188
    v_mul_f32 v189, s36, v189
    v_exp_f32 v189, v189
    s_nop 0
    v_mul_f32 v189, v189, v190
    v_cvt_pk_bf16_f32 v96, v189, 0
    v_sub_f32 v189, v97, v188
    v_mul_f32 v189, s36, v189
    v_exp_f32 v189, v189
    s_nop 0
    v_mul_f32 v189, v189, v190
    v_cvt_pk_bf16_f32 v97, v189, 0
    v_sub_f32 v189, v98, v188
    v_mul_f32 v189, s36, v189
    v_exp_f32 v189, v189
    s_nop 0
    v_mul_f32 v189, v189, v190
    v_cvt_pk_bf16_f32 v98, v189, 0
    v_sub_f32 v189, v99, v188
    v_mul_f32 v189, s36, v189
    v_exp_f32 v189, v189
    s_nop 0
    v_mul_f32 v189, v189, v190
    v_cvt_pk_bf16_f32 v99, v189, 0
    v_sub_f32 v189, v100, v188
    v_mul_f32 v189, s36, v189
    v_exp_f32 v189, v189
    s_nop 0
    v_mul_f32 v189, v189, v190
    v_cvt_pk_bf16_f32 v100, v189, 0
    v_sub_f32 v189, v101, v188
    v_mul_f32 v189, s36, v189
    v_exp_f32 v189, v189
    s_nop 0
    v_mul_f32 v189, v189, v190
    v_cvt_pk_bf16_f32 v101, v189, 0
    v_sub_f32 v189, v102, v188
    v_mul_f32 v189, s36, v189
    v_exp_f32 v189, v189
    s_nop 0
    v_mul_f32 v189, v189, v190
    v_cvt_pk_bf16_f32 v102, v189, 0
    v_sub_f32 v189, v103, v188
    v_mul_f32 v189, s36, v189
    v_exp_f32 v189, v189
    s_nop 0
    v_mul_f32 v189, v189, v190
    v_cvt_pk_bf16_f32 v103, v189, 0
    v_sub_f32 v189, v104, v188
    v_mul_f32 v189, s36, v189
    v_exp_f32 v189, v189
    s_nop 0
    v_mul_f32 v189, v189, v190
    v_cvt_pk_bf16_f32 v104, v189, 0
    v_sub_f32 v189, v105, v188
    v_mul_f32 v189, s36, v189
    v_exp_f32 v189, v189
    s_nop 0
    v_mul_f32 v189, v189, v190
    v_cvt_pk_bf16_f32 v105, v189, 0
    v_sub_f32 v189, v106, v188
    v_mul_f32 v189, s36, v189
    v_exp_f32 v189, v189
    s_nop 0
    v_mul_f32 v189, v189, v190
    v_cvt_pk_bf16_f32 v106, v189, 0
    v_sub_f32 v189, v107, v188
    v_mul_f32 v189, s36, v189
    v_exp_f32 v189, v189
    s_nop 0
    v_mul_f32 v189, v189, v190
    v_cvt_pk_bf16_f32 v107, v189, 0
    v_sub_f32 v189, v108, v188
    v_mul_f32 v189, s36, v189
    v_exp_f32 v189, v189
    s_nop 0
    v_mul_f32 v189, v189, v190
    v_cvt_pk_bf16_f32 v108, v189, 0
    v_sub_f32 v189, v109, v188
    v_mul_f32 v189, s36, v189
    v_exp_f32 v189, v189
    s_nop 0
    v_mul_f32 v189, v189, v190
    v_cvt_pk_bf16_f32 v109, v189, 0
    v_sub_f32 v189, v110, v188
    v_mul_f32 v189, s36, v189
    v_exp_f32 v189, v189
    s_nop 0
    v_mul_f32 v189, v189, v190
    v_cvt_pk_bf16_f32 v110, v189, 0
    v_sub_f32 v189, v111, v188
    v_mul_f32 v189, s36, v189
    v_exp_f32 v189, v189
    s_nop 0
    v_mul_f32 v189, v189, v190
    v_cvt_pk_bf16_f32 v111, v189, 0
    v_sub_f32 v189, v112, v188
    v_mul_f32 v189, s36, v189
    v_exp_f32 v189, v189
    s_nop 0
    v_mul_f32 v189, v189, v190
    v_cvt_pk_bf16_f32 v112, v189, 0
    v_sub_f32 v189, v113, v188
    v_mul_f32 v189, s36, v189
    v_exp_f32 v189, v189
    s_nop 0
    v_mul_f32 v189, v189, v190
    v_cvt_pk_bf16_f32 v113, v189, 0
    v_sub_f32 v189, v114, v188
    v_mul_f32 v189, s36, v189
    v_exp_f32 v189, v189
    s_nop 0
    v_mul_f32 v189, v189, v190
    v_cvt_pk_bf16_f32 v114, v189, 0
    v_sub_f32 v189, v115, v188
    v_mul_f32 v189, s36, v189
    v_exp_f32 v189, v189
    s_nop 0
    v_mul_f32 v189, v189, v190
    v_cvt_pk_bf16_f32 v115, v189, 0
    v_sub_f32 v189, v116, v188
    v_mul_f32 v189, s36, v189
    v_exp_f32 v189, v189
    s_nop 0
    v_mul_f32 v189, v189, v190
    v_cvt_pk_bf16_f32 v116, v189, 0
    v_sub_f32 v189, v117, v188
    v_mul_f32 v189, s36, v189
    v_exp_f32 v189, v189
    s_nop 0
    v_mul_f32 v189, v189, v190
    v_cvt_pk_bf16_f32 v117, v189, 0
    v_sub_f32 v189, v118, v188
    v_mul_f32 v189, s36, v189
    v_exp_f32 v189, v189
    s_nop 0
    v_mul_f32 v189, v189, v190
    v_cvt_pk_bf16_f32 v118, v189, 0
    v_sub_f32 v189, v119, v188
    v_mul_f32 v189, s36, v189
    v_exp_f32 v189, v189
    s_nop 0
    v_mul_f32 v189, v189, v190
    v_cvt_pk_bf16_f32 v119, v189, 0
    v_sub_f32 v189, v120, v188
    v_mul_f32 v189, s36, v189
    v_exp_f32 v189, v189
    s_nop 0
    v_mul_f32 v189, v189, v190
    v_cvt_pk_bf16_f32 v120, v189, 0
    v_sub_f32 v189, v121, v188
    v_mul_f32 v189, s36, v189
    v_exp_f32 v189, v189
    s_nop 0
    v_mul_f32 v189, v189, v190
    v_cvt_pk_bf16_f32 v121, v189, 0
    v_sub_f32 v189, v122, v188
    v_mul_f32 v189, s36, v189
    v_exp_f32 v189, v189
    s_nop 0
    v_mul_f32 v189, v189, v190
    v_cvt_pk_bf16_f32 v122, v189, 0
    v_sub_f32 v189, v123, v188
    v_mul_f32 v189, s36, v189
    v_exp_f32 v189, v189
    s_nop 0
    v_mul_f32 v189, v189, v190
    v_cvt_pk_bf16_f32 v123, v189, 0
    v_sub_f32 v189, v124, v188
    v_mul_f32 v189, s36, v189
    v_exp_f32 v189, v189
    s_nop 0
    v_mul_f32 v189, v189, v190
    v_cvt_pk_bf16_f32 v124, v189, 0
    v_sub_f32 v189, v125, v188
    v_mul_f32 v189, s36, v189
    v_exp_f32 v189, v189
    s_nop 0
    v_mul_f32 v189, v189, v190
    v_cvt_pk_bf16_f32 v125, v189, 0
    v_sub_f32 v189, v126, v188
    v_mul_f32 v189, s36, v189
    v_exp_f32 v189, v189
    s_nop 0
    v_mul_f32 v189, v189, v190
    v_cvt_pk_bf16_f32 v126, v189, 0
    v_sub_f32 v189, v127, v188
    v_mul_f32 v189, s36, v189
    v_exp_f32 v189, v189
    s_nop 0
    v_mul_f32 v189, v189, v190
    v_cvt_pk_bf16_f32 v127, v189, 0
    s_waitcnt vmcnt(12)
    v_lshlrev_b32 v188, 16, v96
    v_dot2c_f32_bf16 v40, v164, v96
    v_dot2c_f32_bf16 v41, v164, v188
    v_dot2c_f32_bf16 v42, v165, v96
    v_dot2c_f32_bf16 v43, v165, v188
    v_dot2c_f32_bf16 v44, v166, v96
    v_dot2c_f32_bf16 v45, v166, v188
    v_dot2c_f32_bf16 v46, v167, v96
    v_dot2c_f32_bf16 v47, v167, v188
    v_dot2c_f32_bf16 v48, v168, v96
    v_dot2c_f32_bf16 v49, v168, v188
    v_dot2c_f32_bf16 v50, v169, v96
    v_dot2c_f32_bf16 v51, v169, v188
    v_dot2c_f32_bf16 v52, v170, v96
    v_dot2c_f32_bf16 v53, v170, v188
    v_dot2c_f32_bf16 v54, v171, v96
    v_dot2c_f32_bf16 v55, v171, v188
    v_dot2c_f32_bf16 v56, v172, v96
    v_dot2c_f32_bf16 v57, v172, v188
    v_dot2c_f32_bf16 v58, v173, v96
    v_dot2c_f32_bf16 v59, v173, v188
    v_dot2c_f32_bf16 v60, v174, v96
    v_dot2c_f32_bf16 v61, v174, v188
    v_dot2c_f32_bf16 v62, v175, v96
    v_dot2c_f32_bf16 v63, v175, v188
    buffer_load_dwordx4 v[164:167], v2, s[20:23], s25 offen offset:0 nt
    buffer_load_dwordx4 v[168:171], v2, s[20:23], s25 offen offset:128 nt
    buffer_load_dwordx4 v[172:175], v2, s[20:23], s25 offen offset:256 nt
    s_add_u32 s25, s25, 3072
    s_waitcnt vmcnt(12)
    v_lshlrev_b32 v188, 16, v97
    v_dot2c_f32_bf16 v40, v176, v97
    v_dot2c_f32_bf16 v41, v176, v188
    v_dot2c_f32_bf16 v42, v177, v97
    v_dot2c_f32_bf16 v43, v177, v188
    v_dot2c_f32_bf16 v44, v178, v97
    v_dot2c_f32_bf16 v45, v178, v188
    v_dot2c_f32_bf16 v46, v179, v97
    v_dot2c_f32_bf16 v47, v179, v188
    v_dot2c_f32_bf16 v48, v180, v97
    v_dot2c_f32_bf16 v49, v180, v188
    v_dot2c_f32_bf16 v50, v181, v97
    v_dot2c_f32_bf16 v51, v181, v188
    v_dot2c_f32_bf16 v52, v182, v97
    v_dot2c_f32_bf16 v53, v182, v188
    v_dot2c_f32_bf16 v54, v183, v97
    v_dot2c_f32_bf16 v55, v183, v188
    v_dot2c_f32_bf16 v56, v184, v97
    v_dot2c_f32_bf16 v57, v184, v188
    v_dot2c_f32_bf16 v58, v185, v97
    v_dot2c_f32_bf16 v59, v185, v188
    v_dot2c_f32_bf16 v60, v186, v97
    v_dot2c_f32_bf16 v61, v186, v188
    v_dot2c_f32_bf16 v62, v187, v97
    v_dot2c_f32_bf16 v63, v187, v188
    buffer_load_dwordx4 v[176:179], v2, s[20:23], s25 offen offset:0 nt
    buffer_load_dwordx4 v[180:183], v2, s[20:23], s25 offen offset:128 nt
    buffer_load_dwordx4 v[184:187], v2, s[20:23], s25 offen offset:256 nt
    s_add_u32 s25, s25, 3072
    s_waitcnt vmcnt(12)
    v_lshlrev_b32 v188, 16, v98
    v_dot2c_f32_bf16 v40, v128, v98
    v_dot2c_f32_bf16 v41, v128, v188
    v_dot2c_f32_bf16 v42, v129, v98
    v_dot2c_f32_bf16 v43, v129, v188
    v_dot2c_f32_bf16 v44, v130, v98
    v_dot2c_f32_bf16 v45, v130, v188
    v_dot2c_f32_bf16 v46, v131, v98
    v_dot2c_f32_bf16 v47, v131, v188
    v_dot2c_f32_bf16 v48, v132, v98
    v_dot2c_f32_bf16 v49, v132, v188
    v_dot2c_f32_bf16 v50, v133, v98
    v_dot2c_f32_bf16 v51, v133, v188
    v_dot2c_f32_bf16 v52, v134, v98
    v_dot2c_f32_bf16 v53, v134, v188
    v_dot2c_f32_bf16 v54, v135, v98
    v_dot2c_f32_bf16 v55, v135, v188
    v_dot2c_f32_bf16 v56, v136, v98
    v_dot2c_f32_bf16 v57, v136, v188
    v_dot2c_f32_bf16 v58, v137, v98
    v_dot2c_f32_bf16 v59, v137, v188
    v_dot2c_f32_bf16 v60, v138, v98
    v_dot2c_f32_bf16 v61, v138, v188
    v_dot2c_f32_bf16 v62, v139, v98
    v_dot2c_f32_bf16 v63, v139, v188
    buffer_load_dwordx4 v[128:131], v2, s[20:23], s25 offen offset:0 nt
    buffer_load_dwordx4 v[132:135], v2, s[20:23], s25 offen offset:128 nt
    buffer_load_dwordx4 v[136:139], v2, s[20:23], s25 offen offset:256 nt
    s_add_u32 s25, s25, 3072
    v_and_b32 v189, 7, v0
    s_min_u32 s13, s3, 159
    s_lshl_b32 s43, s13, 3
    v_add_u32 v190, s43, v189
    v_lshlrev_b32 v190, 1, v190
    global_load_ushort v14, v190, s[64:65]
    s_cmp_ge_u32 s13, 80
    s_cselect_b32 s43, 80, 0
    s_sub_u32 s13, s13, s43
    s_lshl_b32 s13, s13, 3
    v_add_u32 v190, s13, v189
    v_lshlrev_b32 v190, 1, v190
    global_load_ushort v3, v190, s[82:83]
    s_min_u32 s13, s49, 191
    s_lshl_b32 s13, s13, 3
    v_add_u32 v190, s13, v189
    v_lshlrev_b32 v190, 1, v190
    global_load_ushort v15, v190, s[78:79]

    s_waitcnt vmcnt(15)
    v_lshlrev_b32 v188, 16, v99
    v_dot2c_f32_bf16 v40, v140, v99
    v_dot2c_f32_bf16 v41, v140, v188
    v_dot2c_f32_bf16 v42, v141, v99
    v_dot2c_f32_bf16 v43, v141, v188
    v_dot2c_f32_bf16 v44, v142, v99
    v_dot2c_f32_bf16 v45, v142, v188
    v_dot2c_f32_bf16 v46, v143, v99
    v_dot2c_f32_bf16 v47, v143, v188
    v_dot2c_f32_bf16 v48, v144, v99
    v_dot2c_f32_bf16 v49, v144, v188
    v_dot2c_f32_bf16 v50, v145, v99
    v_dot2c_f32_bf16 v51, v145, v188
    v_dot2c_f32_bf16 v52, v146, v99
    v_dot2c_f32_bf16 v53, v146, v188
    v_dot2c_f32_bf16 v54, v147, v99
    v_dot2c_f32_bf16 v55, v147, v188
    v_dot2c_f32_bf16 v56, v148, v99
    v_dot2c_f32_bf16 v57, v148, v188
    v_dot2c_f32_bf16 v58, v149, v99
    v_dot2c_f32_bf16 v59, v149, v188
    v_dot2c_f32_bf16 v60, v150, v99
    v_dot2c_f32_bf16 v61, v150, v188
    v_dot2c_f32_bf16 v62, v151, v99
    v_dot2c_f32_bf16 v63, v151, v188
    buffer_load_dwordx4 v[140:143], v2, s[20:23], s25 offen offset:0 nt
    buffer_load_dwordx4 v[144:147], v2, s[20:23], s25 offen offset:128 nt
    buffer_load_dwordx4 v[148:151], v2, s[20:23], s25 offen offset:256 nt
    s_add_u32 s25, s25, 3072
    s_waitcnt vmcnt(15)
    v_lshlrev_b32 v188, 16, v100
    v_dot2c_f32_bf16 v40, v152, v100
    v_dot2c_f32_bf16 v41, v152, v188
    v_dot2c_f32_bf16 v42, v153, v100
    v_dot2c_f32_bf16 v43, v153, v188
    v_dot2c_f32_bf16 v44, v154, v100
    v_dot2c_f32_bf16 v45, v154, v188
    v_dot2c_f32_bf16 v46, v155, v100
    v_dot2c_f32_bf16 v47, v155, v188
    v_dot2c_f32_bf16 v48, v156, v100
    v_dot2c_f32_bf16 v49, v156, v188
    v_dot2c_f32_bf16 v50, v157, v100
    v_dot2c_f32_bf16 v51, v157, v188
    v_dot2c_f32_bf16 v52, v158, v100
    v_dot2c_f32_bf16 v53, v158, v188
    v_dot2c_f32_bf16 v54, v159, v100
    v_dot2c_f32_bf16 v55, v159, v188
    v_dot2c_f32_bf16 v56, v160, v100
    v_dot2c_f32_bf16 v57, v160, v188
    v_dot2c_f32_bf16 v58, v161, v100
    v_dot2c_f32_bf16 v59, v161, v188
    v_dot2c_f32_bf16 v60, v162, v100
    v_dot2c_f32_bf16 v61, v162, v188
    v_dot2c_f32_bf16 v62, v163, v100
    v_dot2c_f32_bf16 v63, v163, v188
    buffer_load_dwordx4 v[152:155], v2, s[20:23], s25 offen offset:0 nt
    buffer_load_dwordx4 v[156:159], v2, s[20:23], s25 offen offset:128 nt
    buffer_load_dwordx4 v[160:163], v2, s[20:23], s25 offen offset:256 nt
    s_add_u32 s25, s25, 3072
    s_waitcnt vmcnt(15)
    v_lshlrev_b32 v188, 16, v101
    v_dot2c_f32_bf16 v40, v164, v101
    v_dot2c_f32_bf16 v41, v164, v188
    v_dot2c_f32_bf16 v42, v165, v101
    v_dot2c_f32_bf16 v43, v165, v188
    v_dot2c_f32_bf16 v44, v166, v101
    v_dot2c_f32_bf16 v45, v166, v188
    v_dot2c_f32_bf16 v46, v167, v101
    v_dot2c_f32_bf16 v47, v167, v188
    v_dot2c_f32_bf16 v48, v168, v101
    v_dot2c_f32_bf16 v49, v168, v188
    v_dot2c_f32_bf16 v50, v169, v101
    v_dot2c_f32_bf16 v51, v169, v188
    v_dot2c_f32_bf16 v52, v170, v101
    v_dot2c_f32_bf16 v53, v170, v188
    v_dot2c_f32_bf16 v54, v171, v101
    v_dot2c_f32_bf16 v55, v171, v188
    v_dot2c_f32_bf16 v56, v172, v101
    v_dot2c_f32_bf16 v57, v172, v188
    v_dot2c_f32_bf16 v58, v173, v101
    v_dot2c_f32_bf16 v59, v173, v188
    v_dot2c_f32_bf16 v60, v174, v101
    v_dot2c_f32_bf16 v61, v174, v188
    v_dot2c_f32_bf16 v62, v175, v101
    v_dot2c_f32_bf16 v63, v175, v188
    buffer_load_dwordx4 v[164:167], v2, s[20:23], s25 offen offset:0 nt
    buffer_load_dwordx4 v[168:171], v2, s[20:23], s25 offen offset:128 nt
    buffer_load_dwordx4 v[172:175], v2, s[20:23], s25 offen offset:256 nt
    s_add_u32 s25, s25, 3072
    s_waitcnt vmcnt(15)
    v_lshlrev_b32 v188, 16, v102
    v_dot2c_f32_bf16 v40, v176, v102
    v_dot2c_f32_bf16 v41, v176, v188
    v_dot2c_f32_bf16 v42, v177, v102
    v_dot2c_f32_bf16 v43, v177, v188
    v_dot2c_f32_bf16 v44, v178, v102
    v_dot2c_f32_bf16 v45, v178, v188
    v_dot2c_f32_bf16 v46, v179, v102
    v_dot2c_f32_bf16 v47, v179, v188
    v_dot2c_f32_bf16 v48, v180, v102
    v_dot2c_f32_bf16 v49, v180, v188
    v_dot2c_f32_bf16 v50, v181, v102
    v_dot2c_f32_bf16 v51, v181, v188
    v_dot2c_f32_bf16 v52, v182, v102
    v_dot2c_f32_bf16 v53, v182, v188
    v_dot2c_f32_bf16 v54, v183, v102
    v_dot2c_f32_bf16 v55, v183, v188
    v_dot2c_f32_bf16 v56, v184, v102
    v_dot2c_f32_bf16 v57, v184, v188
    v_dot2c_f32_bf16 v58, v185, v102
    v_dot2c_f32_bf16 v59, v185, v188
    v_dot2c_f32_bf16 v60, v186, v102
    v_dot2c_f32_bf16 v61, v186, v188
    v_dot2c_f32_bf16 v62, v187, v102
    v_dot2c_f32_bf16 v63, v187, v188
    buffer_load_dwordx4 v[176:179], v2, s[20:23], s25 offen offset:0 nt
    buffer_load_dwordx4 v[180:183], v2, s[20:23], s25 offen offset:128 nt
    buffer_load_dwordx4 v[184:187], v2, s[20:23], s25 offen offset:256 nt
    s_add_u32 s25, s25, 3072
    s_waitcnt vmcnt(15)
    v_lshlrev_b32 v188, 16, v103
    v_dot2c_f32_bf16 v40, v128, v103
    v_dot2c_f32_bf16 v41, v128, v188
    v_dot2c_f32_bf16 v42, v129, v103
    v_dot2c_f32_bf16 v43, v129, v188
    v_dot2c_f32_bf16 v44, v130, v103
    v_dot2c_f32_bf16 v45, v130, v188
    v_dot2c_f32_bf16 v46, v131, v103
    v_dot2c_f32_bf16 v47, v131, v188
    v_dot2c_f32_bf16 v48, v132, v103
    v_dot2c_f32_bf16 v49, v132, v188
    v_dot2c_f32_bf16 v50, v133, v103
    v_dot2c_f32_bf16 v51, v133, v188
    v_dot2c_f32_bf16 v52, v134, v103
    v_dot2c_f32_bf16 v53, v134, v188
    v_dot2c_f32_bf16 v54, v135, v103
    v_dot2c_f32_bf16 v55, v135, v188
    v_dot2c_f32_bf16 v56, v136, v103
    v_dot2c_f32_bf16 v57, v136, v188
    v_dot2c_f32_bf16 v58, v137, v103
    v_dot2c_f32_bf16 v59, v137, v188
    v_dot2c_f32_bf16 v60, v138, v103
    v_dot2c_f32_bf16 v61, v138, v188
    v_dot2c_f32_bf16 v62, v139, v103
    v_dot2c_f32_bf16 v63, v139, v188
    buffer_load_dwordx4 v[128:131], v2, s[20:23], s25 offen offset:0 nt
    buffer_load_dwordx4 v[132:135], v2, s[20:23], s25 offen offset:128 nt
    buffer_load_dwordx4 v[136:139], v2, s[20:23], s25 offen offset:256 nt
    s_add_u32 s25, s25, 3072
    s_waitcnt vmcnt(12)
    v_lshlrev_b32 v188, 16, v104
    v_dot2c_f32_bf16 v40, v140, v104
    v_dot2c_f32_bf16 v41, v140, v188
    v_dot2c_f32_bf16 v42, v141, v104
    v_dot2c_f32_bf16 v43, v141, v188
    v_dot2c_f32_bf16 v44, v142, v104
    v_dot2c_f32_bf16 v45, v142, v188
    v_dot2c_f32_bf16 v46, v143, v104
    v_dot2c_f32_bf16 v47, v143, v188
    v_dot2c_f32_bf16 v48, v144, v104
    v_dot2c_f32_bf16 v49, v144, v188
    v_dot2c_f32_bf16 v50, v145, v104
    v_dot2c_f32_bf16 v51, v145, v188
    v_dot2c_f32_bf16 v52, v146, v104
    v_dot2c_f32_bf16 v53, v146, v188
    v_dot2c_f32_bf16 v54, v147, v104
    v_dot2c_f32_bf16 v55, v147, v188
    v_dot2c_f32_bf16 v56, v148, v104
    v_dot2c_f32_bf16 v57, v148, v188
    v_dot2c_f32_bf16 v58, v149, v104
    v_dot2c_f32_bf16 v59, v149, v188
    v_dot2c_f32_bf16 v60, v150, v104
    v_dot2c_f32_bf16 v61, v150, v188
    v_dot2c_f32_bf16 v62, v151, v104
    v_dot2c_f32_bf16 v63, v151, v188
    buffer_load_dwordx4 v[140:143], v2, s[20:23], s25 offen offset:0 nt
    buffer_load_dwordx4 v[144:147], v2, s[20:23], s25 offen offset:128 nt
    buffer_load_dwordx4 v[148:151], v2, s[20:23], s25 offen offset:256 nt
    s_add_u32 s25, s25, 3072
    s_waitcnt vmcnt(12)
    v_lshlrev_b32 v188, 16, v105
    v_dot2c_f32_bf16 v40, v152, v105
    v_dot2c_f32_bf16 v41, v152, v188
    v_dot2c_f32_bf16 v42, v153, v105
    v_dot2c_f32_bf16 v43, v153, v188
    v_dot2c_f32_bf16 v44, v154, v105
    v_dot2c_f32_bf16 v45, v154, v188
    v_dot2c_f32_bf16 v46, v155, v105
    v_dot2c_f32_bf16 v47, v155, v188
    v_dot2c_f32_bf16 v48, v156, v105
    v_dot2c_f32_bf16 v49, v156, v188
    v_dot2c_f32_bf16 v50, v157, v105
    v_dot2c_f32_bf16 v51, v157, v188
    v_dot2c_f32_bf16 v52, v158, v105
    v_dot2c_f32_bf16 v53, v158, v188
    v_dot2c_f32_bf16 v54, v159, v105
    v_dot2c_f32_bf16 v55, v159, v188
    v_dot2c_f32_bf16 v56, v160, v105
    v_dot2c_f32_bf16 v57, v160, v188
    v_dot2c_f32_bf16 v58, v161, v105
    v_dot2c_f32_bf16 v59, v161, v188
    v_dot2c_f32_bf16 v60, v162, v105
    v_dot2c_f32_bf16 v61, v162, v188
    v_dot2c_f32_bf16 v62, v163, v105
    v_dot2c_f32_bf16 v63, v163, v188
    buffer_load_dwordx4 v[152:155], v2, s[20:23], s25 offen offset:0 nt
    buffer_load_dwordx4 v[156:159], v2, s[20:23], s25 offen offset:128 nt
    buffer_load_dwordx4 v[160:163], v2, s[20:23], s25 offen offset:256 nt
    s_add_u32 s25, s25, 3072
    s_waitcnt vmcnt(12)
    v_lshlrev_b32 v188, 16, v106
    v_dot2c_f32_bf16 v40, v164, v106
    v_dot2c_f32_bf16 v41, v164, v188
    v_dot2c_f32_bf16 v42, v165, v106
    v_dot2c_f32_bf16 v43, v165, v188
    v_dot2c_f32_bf16 v44, v166, v106
    v_dot2c_f32_bf16 v45, v166, v188
    v_dot2c_f32_bf16 v46, v167, v106
    v_dot2c_f32_bf16 v47, v167, v188
    v_dot2c_f32_bf16 v48, v168, v106
    v_dot2c_f32_bf16 v49, v168, v188
    v_dot2c_f32_bf16 v50, v169, v106
    v_dot2c_f32_bf16 v51, v169, v188
    v_dot2c_f32_bf16 v52, v170, v106
    v_dot2c_f32_bf16 v53, v170, v188
    v_dot2c_f32_bf16 v54, v171, v106
    v_dot2c_f32_bf16 v55, v171, v188
    v_dot2c_f32_bf16 v56, v172, v106
    v_dot2c_f32_bf16 v57, v172, v188
    v_dot2c_f32_bf16 v58, v173, v106
    v_dot2c_f32_bf16 v59, v173, v188
    v_dot2c_f32_bf16 v60, v174, v106
    v_dot2c_f32_bf16 v61, v174, v188
    v_dot2c_f32_bf16 v62, v175, v106
    v_dot2c_f32_bf16 v63, v175, v188
    buffer_load_dwordx4 v[164:167], v2, s[20:23], s25 offen offset:0 nt
    buffer_load_dwordx4 v[168:171], v2, s[20:23], s25 offen offset:128 nt
    buffer_load_dwordx4 v[172:175], v2, s[20:23], s25 offen offset:256 nt
    s_add_u32 s25, s25, 3072
    s_waitcnt vmcnt(12)
    v_lshlrev_b32 v188, 16, v107
    v_dot2c_f32_bf16 v40, v176, v107
    v_dot2c_f32_bf16 v41, v176, v188
    v_dot2c_f32_bf16 v42, v177, v107
    v_dot2c_f32_bf16 v43, v177, v188
    v_dot2c_f32_bf16 v44, v178, v107
    v_dot2c_f32_bf16 v45, v178, v188
    v_dot2c_f32_bf16 v46, v179, v107
    v_dot2c_f32_bf16 v47, v179, v188
    v_dot2c_f32_bf16 v48, v180, v107
    v_dot2c_f32_bf16 v49, v180, v188
    v_dot2c_f32_bf16 v50, v181, v107
    v_dot2c_f32_bf16 v51, v181, v188
    v_dot2c_f32_bf16 v52, v182, v107
    v_dot2c_f32_bf16 v53, v182, v188
    v_dot2c_f32_bf16 v54, v183, v107
    v_dot2c_f32_bf16 v55, v183, v188
    v_dot2c_f32_bf16 v56, v184, v107
    v_dot2c_f32_bf16 v57, v184, v188
    v_dot2c_f32_bf16 v58, v185, v107
    v_dot2c_f32_bf16 v59, v185, v188
    v_dot2c_f32_bf16 v60, v186, v107
    v_dot2c_f32_bf16 v61, v186, v188
    v_dot2c_f32_bf16 v62, v187, v107
    v_dot2c_f32_bf16 v63, v187, v188
    buffer_load_dwordx4 v[176:179], v2, s[20:23], s25 offen offset:0 nt
    buffer_load_dwordx4 v[180:183], v2, s[20:23], s25 offen offset:128 nt
    buffer_load_dwordx4 v[184:187], v2, s[20:23], s25 offen offset:256 nt
    s_add_u32 s25, s25, 3072
    s_waitcnt vmcnt(12)
    v_lshlrev_b32 v188, 16, v108
    v_dot2c_f32_bf16 v40, v128, v108
    v_dot2c_f32_bf16 v41, v128, v188
    v_dot2c_f32_bf16 v42, v129, v108
    v_dot2c_f32_bf16 v43, v129, v188
    v_dot2c_f32_bf16 v44, v130, v108
    v_dot2c_f32_bf16 v45, v130, v188
    v_dot2c_f32_bf16 v46, v131, v108
    v_dot2c_f32_bf16 v47, v131, v188
    v_dot2c_f32_bf16 v48, v132, v108
    v_dot2c_f32_bf16 v49, v132, v188
    v_dot2c_f32_bf16 v50, v133, v108
    v_dot2c_f32_bf16 v51, v133, v188
    v_dot2c_f32_bf16 v52, v134, v108
    v_dot2c_f32_bf16 v53, v134, v188
    v_dot2c_f32_bf16 v54, v135, v108
    v_dot2c_f32_bf16 v55, v135, v188
    v_dot2c_f32_bf16 v56, v136, v108
    v_dot2c_f32_bf16 v57, v136, v188
    v_dot2c_f32_bf16 v58, v137, v108
    v_dot2c_f32_bf16 v59, v137, v188
    v_dot2c_f32_bf16 v60, v138, v108
    v_dot2c_f32_bf16 v61, v138, v188
    v_dot2c_f32_bf16 v62, v139, v108
    v_dot2c_f32_bf16 v63, v139, v188
    buffer_load_dwordx4 v[128:131], v2, s[20:23], s25 offen offset:0 nt
    buffer_load_dwordx4 v[132:135], v2, s[20:23], s25 offen offset:128 nt
    buffer_load_dwordx4 v[136:139], v2, s[20:23], s25 offen offset:256 nt
    s_add_u32 s25, s25, 3072
    s_waitcnt vmcnt(12)
    v_lshlrev_b32 v188, 16, v109
    v_dot2c_f32_bf16 v40, v140, v109
    v_dot2c_f32_bf16 v41, v140, v188
    v_dot2c_f32_bf16 v42, v141, v109
    v_dot2c_f32_bf16 v43, v141, v188
    v_dot2c_f32_bf16 v44, v142, v109
    v_dot2c_f32_bf16 v45, v142, v188
    v_dot2c_f32_bf16 v46, v143, v109
    v_dot2c_f32_bf16 v47, v143, v188
    v_dot2c_f32_bf16 v48, v144, v109
    v_dot2c_f32_bf16 v49, v144, v188
    v_dot2c_f32_bf16 v50, v145, v109
    v_dot2c_f32_bf16 v51, v145, v188
    v_dot2c_f32_bf16 v52, v146, v109
    v_dot2c_f32_bf16 v53, v146, v188
    v_dot2c_f32_bf16 v54, v147, v109
    v_dot2c_f32_bf16 v55, v147, v188
    v_dot2c_f32_bf16 v56, v148, v109
    v_dot2c_f32_bf16 v57, v148, v188
    v_dot2c_f32_bf16 v58, v149, v109
    v_dot2c_f32_bf16 v59, v149, v188
    v_dot2c_f32_bf16 v60, v150, v109
    v_dot2c_f32_bf16 v61, v150, v188
    v_dot2c_f32_bf16 v62, v151, v109
    v_dot2c_f32_bf16 v63, v151, v188
    buffer_load_dwordx4 v[140:143], v2, s[20:23], s25 offen offset:0 nt
    buffer_load_dwordx4 v[144:147], v2, s[20:23], s25 offen offset:128 nt
    buffer_load_dwordx4 v[148:151], v2, s[20:23], s25 offen offset:256 nt
    s_add_u32 s25, s25, 3072
    s_waitcnt vmcnt(12)
    v_lshlrev_b32 v188, 16, v110
    v_dot2c_f32_bf16 v40, v152, v110
    v_dot2c_f32_bf16 v41, v152, v188
    v_dot2c_f32_bf16 v42, v153, v110
    v_dot2c_f32_bf16 v43, v153, v188
    v_dot2c_f32_bf16 v44, v154, v110
    v_dot2c_f32_bf16 v45, v154, v188
    v_dot2c_f32_bf16 v46, v155, v110
    v_dot2c_f32_bf16 v47, v155, v188
    v_dot2c_f32_bf16 v48, v156, v110
    v_dot2c_f32_bf16 v49, v156, v188
    v_dot2c_f32_bf16 v50, v157, v110
    v_dot2c_f32_bf16 v51, v157, v188
    v_dot2c_f32_bf16 v52, v158, v110
    v_dot2c_f32_bf16 v53, v158, v188
    v_dot2c_f32_bf16 v54, v159, v110
    v_dot2c_f32_bf16 v55, v159, v188
    v_dot2c_f32_bf16 v56, v160, v110
    v_dot2c_f32_bf16 v57, v160, v188
    v_dot2c_f32_bf16 v58, v161, v110
    v_dot2c_f32_bf16 v59, v161, v188
    v_dot2c_f32_bf16 v60, v162, v110
    v_dot2c_f32_bf16 v61, v162, v188
    v_dot2c_f32_bf16 v62, v163, v110
    v_dot2c_f32_bf16 v63, v163, v188
    buffer_load_dwordx4 v[152:155], v2, s[20:23], s25 offen offset:0 nt
    buffer_load_dwordx4 v[156:159], v2, s[20:23], s25 offen offset:128 nt
    buffer_load_dwordx4 v[160:163], v2, s[20:23], s25 offen offset:256 nt
    s_add_u32 s25, s25, 3072
    s_waitcnt vmcnt(12)
    v_lshlrev_b32 v188, 16, v111
    v_dot2c_f32_bf16 v40, v164, v111
    v_dot2c_f32_bf16 v41, v164, v188
    v_dot2c_f32_bf16 v42, v165, v111
    v_dot2c_f32_bf16 v43, v165, v188
    v_dot2c_f32_bf16 v44, v166, v111
    v_dot2c_f32_bf16 v45, v166, v188
    v_dot2c_f32_bf16 v46, v167, v111
    v_dot2c_f32_bf16 v47, v167, v188
    v_dot2c_f32_bf16 v48, v168, v111
    v_dot2c_f32_bf16 v49, v168, v188
    v_dot2c_f32_bf16 v50, v169, v111
    v_dot2c_f32_bf16 v51, v169, v188
    v_dot2c_f32_bf16 v52, v170, v111
    v_dot2c_f32_bf16 v53, v170, v188
    v_dot2c_f32_bf16 v54, v171, v111
    v_dot2c_f32_bf16 v55, v171, v188
    v_dot2c_f32_bf16 v56, v172, v111
    v_dot2c_f32_bf16 v57, v172, v188
    v_dot2c_f32_bf16 v58, v173, v111
    v_dot2c_f32_bf16 v59, v173, v188
    v_dot2c_f32_bf16 v60, v174, v111
    v_dot2c_f32_bf16 v61, v174, v188
    v_dot2c_f32_bf16 v62, v175, v111
    v_dot2c_f32_bf16 v63, v175, v188
    buffer_load_dwordx4 v[164:167], v2, s[20:23], s25 offen offset:0 nt
    buffer_load_dwordx4 v[168:171], v2, s[20:23], s25 offen offset:128 nt
    buffer_load_dwordx4 v[172:175], v2, s[20:23], s25 offen offset:256 nt
    s_add_u32 s25, s25, 3072
    s_waitcnt vmcnt(12)
    v_lshlrev_b32 v188, 16, v112
    v_dot2c_f32_bf16 v40, v176, v112
    v_dot2c_f32_bf16 v41, v176, v188
    v_dot2c_f32_bf16 v42, v177, v112
    v_dot2c_f32_bf16 v43, v177, v188
    v_dot2c_f32_bf16 v44, v178, v112
    v_dot2c_f32_bf16 v45, v178, v188
    v_dot2c_f32_bf16 v46, v179, v112
    v_dot2c_f32_bf16 v47, v179, v188
    v_dot2c_f32_bf16 v48, v180, v112
    v_dot2c_f32_bf16 v49, v180, v188
    v_dot2c_f32_bf16 v50, v181, v112
    v_dot2c_f32_bf16 v51, v181, v188
    v_dot2c_f32_bf16 v52, v182, v112
    v_dot2c_f32_bf16 v53, v182, v188
    v_dot2c_f32_bf16 v54, v183, v112
    v_dot2c_f32_bf16 v55, v183, v188
    v_dot2c_f32_bf16 v56, v184, v112
    v_dot2c_f32_bf16 v57, v184, v188
    v_dot2c_f32_bf16 v58, v185, v112
    v_dot2c_f32_bf16 v59, v185, v188
    v_dot2c_f32_bf16 v60, v186, v112
    v_dot2c_f32_bf16 v61, v186, v188
    v_dot2c_f32_bf16 v62, v187, v112
    v_dot2c_f32_bf16 v63, v187, v188
    buffer_load_dwordx4 v[176:179], v2, s[20:23], s25 offen offset:0 nt
    buffer_load_dwordx4 v[180:183], v2, s[20:23], s25 offen offset:128 nt
    buffer_load_dwordx4 v[184:187], v2, s[20:23], s25 offen offset:256 nt
    s_add_u32 s25, s25, 3072
    s_waitcnt vmcnt(12)
    v_lshlrev_b32 v188, 16, v113
    v_dot2c_f32_bf16 v40, v128, v113
    v_dot2c_f32_bf16 v41, v128, v188
    v_dot2c_f32_bf16 v42, v129, v113
    v_dot2c_f32_bf16 v43, v129, v188
    v_dot2c_f32_bf16 v44, v130, v113
    v_dot2c_f32_bf16 v45, v130, v188
    v_dot2c_f32_bf16 v46, v131, v113
    v_dot2c_f32_bf16 v47, v131, v188
    v_dot2c_f32_bf16 v48, v132, v113
    v_dot2c_f32_bf16 v49, v132, v188
    v_dot2c_f32_bf16 v50, v133, v113
    v_dot2c_f32_bf16 v51, v133, v188
    v_dot2c_f32_bf16 v52, v134, v113
    v_dot2c_f32_bf16 v53, v134, v188
    v_dot2c_f32_bf16 v54, v135, v113
    v_dot2c_f32_bf16 v55, v135, v188
    v_dot2c_f32_bf16 v56, v136, v113
    v_dot2c_f32_bf16 v57, v136, v188
    v_dot2c_f32_bf16 v58, v137, v113
    v_dot2c_f32_bf16 v59, v137, v188
    v_dot2c_f32_bf16 v60, v138, v113
    v_dot2c_f32_bf16 v61, v138, v188
    v_dot2c_f32_bf16 v62, v139, v113
    v_dot2c_f32_bf16 v63, v139, v188
    buffer_load_dwordx4 v[128:131], v2, s[20:23], s25 offen offset:0 nt
    buffer_load_dwordx4 v[132:135], v2, s[20:23], s25 offen offset:128 nt
    buffer_load_dwordx4 v[136:139], v2, s[20:23], s25 offen offset:256 nt
    s_add_u32 s25, s25, 3072
    s_waitcnt vmcnt(12)
    v_lshlrev_b32 v188, 16, v114
    v_dot2c_f32_bf16 v40, v140, v114
    v_dot2c_f32_bf16 v41, v140, v188
    v_dot2c_f32_bf16 v42, v141, v114
    v_dot2c_f32_bf16 v43, v141, v188
    v_dot2c_f32_bf16 v44, v142, v114
    v_dot2c_f32_bf16 v45, v142, v188
    v_dot2c_f32_bf16 v46, v143, v114
    v_dot2c_f32_bf16 v47, v143, v188
    v_dot2c_f32_bf16 v48, v144, v114
    v_dot2c_f32_bf16 v49, v144, v188
    v_dot2c_f32_bf16 v50, v145, v114
    v_dot2c_f32_bf16 v51, v145, v188
    v_dot2c_f32_bf16 v52, v146, v114
    v_dot2c_f32_bf16 v53, v146, v188
    v_dot2c_f32_bf16 v54, v147, v114
    v_dot2c_f32_bf16 v55, v147, v188
    v_dot2c_f32_bf16 v56, v148, v114
    v_dot2c_f32_bf16 v57, v148, v188
    v_dot2c_f32_bf16 v58, v149, v114
    v_dot2c_f32_bf16 v59, v149, v188
    v_dot2c_f32_bf16 v60, v150, v114
    v_dot2c_f32_bf16 v61, v150, v188
    v_dot2c_f32_bf16 v62, v151, v114
    v_dot2c_f32_bf16 v63, v151, v188
    buffer_load_dwordx4 v[140:143], v2, s[20:23], s25 offen offset:0 nt
    buffer_load_dwordx4 v[144:147], v2, s[20:23], s25 offen offset:128 nt
    buffer_load_dwordx4 v[148:151], v2, s[20:23], s25 offen offset:256 nt
    s_add_u32 s25, s25, 3072
    s_waitcnt vmcnt(12)
    v_lshlrev_b32 v188, 16, v115
    v_dot2c_f32_bf16 v40, v152, v115
    v_dot2c_f32_bf16 v41, v152, v188
    v_dot2c_f32_bf16 v42, v153, v115
    v_dot2c_f32_bf16 v43, v153, v188
    v_dot2c_f32_bf16 v44, v154, v115
    v_dot2c_f32_bf16 v45, v154, v188
    v_dot2c_f32_bf16 v46, v155, v115
    v_dot2c_f32_bf16 v47, v155, v188
    v_dot2c_f32_bf16 v48, v156, v115
    v_dot2c_f32_bf16 v49, v156, v188
    v_dot2c_f32_bf16 v50, v157, v115
    v_dot2c_f32_bf16 v51, v157, v188
    v_dot2c_f32_bf16 v52, v158, v115
    v_dot2c_f32_bf16 v53, v158, v188
    v_dot2c_f32_bf16 v54, v159, v115
    v_dot2c_f32_bf16 v55, v159, v188
    v_dot2c_f32_bf16 v56, v160, v115
    v_dot2c_f32_bf16 v57, v160, v188
    v_dot2c_f32_bf16 v58, v161, v115
    v_dot2c_f32_bf16 v59, v161, v188
    v_dot2c_f32_bf16 v60, v162, v115
    v_dot2c_f32_bf16 v61, v162, v188
    v_dot2c_f32_bf16 v62, v163, v115
    v_dot2c_f32_bf16 v63, v163, v188
    buffer_load_dwordx4 v[152:155], v2, s[20:23], s25 offen offset:0 nt
    buffer_load_dwordx4 v[156:159], v2, s[20:23], s25 offen offset:128 nt
    buffer_load_dwordx4 v[160:163], v2, s[20:23], s25 offen offset:256 nt
    s_add_u32 s25, s25, 3072
    s_waitcnt vmcnt(12)
    v_lshlrev_b32 v188, 16, v116
    v_dot2c_f32_bf16 v40, v164, v116
    v_dot2c_f32_bf16 v41, v164, v188
    v_dot2c_f32_bf16 v42, v165, v116
    v_dot2c_f32_bf16 v43, v165, v188
    v_dot2c_f32_bf16 v44, v166, v116
    v_dot2c_f32_bf16 v45, v166, v188
    v_dot2c_f32_bf16 v46, v167, v116
    v_dot2c_f32_bf16 v47, v167, v188
    v_dot2c_f32_bf16 v48, v168, v116
    v_dot2c_f32_bf16 v49, v168, v188
    v_dot2c_f32_bf16 v50, v169, v116
    v_dot2c_f32_bf16 v51, v169, v188
    v_dot2c_f32_bf16 v52, v170, v116
    v_dot2c_f32_bf16 v53, v170, v188
    v_dot2c_f32_bf16 v54, v171, v116
    v_dot2c_f32_bf16 v55, v171, v188
    v_dot2c_f32_bf16 v56, v172, v116
    v_dot2c_f32_bf16 v57, v172, v188
    v_dot2c_f32_bf16 v58, v173, v116
    v_dot2c_f32_bf16 v59, v173, v188
    v_dot2c_f32_bf16 v60, v174, v116
    v_dot2c_f32_bf16 v61, v174, v188
    v_dot2c_f32_bf16 v62, v175, v116
    v_dot2c_f32_bf16 v63, v175, v188
    buffer_load_dwordx4 v[164:167], v2, s[20:23], s25 offen offset:0 nt
    buffer_load_dwordx4 v[168:171], v2, s[20:23], s25 offen offset:128 nt
    buffer_load_dwordx4 v[172:175], v2, s[20:23], s25 offen offset:256 nt
    s_add_u32 s25, s25, 3072
    s_cmp_lg_u32 s12, 0
    s_cbranch_scc1 L_NOGL
    v_mul_u32_u24 v13, 13440, v0
    v_mov_b32 v64, 0
    v_cmp_eq_u32 vcc, 8, v12
    s_nop 1
    s_cmp_eq_u64 vcc, exec
    s_cbranch_scc0 L_NOGL
    v_add_u32 v189, 0, v13
    global_load_dwordx4 v[64:67], v189, s[88:89] offset:96 sc1
    v_add_u32 v189, 860160, v13
    global_load_dwordx4 v[68:71], v189, s[88:89] offset:96 sc1
    v_add_u32 v189, 1720320, v13
    global_load_dwordx4 v[72:75], v189, s[88:89] offset:96 sc1
    v_add_u32 v189, 2580480, v13
    global_load_dwordx4 v[76:79], v189, s[88:89] offset:96 sc1
L_NOGL:
    s_waitcnt vmcnt(12)
    v_lshlrev_b32 v188, 16, v117
    v_dot2c_f32_bf16 v40, v176, v117
    v_dot2c_f32_bf16 v41, v176, v188
    v_dot2c_f32_bf16 v42, v177, v117
    v_dot2c_f32_bf16 v43, v177, v188
    v_dot2c_f32_bf16 v44, v178, v117
    v_dot2c_f32_bf16 v45, v178, v188
    v_dot2c_f32_bf16 v46, v179, v117
    v_dot2c_f32_bf16 v47, v179, v188
    v_dot2c_f32_bf16 v48, v180, v117
    v_dot2c_f32_bf16 v49, v180, v188
    v_dot2c_f32_bf16 v50, v181, v117
    v_dot2c_f32_bf16 v51, v181, v188
    v_dot2c_f32_bf16 v52, v182, v117
    v_dot2c_f32_bf16 v53, v182, v188
    v_dot2c_f32_bf16 v54, v183, v117
    v_dot2c_f32_bf16 v55, v183, v188
    v_dot2c_f32_bf16 v56, v184, v117
    v_dot2c_f32_bf16 v57, v184, v188
    v_dot2c_f32_bf16 v58, v185, v117
    v_dot2c_f32_bf16 v59, v185, v188
    v_dot2c_f32_bf16 v60, v186, v117
    v_dot2c_f32_bf16 v61, v186, v188
    v_dot2c_f32_bf16 v62, v187, v117
    v_dot2c_f32_bf16 v63, v187, v188
    buffer_load_dwordx4 v[176:179], v2, s[20:23], s25 offen offset:0 nt
    buffer_load_dwordx4 v[180:183], v2, s[20:23], s25 offen offset:128 nt
    buffer_load_dwordx4 v[184:187], v2, s[20:23], s25 offen offset:256 nt
    s_add_u32 s25, s25, 3072
    s_waitcnt vmcnt(12)
    v_lshlrev_b32 v188, 16, v118
    v_dot2c_f32_bf16 v40, v128, v118
    v_dot2c_f32_bf16 v41, v128, v188
    v_dot2c_f32_bf16 v42, v129, v118
    v_dot2c_f32_bf16 v43, v129, v188
    v_dot2c_f32_bf16 v44, v130, v118
    v_dot2c_f32_bf16 v45, v130, v188
    v_dot2c_f32_bf16 v46, v131, v118
    v_dot2c_f32_bf16 v47, v131, v188
    v_dot2c_f32_bf16 v48, v132, v118
    v_dot2c_f32_bf16 v49, v132, v188
    v_dot2c_f32_bf16 v50, v133, v118
    v_dot2c_f32_bf16 v51, v133, v188
    v_dot2c_f32_bf16 v52, v134, v118
    v_dot2c_f32_bf16 v53, v134, v188
    v_dot2c_f32_bf16 v54, v135, v118
    v_dot2c_f32_bf16 v55, v135, v188
    v_dot2c_f32_bf16 v56, v136, v118
    v_dot2c_f32_bf16 v57, v136, v188
    v_dot2c_f32_bf16 v58, v137, v118
    v_dot2c_f32_bf16 v59, v137, v188
    v_dot2c_f32_bf16 v60, v138, v118
    v_dot2c_f32_bf16 v61, v138, v188
    v_dot2c_f32_bf16 v62, v139, v118
    v_dot2c_f32_bf16 v63, v139, v188
    buffer_load_dwordx4 v[128:131], v2, s[20:23], s25 offen offset:0 nt
    buffer_load_dwordx4 v[132:135], v2, s[20:23], s25 offen offset:128 nt
    buffer_load_dwordx4 v[136:139], v2, s[20:23], s25 offen offset:256 nt
    s_add_u32 s25, s25, 3072
    s_waitcnt vmcnt(12)
    v_lshlrev_b32 v188, 16, v119
    v_dot2c_f32_bf16 v40, v140, v119
    v_dot2c_f32_bf16 v41, v140, v188
    v_dot2c_f32_bf16 v42, v141, v119
    v_dot2c_f32_bf16 v43, v141, v188
    v_dot2c_f32_bf16 v44, v142, v119
    v_dot2c_f32_bf16 v45, v142, v188
    v_dot2c_f32_bf16 v46, v143, v119
    v_dot2c_f32_bf16 v47, v143, v188
    v_dot2c_f32_bf16 v48, v144, v119
    v_dot2c_f32_bf16 v49, v144, v188
    v_dot2c_f32_bf16 v50, v145, v119
    v_dot2c_f32_bf16 v51, v145, v188
    v_dot2c_f32_bf16 v52, v146, v119
    v_dot2c_f32_bf16 v53, v146, v188
    v_dot2c_f32_bf16 v54, v147, v119
    v_dot2c_f32_bf16 v55, v147, v188
    v_dot2c_f32_bf16 v56, v148, v119
    v_dot2c_f32_bf16 v57, v148, v188
    v_dot2c_f32_bf16 v58, v149, v119
    v_dot2c_f32_bf16 v59, v149, v188
    v_dot2c_f32_bf16 v60, v150, v119
    v_dot2c_f32_bf16 v61, v150, v188
    v_dot2c_f32_bf16 v62, v151, v119
    v_dot2c_f32_bf16 v63, v151, v188
    buffer_load_dwordx4 v[140:143], v2, s[20:23], s25 offen offset:0 nt
    buffer_load_dwordx4 v[144:147], v2, s[20:23], s25 offen offset:128 nt
    buffer_load_dwordx4 v[148:151], v2, s[20:23], s25 offen offset:256 nt
    s_add_u32 s25, s25, 3072
    s_waitcnt vmcnt(12)
    v_lshlrev_b32 v188, 16, v120
    v_dot2c_f32_bf16 v40, v152, v120
    v_dot2c_f32_bf16 v41, v152, v188
    v_dot2c_f32_bf16 v42, v153, v120
    v_dot2c_f32_bf16 v43, v153, v188
    v_dot2c_f32_bf16 v44, v154, v120
    v_dot2c_f32_bf16 v45, v154, v188
    v_dot2c_f32_bf16 v46, v155, v120
    v_dot2c_f32_bf16 v47, v155, v188
    v_dot2c_f32_bf16 v48, v156, v120
    v_dot2c_f32_bf16 v49, v156, v188
    v_dot2c_f32_bf16 v50, v157, v120
    v_dot2c_f32_bf16 v51, v157, v188
    v_dot2c_f32_bf16 v52, v158, v120
    v_dot2c_f32_bf16 v53, v158, v188
    v_dot2c_f32_bf16 v54, v159, v120
    v_dot2c_f32_bf16 v55, v159, v188
    v_dot2c_f32_bf16 v56, v160, v120
    v_dot2c_f32_bf16 v57, v160, v188
    v_dot2c_f32_bf16 v58, v161, v120
    v_dot2c_f32_bf16 v59, v161, v188
    v_dot2c_f32_bf16 v60, v162, v120
    v_dot2c_f32_bf16 v61, v162, v188
    v_dot2c_f32_bf16 v62, v163, v120
    v_dot2c_f32_bf16 v63, v163, v188
    buffer_load_dwordx4 v[152:155], v2, s[20:23], s25 offen offset:0 nt
    buffer_load_dwordx4 v[156:159], v2, s[20:23], s25 offen offset:128 nt
    buffer_load_dwordx4 v[160:163], v2, s[20:23], s25 offen offset:256 nt
    s_add_u32 s25, s25, 3072
    s_waitcnt vmcnt(12)
    v_lshlrev_b32 v188, 16, v121
    v_dot2c_f32_bf16 v40, v164, v121
    v_dot2c_f32_bf16 v41, v164, v188
    v_dot2c_f32_bf16 v42, v165, v121
    v_dot2c_f32_bf16 v43, v165, v188
    v_dot2c_f32_bf16 v44, v166, v121
    v_dot2c_f32_bf16 v45, v166, v188
    v_dot2c_f32_bf16 v46, v167, v121
    v_dot2c_f32_bf16 v47, v167, v188
    v_dot2c_f32_bf16 v48, v168, v121
    v_dot2c_f32_bf16 v49, v168, v188
    v_dot2c_f32_bf16 v50, v169, v121
    v_dot2c_f32_bf16 v51, v169, v188
    v_dot2c_f32_bf16 v52, v170, v121
    v_dot2c_f32_bf16 v53, v170, v188
    v_dot2c_f32_bf16 v54, v171, v121
    v_dot2c_f32_bf16 v55, v171, v188
    v_dot2c_f32_bf16 v56, v172, v121
    v_dot2c_f32_bf16 v57, v172, v188
    v_dot2c_f32_bf16 v58, v173, v121
    v_dot2c_f32_bf16 v59, v173, v188
    v_dot2c_f32_bf16 v60, v174, v121
    v_dot2c_f32_bf16 v61, v174, v188
    v_dot2c_f32_bf16 v62, v175, v121
    v_dot2c_f32_bf16 v63, v175, v188
    buffer_load_dwordx4 v[164:167], v2, s[20:23], s25 offen offset:0 nt
    buffer_load_dwordx4 v[168:171], v2, s[20:23], s25 offen offset:128 nt
    buffer_load_dwordx4 v[172:175], v2, s[20:23], s25 offen offset:256 nt
    s_add_u32 s25, s25, 3072
    s_waitcnt vmcnt(12)
    v_lshlrev_b32 v188, 16, v122
    v_dot2c_f32_bf16 v40, v176, v122
    v_dot2c_f32_bf16 v41, v176, v188
    v_dot2c_f32_bf16 v42, v177, v122
    v_dot2c_f32_bf16 v43, v177, v188
    v_dot2c_f32_bf16 v44, v178, v122
    v_dot2c_f32_bf16 v45, v178, v188
    v_dot2c_f32_bf16 v46, v179, v122
    v_dot2c_f32_bf16 v47, v179, v188
    v_dot2c_f32_bf16 v48, v180, v122
    v_dot2c_f32_bf16 v49, v180, v188
    v_dot2c_f32_bf16 v50, v181, v122
    v_dot2c_f32_bf16 v51, v181, v188
    v_dot2c_f32_bf16 v52, v182, v122
    v_dot2c_f32_bf16 v53, v182, v188
    v_dot2c_f32_bf16 v54, v183, v122
    v_dot2c_f32_bf16 v55, v183, v188
    v_dot2c_f32_bf16 v56, v184, v122
    v_dot2c_f32_bf16 v57, v184, v188
    v_dot2c_f32_bf16 v58, v185, v122
    v_dot2c_f32_bf16 v59, v185, v188
    v_dot2c_f32_bf16 v60, v186, v122
    v_dot2c_f32_bf16 v61, v186, v188
    v_dot2c_f32_bf16 v62, v187, v122
    v_dot2c_f32_bf16 v63, v187, v188
    buffer_load_dwordx4 v[176:179], v2, s[20:23], s25 offen offset:0 nt
    buffer_load_dwordx4 v[180:183], v2, s[20:23], s25 offen offset:128 nt
    buffer_load_dwordx4 v[184:187], v2, s[20:23], s25 offen offset:256 nt
    s_mov_b32 s25, 100663296
    s_waitcnt vmcnt(12)
    v_lshlrev_b32 v188, 16, v123
    v_dot2c_f32_bf16 v40, v128, v123
    v_dot2c_f32_bf16 v41, v128, v188
    v_dot2c_f32_bf16 v42, v129, v123
    v_dot2c_f32_bf16 v43, v129, v188
    v_dot2c_f32_bf16 v44, v130, v123
    v_dot2c_f32_bf16 v45, v130, v188
    v_dot2c_f32_bf16 v46, v131, v123
    v_dot2c_f32_bf16 v47, v131, v188
    v_dot2c_f32_bf16 v48, v132, v123
    v_dot2c_f32_bf16 v49, v132, v188
    v_dot2c_f32_bf16 v50, v133, v123
    v_dot2c_f32_bf16 v51, v133, v188
    v_dot2c_f32_bf16 v52, v134, v123
    v_dot2c_f32_bf16 v53, v134, v188
    v_dot2c_f32_bf16 v54, v135, v123
    v_dot2c_f32_bf16 v55, v135, v188
    v_dot2c_f32_bf16 v56, v136, v123
    v_dot2c_f32_bf16 v57, v136, v188
    v_dot2c_f32_bf16 v58, v137, v123
    v_dot2c_f32_bf16 v59, v137, v188
    v_dot2c_f32_bf16 v60, v138, v123
    v_dot2c_f32_bf16 v61, v138, v188
    v_dot2c_f32_bf16 v62, v139, v123
    v_dot2c_f32_bf16 v63, v139, v188
    buffer_load_dwordx4 a[0:3], v6, s[32:35], s27 offen nt
    s_add_u32 s27, s27, 1280
    buffer_load_dwordx4 a[4:7], v6, s[32:35], s27 offen nt
    s_add_u32 s27, s27, 1280
    buffer_load_dwordx4 a[8:11], v6, s[32:35], s27 offen nt
    s_add_u32 s27, s27, 1280
    buffer_load_dwordx4 a[12:15], v6, s[32:35], s27 offen nt
    s_add_u32 s27, s27, 1280
    s_waitcnt vmcnt(13)
    v_lshlrev_b32 v188, 16, v124
    v_dot2c_f32_bf16 v40, v140, v124
    v_dot2c_f32_bf16 v41, v140, v188
    v_dot2c_f32_bf16 v42, v141, v124
    v_dot2c_f32_bf16 v43, v141, v188
    v_dot2c_f32_bf16 v44, v142, v124
    v_dot2c_f32_bf16 v45, v142, v188
    v_dot2c_f32_bf16 v46, v143, v124
    v_dot2c_f32_bf16 v47, v143, v188
    v_dot2c_f32_bf16 v48, v144, v124
    v_dot2c_f32_bf16 v49, v144, v188
    v_dot2c_f32_bf16 v50, v145, v124
    v_dot2c_f32_bf16 v51, v145, v188
    v_dot2c_f32_bf16 v52, v146, v124
    v_dot2c_f32_bf16 v53, v146, v188
    v_dot2c_f32_bf16 v54, v147, v124
    v_dot2c_f32_bf16 v55, v147, v188
    v_dot2c_f32_bf16 v56, v148, v124
    v_dot2c_f32_bf16 v57, v148, v188
    v_dot2c_f32_bf16 v58, v149, v124
    v_dot2c_f32_bf16 v59, v149, v188
    v_dot2c_f32_bf16 v60, v150, v124
    v_dot2c_f32_bf16 v61, v150, v188
    v_dot2c_f32_bf16 v62, v151, v124
    v_dot2c_f32_bf16 v63, v151, v188
    buffer_load_dwordx4 a[16:19], v6, s[32:35], s27 offen nt
    s_add_u32 s27, s27, 1280
    buffer_load_dwordx4 a[20:23], v6, s[32:35], s27 offen nt
    s_add_u32 s27, s27, 1280
    buffer_load_dwordx4 a[24:27], v6, s[32:35], s27 offen nt
    s_add_u32 s27, s27, 1280
    buffer_load_dwordx4 a[28:31], v6, s[32:35], s27 offen nt
    s_add_u32 s27, s27, 1280
    s_waitcnt vmcnt(14)
    v_lshlrev_b32 v188, 16, v125
    v_dot2c_f32_bf16 v40, v152, v125
    v_dot2c_f32_bf16 v41, v152, v188
    v_dot2c_f32_bf16 v42, v153, v125
    v_dot2c_f32_bf16 v43, v153, v188
    v_dot2c_f32_bf16 v44, v154, v125
    v_dot2c_f32_bf16 v45, v154, v188
    v_dot2c_f32_bf16 v46, v155, v125
    v_dot2c_f32_bf16 v47, v155, v188
    v_dot2c_f32_bf16 v48, v156, v125
    v_dot2c_f32_bf16 v49, v156, v188
    v_dot2c_f32_bf16 v50, v157, v125
    v_dot2c_f32_bf16 v51, v157, v188
    v_dot2c_f32_bf16 v52, v158, v125
    v_dot2c_f32_bf16 v53, v158, v188
    v_dot2c_f32_bf16 v54, v159, v125
    v_dot2c_f32_bf16 v55, v159, v188
    v_dot2c_f32_bf16 v56, v160, v125
    v_dot2c_f32_bf16 v57, v160, v188
    v_dot2c_f32_bf16 v58, v161, v125
    v_dot2c_f32_bf16 v59, v161, v188
    v_dot2c_f32_bf16 v60, v162, v125
    v_dot2c_f32_bf16 v61, v162, v188
    v_dot2c_f32_bf16 v62, v163, v125
    v_dot2c_f32_bf16 v63, v163, v188
    global_load_dwordx4 a[32:35], v7, s[76:77]
    global_load_dwordx4 a[36:39], v8, s[76:77]
    global_load_dwordx4 a[40:43], v9, s[76:77]
    global_load_dwordx4 a[44:47], v10, s[80:81] offset:0 nt
    s_waitcnt vmcnt(15)
    v_lshlrev_b32 v188, 16, v126
    v_dot2c_f32_bf16 v40, v164, v126
    v_dot2c_f32_bf16 v41, v164, v188
    v_dot2c_f32_bf16 v42, v165, v126
    v_dot2c_f32_bf16 v43, v165, v188
    v_dot2c_f32_bf16 v44, v166, v126
    v_dot2c_f32_bf16 v45, v166, v188
    v_dot2c_f32_bf16 v46, v167, v126
    v_dot2c_f32_bf16 v47, v167, v188
    v_dot2c_f32_bf16 v48, v168, v126
    v_dot2c_f32_bf16 v49, v168, v188
    v_dot2c_f32_bf16 v50, v169, v126
    v_dot2c_f32_bf16 v51, v169, v188
    v_dot2c_f32_bf16 v52, v170, v126
    v_dot2c_f32_bf16 v53, v170, v188
    v_dot2c_f32_bf16 v54, v171, v126
    v_dot2c_f32_bf16 v55, v171, v188
    v_dot2c_f32_bf16 v56, v172, v126
    v_dot2c_f32_bf16 v57, v172, v188
    v_dot2c_f32_bf16 v58, v173, v126
    v_dot2c_f32_bf16 v59, v173, v188
    v_dot2c_f32_bf16 v60, v174, v126
    v_dot2c_f32_bf16 v61, v174, v188
    v_dot2c_f32_bf16 v62, v175, v126
    v_dot2c_f32_bf16 v63, v175, v188
    global_load_dwordx4 a[48:51], v10, s[80:81] offset:1280 nt
    global_load_dwordx4 a[52:55], v10, s[80:81] offset:2560 nt
    v_add_u32 v10, 3840, v10
    global_load_dwordx4 a[56:59], v10, s[80:81] offset:0 nt
    global_load_dwordx4 a[60:63], v10, s[80:81] offset:1280 nt
    s_waitcnt vmcnt(16)
    v_lshlrev_b32 v188, 16, v127
    v_dot2c_f32_bf16 v40, v176, v127
    v_dot2c_f32_bf16 v41, v176, v188
    v_dot2c_f32_bf16 v42, v177, v127
    v_dot2c_f32_bf16 v43, v177, v188
    v_dot2c_f32_bf16 v44, v178, v127
    v_dot2c_f32_bf16 v45, v178, v188
    v_dot2c_f32_bf16 v46, v179, v127
    v_dot2c_f32_bf16 v47, v179, v188
    v_dot2c_f32_bf16 v48, v180, v127
    v_dot2c_f32_bf16 v49, v180, v188
    v_dot2c_f32_bf16 v50, v181, v127
    v_dot2c_f32_bf16 v51, v181, v188
    v_dot2c_f32_bf16 v52, v182, v127
    v_dot2c_f32_bf16 v53, v182, v188
    v_dot2c_f32_bf16 v54, v183, v127
    v_dot2c_f32_bf16 v55, v183, v188
    v_dot2c_f32_bf16 v56, v184, v127
    v_dot2c_f32_bf16 v57, v184, v188
    v_dot2c_f32_bf16 v58, v185, v127
    v_dot2c_f32_bf16 v59, v185, v188
    v_dot2c_f32_bf16 v60, v186, v127
    v_dot2c_f32_bf16 v61, v186, v188
    v_dot2c_f32_bf16 v62, v187, v127
    v_dot2c_f32_bf16 v63, v187, v188
    global_load_dwordx4 a[64:67], v10, s[80:81] offset:2560 nt
    v_add_u32 v10, 3840, v10
    global_load_dwordx4 a[68:71], v10, s[80:81] offset:0 nt
    global_load_dwordx4 a[72:75], v10, s[80:81] offset:1280 nt
    s_nop 3
    v_add_f32_dpp v16, v16, v16 row_ror:8 row_mask:0xf bank_mask:0xf
    v_add_f32_dpp v17, v17, v17 row_ror:8 row_mask:0xf bank_mask:0xf
    v_add_f32_dpp v18, v18, v18 row_ror:8 row_mask:0xf bank_mask:0xf
    v_add_f32_dpp v19, v19, v19 row_ror:8 row_mask:0xf bank_mask:0xf
    v_add_f32_dpp v20, v20, v20 row_ror:8 row_mask:0xf bank_mask:0xf
    v_add_f32_dpp v21, v21, v21 row_ror:8 row_mask:0xf bank_mask:0xf
    v_add_f32_dpp v22, v22, v22 row_ror:8 row_mask:0xf bank_mask:0xf
    v_add_f32_dpp v23, v23, v23 row_ror:8 row_mask:0xf bank_mask:0xf
    v_add_f32_dpp v24, v24, v24 row_ror:8 row_mask:0xf bank_mask:0xf
    v_add_f32_dpp v25, v25, v25 row_ror:8 row_mask:0xf bank_mask:0xf
    v_add_f32_dpp v26, v26, v26 row_ror:8 row_mask:0xf bank_mask:0xf
    v_add_f32_dpp v27, v27, v27 row_ror:8 row_mask:0xf bank_mask:0xf
    v_add_f32_dpp v28, v28, v28 row_ror:8 row_mask:0xf bank_mask:0xf
    v_add_f32_dpp v29, v29, v29 row_ror:8 row_mask:0xf bank_mask:0xf
    v_add_f32_dpp v30, v30, v30 row_ror:8 row_mask:0xf bank_mask:0xf
    v_add_f32_dpp v31, v31, v31 row_ror:8 row_mask:0xf bank_mask:0xf
    v_add_f32_dpp v32, v32, v32 row_ror:8 row_mask:0xf bank_mask:0xf
    v_add_f32_dpp v33, v33, v33 row_ror:8 row_mask:0xf bank_mask:0xf
    v_add_f32_dpp v34, v34, v34 row_ror:8 row_mask:0xf bank_mask:0xf
    v_add_f32_dpp v35, v35, v35 row_ror:8 row_mask:0xf bank_mask:0xf
    v_add_f32_dpp v36, v36, v36 row_ror:8 row_mask:0xf bank_mask:0xf
    v_add_f32_dpp v37, v37, v37 row_ror:8 row_mask:0xf bank_mask:0xf
    v_add_f32_dpp v38, v38, v38 row_ror:8 row_mask:0xf bank_mask:0xf
    v_add_f32_dpp v39, v39, v39 row_ror:8 row_mask:0xf bank_mask:0xf
    v_add_f32_dpp v40, v40, v40 row_ror:8 row_mask:0xf bank_mask:0xf
    v_add_f32_dpp v41, v41, v41 row_ror:8 row_mask:0xf bank_mask:0xf
    v_add_f32_dpp v42, v42, v42 row_ror:8 row_mask:0xf bank_mask:0xf
    v_add_f32_dpp v43, v43, v43 row_ror:8 row_mask:0xf bank_mask:0xf
    v_add_f32_dpp v44, v44, v44 row_ror:8 row_mask:0xf bank_mask:0xf
    v_add_f32_dpp v45, v45, v45 row_ror:8 row_mask:0xf bank_mask:0xf
    v_add_f32_dpp v46, v46, v46 row_ror:8 row_mask:0xf bank_mask:0xf
    v_add_f32_dpp v47, v47, v47 row_ror:8 row_mask:0xf bank_mask:0xf
    v_add_f32_dpp v48, v48, v48 row_ror:8 row_mask:0xf bank_mask:0xf
    v_add_f32_dpp v49, v49, v49 row_ror:8 row_mask:0xf bank_mask:0xf
    v_add_f32_dpp v50, v50, v50 row_ror:8 row_mask:0xf bank_mask:0xf
    v_add_f32_dpp v51, v51, v51 row_ror:8 row_mask:0xf bank_mask:0xf
    v_add_f32_dpp v52, v52, v52 row_ror:8 row_mask:0xf bank_mask:0xf
    v_add_f32_dpp v53, v53, v53 row_ror:8 row_mask:0xf bank_mask:0xf
    v_add_f32_dpp v54, v54, v54 row_ror:8 row_mask:0xf bank_mask:0xf
    v_add_f32_dpp v55, v55, v55 row_ror:8 row_mask:0xf bank_mask:0xf
    v_add_f32_dpp v56, v56, v56 row_ror:8 row_mask:0xf bank_mask:0xf
    v_add_f32_dpp v57, v57, v57 row_ror:8 row_mask:0xf bank_mask:0xf
    v_add_f32_dpp v58, v58, v58 row_ror:8 row_mask:0xf bank_mask:0xf
    v_add_f32_dpp v59, v59, v59 row_ror:8 row_mask:0xf bank_mask:0xf
    v_add_f32_dpp v60, v60, v60 row_ror:8 row_mask:0xf bank_mask:0xf
    v_add_f32_dpp v61, v61, v61 row_ror:8 row_mask:0xf bank_mask:0xf
    v_add_f32_dpp v62, v62, v62 row_ror:8 row_mask:0xf bank_mask:0xf
    v_add_f32_dpp v63, v63, v63 row_ror:8 row_mask:0xf bank_mask:0xf
    v_lshrrev_b32 v188, 4, v0
    v_mul_u32_u24 v188, 1536, v188
    v_and_b32 v189, 7, v1
    v_lshl_add_u32 v188, v189, 5, v188

    ds_write_b128 v188, v[16:19] offset:6144
    ds_write_b128 v188, v[20:23] offset:6160
    ds_write_b128 v188, v[24:27] offset:6400
    ds_write_b128 v188, v[28:31] offset:6416
    ds_write_b128 v188, v[32:35] offset:6656
    ds_write_b128 v188, v[36:39] offset:6672
    ds_write_b128 v188, v[40:43] offset:6912
    ds_write_b128 v188, v[44:47] offset:6928
    ds_write_b128 v188, v[48:51] offset:7168
    ds_write_b128 v188, v[52:55] offset:7184
    ds_write_b128 v188, v[56:59] offset:7424
    ds_write_b128 v188, v[60:63] offset:7440
    s_waitcnt lgkmcnt(0)
    s_barrier
    v_lshlrev_b32 v188, 2, v0

    ds_read_b32 v16, v188 offset:6144
    ds_read_b32 v17, v188 offset:7680
    ds_read_b32 v18, v188 offset:9216
    ds_read_b32 v19, v188 offset:10752
    ds_read_b32 v20, v188 offset:12288
    ds_read_b32 v21, v188 offset:13824
    ds_read_b32 v22, v188 offset:15360
    ds_read_b32 v23, v188 offset:16896
    ds_read_b32 v24, v188 offset:18432
    ds_read_b32 v25, v188 offset:19968
    ds_read_b32 v26, v188 offset:21504
    ds_read_b32 v27, v188 offset:23040
    ds_read_b32 v28, v188 offset:24576
    ds_read_b32 v29, v188 offset:26112
    ds_read_b32 v30, v188 offset:27648
    ds_read_b32 v31, v188 offset:29184
    s_cmp_ge_u32 s12, 2
    s_cbranch_scc1 L_SP1_o
    ds_read_b32 v32, v188 offset:7168
    ds_read_b32 v33, v188 offset:8704
    ds_read_b32 v34, v188 offset:10240
    ds_read_b32 v35, v188 offset:11776
    ds_read_b32 v36, v188 offset:13312
    ds_read_b32 v37, v188 offset:14848
    ds_read_b32 v38, v188 offset:16384
    ds_read_b32 v39, v188 offset:17920
    ds_read_b32 v40, v188 offset:19456
    ds_read_b32 v41, v188 offset:20992
    ds_read_b32 v42, v188 offset:22528
    ds_read_b32 v43, v188 offset:24064
    ds_read_b32 v44, v188 offset:25600
    ds_read_b32 v45, v188 offset:27136
    ds_read_b32 v46, v188 offset:28672
    ds_read_b32 v47, v188 offset:30208
    s_waitcnt lgkmcnt(0)
    v_add_f32 v32, v32, v40
    v_add_f32 v33, v33, v41
    v_add_f32 v34, v34, v42
    v_add_f32 v35, v35, v43
    v_add_f32 v36, v36, v44
    v_add_f32 v37, v37, v45
    v_add_f32 v38, v38, v46
    v_add_f32 v39, v39, v47
    v_add_f32 v32, v32, v36
    v_add_f32 v33, v33, v37
    v_add_f32 v34, v34, v38
    v_add_f32 v35, v35, v39
    v_add_f32 v32, v32, v34
    v_add_f32 v33, v33, v35
    v_add_f32 v32, v32, v33
    v_or_b32 v32, 1, v32
    v_add_u32 v189, s42, v188
    global_store_dword v189, v32, s[88:89] offset:2672 sc1
L_SP1_o:
    s_waitcnt lgkmcnt(0)
    v_add_f32 v16, v16, v24
    v_add_f32 v17, v17, v25
    v_add_f32 v18, v18, v26
    v_add_f32 v19, v19, v27
    v_add_f32 v20, v20, v28
    v_add_f32 v21, v21, v29
    v_add_f32 v22, v22, v30
    v_add_f32 v23, v23, v31
    v_add_f32 v16, v16, v20
    v_add_f32 v17, v17, v21
    v_add_f32 v18, v18, v22
    v_add_f32 v19, v19, v23
    v_add_f32 v16, v16, v18
    v_add_f32 v17, v17, v19
    v_add_f32 v16, v16, v17
    v_or_b32 v16, 1, v16
    v_add_u32 v189, s42, v188
    global_store_dword v189, v16, s[88:89] offset:1648 sc1
    s_cmp_lg_u32 s12, 0
    s_cbranch_scc1 L_A_SKIP
L_GCHK:
    s_waitcnt vmcnt(0)
    v_and_b32 v190, v64, v65
    v_and_b32 v190, v190, v66
    v_and_b32 v190, v190, v67
    v_and_b32 v190, v190, v68
    v_and_b32 v190, v190, v69
    v_and_b32 v190, v190, v70
    v_and_b32 v190, v190, v71
    v_and_b32 v190, v190, v72
    v_and_b32 v190, v190, v73
    v_and_b32 v190, v190, v74
    v_and_b32 v190, v190, v75
    v_and_b32 v190, v190, v76
    v_and_b32 v190, v190, v77
    v_and_b32 v190, v190, v78
    v_and_b32 v190, v190, v79
    v_cmp_eq_u32 vcc, 1, v190
    s_nop 1
    s_cmp_eq_u64 vcc, exec
    s_cbranch_scc1 L_GOK
L_G1:
    s_sleep 10
    v_and_b32 v189, 31, v0
    v_lshlrev_b32 v189, 2, v189
    global_load_dword v12, v189, s[86:87] sc1
    s_waitcnt vmcnt(0)
    v_cmp_eq_u32 vcc, 8, v12
    s_nop 1
    s_cmp_eq_u64 vcc, exec
    s_cbranch_scc0 L_G1
    v_add_u32 v189, 0, v13
    global_load_dwordx4 v[64:67], v189, s[88:89] offset:96 sc1
    v_add_u32 v189, 860160, v13
    global_load_dwordx4 v[68:71], v189, s[88:89] offset:96 sc1
    v_add_u32 v189, 1720320, v13
    global_load_dwordx4 v[72:75], v189, s[88:89] offset:96 sc1
    v_add_u32 v189, 2580480, v13
    global_load_dwordx4 v[76:79], v189, s[88:89] offset:96 sc1
    s_branch L_GCHK
L_GOK:
    v_cmp_gt_u32 vcc, 48, v0
    s_and_saveexec_b64 s[40:41], vcc
    v_cmp_lt_u32 vcc, 23, v0
    v_mov_b32 v189, 0
    v_mov_b32 v190, 672
    v_cndmask_b32 v189, v189, v190, vcc
    v_lshl_add_u32 v189, v0, 2, v189
    s_mul_i32 s13, s14, 107520
    s_mul_i32 s43, s11, 96
    s_add_u32 s13, s13, s43
    v_add_u32 v189, s13, v189

    v_add_u32 v72, 0, v189
    v_add_u32 v73, 13440, v189
    v_add_u32 v74, 26880, v189
    v_add_u32 v75, 40320, v189
    v_add_u32 v76, 53760, v189
    v_add_u32 v77, 67200, v189
    v_add_u32 v78, 80640, v189
    v_add_u32 v79, 94080, v189
L_A:
    global_load_dword v64, v72, s[88:89] offset:1648 sc1
    global_load_dword v65, v73, s[88:89] offset:1648 sc1
    global_load_dword v66, v74, s[88:89] offset:1648 sc1
    global_load_dword v67, v75, s[88:89] offset:1648 sc1
    global_load_dword v68, v76, s[88:89] offset:1648 sc1
    global_load_dword v69, v77, s[88:89] offset:1648 sc1
    global_load_dword v70, v78, s[88:89] offset:1648 sc1
    global_load_dword v71, v79, s[88:89] offset:1648 sc1
    s_waitcnt vmcnt(0)
    v_and_b32 v188, 1, v64
    v_and_b32 v188, v188, v65
    v_and_b32 v188, v188, v66
    v_and_b32 v188, v188, v67
    v_and_b32 v188, v188, v68
    v_and_b32 v188, v188, v69
    v_and_b32 v188, v188, v70
    v_and_b32 v188, v188, v71
    v_cmp_eq_u32 vcc, 1, v188
    s_nop 1
    s_cmp_eq_u64 vcc, exec
    s_cbranch_scc1 L_A_OK
    s_sleep 1
    s_branch L_A
L_A_OK:
    v_add_f32 v64, v64, v65
    v_add_f32 v66, v66, v67
    v_add_f32 v68, v68, v69
    v_add_f32 v70, v70, v71
    v_add_f32 v64, v64, v66
    v_add_f32 v68, v68, v70
    v_add_f32 v64, v64, v68
    v_cvt_pk_bf16_f32 v64, v64, v64
    v_and_b32 v64, 0xffff0000, v64
    v_lshlrev_b32 v188, 2, v0
    ds_write_b32 v188, v64 offset:0
    s_mov_b64 exec, s[40:41]
L_A_SKIP:
    s_waitcnt vmcnt(0) lgkmcnt(0)
    s_barrier
    v_min_u32 v188, 2, v4
    v_lshlrev_b32 v188, 5, v188

    ds_read_b128 v[72:75], v188 offset:0
    ds_read_b128 v[76:79], v188 offset:16
    ds_read_b128 v[80:83], v188 offset:96
    ds_read_b128 v[84:87], v188 offset:112
    v_mov_b32 v16, 0
    v_mov_b32 v17, 0
    v_mov_b32 v18, 0
    v_mov_b32 v19, 0
    v_mov_b32 v20, 0
    v_mov_b32 v21, 0
    v_mov_b32 v22, 0
    v_mov_b32 v23, 0
    v_mov_b32 v24, 0
    v_mov_b32 v25, 0
    v_mov_b32 v26, 0
    v_mov_b32 v27, 0
    v_mov_b32 v28, 0
    v_mov_b32 v29, 0
    v_mov_b32 v30, 0
    v_mov_b32 v31, 0
    v_accvgpr_read_b32 v96, a0
    v_accvgpr_read_b32 v97, a1
    v_accvgpr_read_b32 v98, a2
    v_accvgpr_read_b32 v99, a3
    v_accvgpr_read_b32 v100, a4
    v_accvgpr_read_b32 v101, a5
    v_accvgpr_read_b32 v102, a6
    v_accvgpr_read_b32 v103, a7
    v_accvgpr_read_b32 v104, a8
    v_accvgpr_read_b32 v105, a9
    v_accvgpr_read_b32 v106, a10
    v_accvgpr_read_b32 v107, a11
    v_accvgpr_read_b32 v108, a12
    v_accvgpr_read_b32 v109, a13
    v_accvgpr_read_b32 v110, a14
    v_accvgpr_read_b32 v111, a15
    v_accvgpr_read_b32 v112, a16
    v_accvgpr_read_b32 v113, a17
    v_accvgpr_read_b32 v114, a18
    v_accvgpr_read_b32 v115, a19
    v_accvgpr_read_b32 v116, a20
    v_accvgpr_read_b32 v117, a21
    v_accvgpr_read_b32 v118, a22
    v_accvgpr_read_b32 v119, a23
    v_accvgpr_read_b32 v120, a24
    v_accvgpr_read_b32 v121, a25
    v_accvgpr_read_b32 v122, a26
    v_accvgpr_read_b32 v123, a27
    v_accvgpr_read_b32 v124, a28
    v_accvgpr_read_b32 v125, a29
    v_accvgpr_read_b32 v126, a30
    v_accvgpr_read_b32 v127, a31
    s_waitcnt lgkmcnt(0)
    v_lshrrev_b32 v188, 16, v72
    v_dot2c_f32_bf16 v16, v96, v188
    v_dot2c_f32_bf16 v17, v96, v72
    v_dot2c_f32_bf16 v18, v97, v188
    v_dot2c_f32_bf16 v19, v97, v72
    v_dot2c_f32_bf16 v20, v98, v188
    v_dot2c_f32_bf16 v21, v98, v72
    v_dot2c_f32_bf16 v22, v99, v188
    v_dot2c_f32_bf16 v23, v99, v72
    v_lshrrev_b32 v188, 16, v73
    v_dot2c_f32_bf16 v16, v100, v188
    v_dot2c_f32_bf16 v17, v100, v73
    v_dot2c_f32_bf16 v18, v101, v188
    v_dot2c_f32_bf16 v19, v101, v73
    v_dot2c_f32_bf16 v20, v102, v188
    v_dot2c_f32_bf16 v21, v102, v73
    v_dot2c_f32_bf16 v22, v103, v188
    v_dot2c_f32_bf16 v23, v103, v73
    v_lshrrev_b32 v188, 16, v74
    v_dot2c_f32_bf16 v16, v104, v188
    v_dot2c_f32_bf16 v17, v104, v74
    v_dot2c_f32_bf16 v18, v105, v188
    v_dot2c_f32_bf16 v19, v105, v74
    v_dot2c_f32_bf16 v20, v106, v188
    v_dot2c_f32_bf16 v21, v106, v74
    v_dot2c_f32_bf16 v22, v107, v188
    v_dot2c_f32_bf16 v23, v107, v74
    v_lshrrev_b32 v188, 16, v75
    v_dot2c_f32_bf16 v16, v108, v188
    v_dot2c_f32_bf16 v17, v108, v75
    v_dot2c_f32_bf16 v18, v109, v188
    v_dot2c_f32_bf16 v19, v109, v75
    v_dot2c_f32_bf16 v20, v110, v188
    v_dot2c_f32_bf16 v21, v110, v75
    v_dot2c_f32_bf16 v22, v111, v188
    v_dot2c_f32_bf16 v23, v111, v75
    v_lshrrev_b32 v188, 16, v76
    v_dot2c_f32_bf16 v16, v112, v188
    v_dot2c_f32_bf16 v17, v112, v76
    v_dot2c_f32_bf16 v18, v113, v188
    v_dot2c_f32_bf16 v19, v113, v76
    v_dot2c_f32_bf16 v20, v114, v188
    v_dot2c_f32_bf16 v21, v114, v76
    v_dot2c_f32_bf16 v22, v115, v188
    v_dot2c_f32_bf16 v23, v115, v76
    v_lshrrev_b32 v188, 16, v77
    v_dot2c_f32_bf16 v16, v116, v188
    v_dot2c_f32_bf16 v17, v116, v77
    v_dot2c_f32_bf16 v18, v117, v188
    v_dot2c_f32_bf16 v19, v117, v77
    v_dot2c_f32_bf16 v20, v118, v188
    v_dot2c_f32_bf16 v21, v118, v77
    v_dot2c_f32_bf16 v22, v119, v188
    v_dot2c_f32_bf16 v23, v119, v77
    v_lshrrev_b32 v188, 16, v78
    v_dot2c_f32_bf16 v16, v120, v188
    v_dot2c_f32_bf16 v17, v120, v78
    v_dot2c_f32_bf16 v18, v121, v188
    v_dot2c_f32_bf16 v19, v121, v78
    v_dot2c_f32_bf16 v20, v122, v188
    v_dot2c_f32_bf16 v21, v122, v78
    v_dot2c_f32_bf16 v22, v123, v188
    v_dot2c_f32_bf16 v23, v123, v78
    v_lshrrev_b32 v188, 16, v79
    v_dot2c_f32_bf16 v16, v124, v188
    v_dot2c_f32_bf16 v17, v124, v79
    v_dot2c_f32_bf16 v18, v125, v188
    v_dot2c_f32_bf16 v19, v125, v79
    v_dot2c_f32_bf16 v20, v126, v188
    v_dot2c_f32_bf16 v21, v126, v79
    v_dot2c_f32_bf16 v22, v127, v188
    v_dot2c_f32_bf16 v23, v127, v79
    v_lshrrev_b32 v188, 16, v80
    v_dot2c_f32_bf16 v24, v96, v188
    v_dot2c_f32_bf16 v25, v96, v80
    v_dot2c_f32_bf16 v26, v97, v188
    v_dot2c_f32_bf16 v27, v97, v80
    v_dot2c_f32_bf16 v28, v98, v188
    v_dot2c_f32_bf16 v29, v98, v80
    v_dot2c_f32_bf16 v30, v99, v188
    v_dot2c_f32_bf16 v31, v99, v80
    v_lshrrev_b32 v188, 16, v81
    v_dot2c_f32_bf16 v24, v100, v188
    v_dot2c_f32_bf16 v25, v100, v81
    v_dot2c_f32_bf16 v26, v101, v188
    v_dot2c_f32_bf16 v27, v101, v81
    v_dot2c_f32_bf16 v28, v102, v188
    v_dot2c_f32_bf16 v29, v102, v81
    v_dot2c_f32_bf16 v30, v103, v188
    v_dot2c_f32_bf16 v31, v103, v81
    v_lshrrev_b32 v188, 16, v82
    v_dot2c_f32_bf16 v24, v104, v188
    v_dot2c_f32_bf16 v25, v104, v82
    v_dot2c_f32_bf16 v26, v105, v188
    v_dot2c_f32_bf16 v27, v105, v82
    v_dot2c_f32_bf16 v28, v106, v188
    v_dot2c_f32_bf16 v29, v106, v82
    v_dot2c_f32_bf16 v30, v107, v188
    v_dot2c_f32_bf16 v31, v107, v82
    v_lshrrev_b32 v188, 16, v83
    v_dot2c_f32_bf16 v24, v108, v188
    v_dot2c_f32_bf16 v25, v108, v83
    v_dot2c_f32_bf16 v26, v109, v188
    v_dot2c_f32_bf16 v27, v109, v83
    v_dot2c_f32_bf16 v28, v110, v188
    v_dot2c_f32_bf16 v29, v110, v83
    v_dot2c_f32_bf16 v30, v111, v188
    v_dot2c_f32_bf16 v31, v111, v83
    v_lshrrev_b32 v188, 16, v84
    v_dot2c_f32_bf16 v24, v112, v188
    v_dot2c_f32_bf16 v25, v112, v84
    v_dot2c_f32_bf16 v26, v113, v188
    v_dot2c_f32_bf16 v27, v113, v84
    v_dot2c_f32_bf16 v28, v114, v188
    v_dot2c_f32_bf16 v29, v114, v84
    v_dot2c_f32_bf16 v30, v115, v188
    v_dot2c_f32_bf16 v31, v115, v84
    v_lshrrev_b32 v188, 16, v85
    v_dot2c_f32_bf16 v24, v116, v188
    v_dot2c_f32_bf16 v25, v116, v85
    v_dot2c_f32_bf16 v26, v117, v188
    v_dot2c_f32_bf16 v27, v117, v85
    v_dot2c_f32_bf16 v28, v118, v188
    v_dot2c_f32_bf16 v29, v118, v85
    v_dot2c_f32_bf16 v30, v119, v188
    v_dot2c_f32_bf16 v31, v119, v85
    v_lshrrev_b32 v188, 16, v86
    v_dot2c_f32_bf16 v24, v120, v188
    v_dot2c_f32_bf16 v25, v120, v86
    v_dot2c_f32_bf16 v26, v121, v188
    v_dot2c_f32_bf16 v27, v121, v86
    v_dot2c_f32_bf16 v28, v122, v188
    v_dot2c_f32_bf16 v29, v122, v86
    v_dot2c_f32_bf16 v30, v123, v188
    v_dot2c_f32_bf16 v31, v123, v86
    v_lshrrev_b32 v188, 16, v87
    v_dot2c_f32_bf16 v24, v124, v188
    v_dot2c_f32_bf16 v25, v124, v87
    v_dot2c_f32_bf16 v26, v125, v188
    v_dot2c_f32_bf16 v27, v125, v87
    v_dot2c_f32_bf16 v28, v126, v188
    v_dot2c_f32_bf16 v29, v126, v87
    v_dot2c_f32_bf16 v30, v127, v188
    v_dot2c_f32_bf16 v31, v127, v87
    s_nop 3
    v_mul_u32_u24 v188, 5120, v4
    v_lshl_add_u32 v188, v5, 5, v188
    ds_write_b128 v188, v[16:19] offset:6144
    ds_write_b128 v188, v[20:23] offset:6160
    ds_write_b128 v188, v[24:27] offset:8704
    ds_write_b128 v188, v[28:31] offset:8720
    s_waitcnt lgkmcnt(0)
    s_barrier
    v_lshlrev_b32 v188, 4, v0

    ds_read_b128 v[64:67], v188 offset:6144
    ds_read_b128 v[68:71], v188 offset:11264
    ds_read_b128 v[72:75], v188 offset:16384
    s_cmp_lg_u32 s12, 0
    s_cbranch_scc1 L_A2
    ds_read_b128 v[76:79], v188 offset:10240
    ds_read_b128 v[80:83], v188 offset:15360
    ds_read_b128 v[84:87], v188 offset:20480
    s_waitcnt lgkmcnt(0)
    v_add_f32 v76, v76, v80
    v_add_f32 v76, v76, v84
    v_or_b32 v76, 1, v76
    v_add_f32 v77, v77, v81
    v_add_f32 v77, v77, v85
    v_or_b32 v77, 1, v77
    v_add_f32 v78, v78, v82
    v_add_f32 v78, v78, v86
    v_or_b32 v78, 1, v78
    v_add_f32 v79, v79, v83
    v_add_f32 v79, v79, v87
    v_or_b32 v79, 1, v79
    s_add_u32 s13, s42, 7280
    v_add_u32 v189, s13, v188
    global_store_dwordx4 v189, v[76:79], s[88:89] sc1
L_A2:
    s_waitcnt lgkmcnt(0)
    v_add_f32 v64, v64, v68
    v_add_f32 v64, v64, v72
    v_or_b32 v64, 1, v64
    v_add_f32 v65, v65, v69
    v_add_f32 v65, v65, v73
    v_or_b32 v65, 1, v65
    v_add_f32 v66, v66, v70
    v_add_f32 v66, v66, v74
    v_or_b32 v66, 1, v66
    v_add_f32 v67, v67, v71
    v_add_f32 v67, v67, v75
    v_or_b32 v67, 1, v67
    v_add_u32 v189, s42, v188
    global_store_dwordx4 v189, v[64:67], s[88:89] offset:3184 sc1
    s_barrier

    s_cmp_ge_u32 s3, 160
    s_cbranch_scc1 L_B_SKIP
    s_cmp_ge_u32 s3, 80
    s_cselect_b32 s50, 1, 0
    s_mul_i32 s51, s50, 80
    s_sub_u32 s51, s3, s51
    v_lshrrev_b32 v189, 1, v0
    v_mul_u32_u24 v189, 13440, v189
    v_and_b32 v190, 1, v0
    v_lshl_add_u32 v189, v190, 4, v189
    s_mul_i32 s13, s50, 2560
    s_lshl_b32 s43, s51, 5
    s_add_u32 s13, s13, s43
    v_add_u32 v189, s13, v189
    v_add_u32 v190, 1720320, v189

L_B:
    global_load_dwordx4 v[64:67], v189, s[88:89] offset:3184 sc1
    global_load_dwordx4 v[68:71], v190, s[88:89] offset:3184 sc1
    s_waitcnt vmcnt(0)
    v_and_b32 v188, 1, v64
    v_and_b32 v188, v188, v65
    v_and_b32 v188, v188, v66
    v_and_b32 v188, v188, v67
    v_and_b32 v188, v188, v68
    v_and_b32 v188, v188, v69
    v_and_b32 v188, v188, v70
    v_and_b32 v188, v188, v71
    v_cmp_eq_u32 vcc, 1, v188
    s_nop 1
    s_cmp_eq_u64 vcc, exec
    s_cbranch_scc1 L_B_OK
    s_sleep 1
    s_branch L_B
L_B_OK:
    v_add_f32 v64, v64, v68
    v_add_f32 v65, v65, v69
    v_add_f32 v66, v66, v70
    v_add_f32 v67, v67, v71
    v_lshlrev_b32 v188, 4, v0
    ds_write_b128 v188, v[64:67] offset:6144
    s_waitcnt lgkmcnt(0)
    s_barrier
    s_cmp_lg_u32 s12, 0
    s_cbranch_scc1 L_B_W
    v_lshrrev_b32 v188, 3, v0
    v_lshlrev_b32 v188, 9, v188
    v_and_b32 v189, 7, v0
    v_lshl_add_u32 v188, v189, 2, v188

    ds_read_b32 v16, v188 offset:6144
    ds_read_b32 v17, v188 offset:6176
    ds_read_b32 v18, v188 offset:6208
    ds_read_b32 v19, v188 offset:6240
    ds_read_b32 v20, v188 offset:6272
    ds_read_b32 v21, v188 offset:6304
    ds_read_b32 v22, v188 offset:6336
    ds_read_b32 v23, v188 offset:6368
    ds_read_b32 v24, v188 offset:6400
    ds_read_b32 v25, v188 offset:6432
    ds_read_b32 v26, v188 offset:6464
    ds_read_b32 v27, v188 offset:6496
    ds_read_b32 v28, v188 offset:6528
    ds_read_b32 v29, v188 offset:6560
    ds_read_b32 v30, v188 offset:6592
    ds_read_b32 v31, v188 offset:6624
    s_waitcnt lgkmcnt(0)
    v_add_f32 v16, v16, v24
    v_add_f32 v17, v17, v25
    v_add_f32 v18, v18, v26
    v_add_f32 v19, v19, v27
    v_add_f32 v20, v20, v28
    v_add_f32 v21, v21, v29
    v_add_f32 v22, v22, v30
    v_add_f32 v23, v23, v31
    v_add_f32 v16, v16, v20
    v_add_f32 v17, v17, v21
    v_add_f32 v18, v18, v22
    v_add_f32 v19, v19, v23
    v_add_f32 v16, v16, v18
    v_add_f32 v17, v17, v19
    v_add_f32 v16, v16, v17
    v_lshlrev_b32 v188, 2, v0
    ds_write_b32 v188, v16 offset:14336
    s_waitcnt lgkmcnt(0)
    v_lshlrev_b32 v188, 2, v189
    ds_read_b32 v16, v188 offset:14336
    ds_read_b32 v17, v188 offset:14368
    ds_read_b32 v18, v188 offset:14400
    ds_read_b32 v19, v188 offset:14432
    ds_read_b32 v20, v188 offset:14464
    ds_read_b32 v21, v188 offset:14496
    ds_read_b32 v22, v188 offset:14528
    ds_read_b32 v23, v188 offset:14560
    s_waitcnt lgkmcnt(0)
    v_add_f32 v16, v16, v20
    v_add_f32 v17, v17, v21
    v_add_f32 v18, v18, v22
    v_add_f32 v19, v19, v23
    v_add_f32 v16, v16, v18
    v_add_f32 v17, v17, v19
    v_add_f32 v16, v16, v17
    v_cvt_pk_bf16_f32 v16, v16, v16
    v_and_b32 v16, 0xffff0000, v16
    v_cmp_gt_u32 vcc, 8, v0
    s_and_saveexec_b64 s[40:41], vcc
    v_lshlrev_b32 v189, 16, v14
    v_add_f32 v11, v189, v16

    v_cvt_pk_bf16_f32 v11, v11, v11
    v_and_b32 v11, 0xffff0000, v11
    v_or_b32 v189, 1, v11
    v_lshl_add_u32 v188, v0, 2, s42
    global_store_dword v188, v189, s[88:89] offset:0 sc1
    s_mov_b64 exec, s[40:41]
L_B_W:
L_B_SKIP:
    s_barrier

    s_cmp_ge_u32 s49, 192
    s_cbranch_scc1 L_C_SKIP
    s_cmp_ge_u32 s12, 2
    s_cbranch_scc1 L_C_NOLN
    s_mul_i32 s13, s12, 80
    v_lshrrev_b32 v189, 2, v1
    v_add_u32 v189, s13, v189
    v_mul_u32_u24 v189, 13440, v189
    v_and_b32 v190, 3, v1
    v_lshl_add_u32 v189, v190, 3, v189

    v_add_u32 v75, 215040, v189
    v_add_u32 v76, 430080, v189
    v_add_u32 v77, 645120, v189
    v_add_u32 v78, 860160, v189
    v_mov_b32 v74, v189
L_C:
    global_load_dwordx2 v[80:81], v74, s[88:89] offset:0 sc1
    global_load_dwordx2 v[82:83], v75, s[88:89] offset:0 sc1
    global_load_dwordx2 v[84:85], v76, s[88:89] offset:0 sc1
    global_load_dwordx2 v[86:87], v77, s[88:89] offset:0 sc1
    global_load_dwordx2 v[88:89], v78, s[88:89] offset:0 sc1
    s_waitcnt vmcnt(0)
    v_and_b32 v188, 1, v80
    v_and_b32 v188, v188, v81
    v_and_b32 v188, v188, v82
    v_and_b32 v188, v188, v83
    v_and_b32 v188, v188, v84
    v_and_b32 v188, v188, v85
    v_and_b32 v188, v188, v86
    v_and_b32 v188, v188, v87
    v_and_b32 v188, v188, v88
    v_and_b32 v188, v188, v89
    v_cmp_eq_u32 vcc, 1, v188
    s_nop 1
    s_cmp_eq_u64 vcc, exec
    s_cbranch_scc1 L_C_OK
    s_sleep 1
    s_branch L_C
L_C_OK:
    v_and_b32 v80, -2, v80
    v_and_b32 v81, -2, v81
    v_and_b32 v82, -2, v82
    v_and_b32 v83, -2, v83
    v_and_b32 v84, -2, v84
    v_and_b32 v85, -2, v85
    v_and_b32 v86, -2, v86
    v_and_b32 v87, -2, v87
    v_and_b32 v88, -2, v88
    v_and_b32 v89, -2, v89
    v_add_f32 v90, v80, v81
    v_add_f32 v90, v90, v82
    v_add_f32 v90, v90, v83
    v_add_f32 v90, v90, v84
    v_add_f32 v90, v90, v85
    v_add_f32 v90, v90, v86
    v_add_f32 v90, v90, v87
    v_add_f32 v90, v90, v88
    v_add_f32 v90, v90, v89
    s_nop 1
    v_add_f32_dpp v91, v90, v90 quad_perm:[1,0,3,2] row_mask:0xf bank_mask:0xf
    s_nop 1
    v_add_f32_dpp v90, v91, v91 quad_perm:[2,3,0,1] row_mask:0xf bank_mask:0xf
    s_nop 1
    v_add_f32_dpp v91, v90, v90 row_half_mirror row_mask:0xf bank_mask:0xf
    s_nop 1
    v_add_f32_dpp v90, v91, v91 row_mirror row_mask:0xf bank_mask:0xf
    s_nop 1
    v_readlane_b32 s44, v90, 0
    v_readlane_b32 s45, v90, 16
    v_readlane_b32 s46, v90, 32
    v_readlane_b32 s47, v90, 48
    s_nop 1
    v_mov_b32 v90, s44
    v_add_f32 v90, s45, v90
    v_add_f32 v90, s46, v90
    v_add_f32 v90, s47, v90
    v_mul_f32 v92, 0x3acccccd, v90
    v_sub_f32 v91, v80, v92
    v_mul_f32 v90, v91, v91
    v_sub_f32 v91, v81, v92
    v_fmac_f32 v90, v91, v91
    v_sub_f32 v91, v82, v92
    v_fmac_f32 v90, v91, v91
    v_sub_f32 v91, v83, v92
    v_fmac_f32 v90, v91, v91
    v_sub_f32 v91, v84, v92
    v_fmac_f32 v90, v91, v91
    v_sub_f32 v91, v85, v92
    v_fmac_f32 v90, v91, v91
    v_sub_f32 v91, v86, v92
    v_fmac_f32 v90, v91, v91
    v_sub_f32 v91, v87, v92
    v_fmac_f32 v90, v91, v91
    v_sub_f32 v91, v88, v92
    v_fmac_f32 v90, v91, v91
    v_sub_f32 v91, v89, v92
    v_fmac_f32 v90, v91, v91
    s_nop 1
    v_add_f32_dpp v91, v90, v90 quad_perm:[1,0,3,2] row_mask:0xf bank_mask:0xf
    s_nop 1
    v_add_f32_dpp v90, v91, v91 quad_perm:[2,3,0,1] row_mask:0xf bank_mask:0xf
    s_nop 1
    v_add_f32_dpp v91, v90, v90 row_half_mirror row_mask:0xf bank_mask:0xf
    s_nop 1
    v_add_f32_dpp v90, v91, v91 row_mirror row_mask:0xf bank_mask:0xf
    s_nop 1
    v_readlane_b32 s44, v90, 0
    v_readlane_b32 s45, v90, 16
    v_readlane_b32 s46, v90, 32
    v_readlane_b32 s47, v90, 48
    s_nop 1
    v_mov_b32 v90, s44
    v_add_f32 v90, s45, v90
    v_add_f32 v90, s46, v90
    v_add_f32 v90, s47, v90
    v_mul_f32 v90, 0x3acccccd, v90
    v_cvt_pk_bf16_f32 v90, v90, v90
    v_and_b32 v90, 0xffff0000, v90
    v_cvt_pk_bf16_f32 v92, v92, v92
    v_and_b32 v92, 0xffff0000, v92
    v_add_f32 v90, 0x3727c5ac, v90
    v_cvt_pk_bf16_f32 v90, v90, v90
    v_and_b32 v90, 0xffff0000, v90
    v_sqrt_f32 v93, v90
    s_nop 0
    v_cvt_pk_bf16_f32 v93, v93, v93
    v_and_b32 v93, 0xffff0000, v93
    v_rcp_f32 v94, v93
    s_nop 0
    v_sub_f32 v80, v80, v92
    v_cvt_pk_bf16_f32 v80, v80, v80
    v_and_b32 v80, 0xffff0000, v80
    v_mul_f32 v95, v80, v94
    v_fma_f32 v91, -v95, v93, v80
    v_fma_f32 v80, v91, v94, v95
    v_cvt_pk_bf16_f32 v80, v80, v80
    v_and_b32 v80, 0xffff0000, v80
    v_sub_f32 v81, v81, v92
    v_cvt_pk_bf16_f32 v81, v81, v81
    v_and_b32 v81, 0xffff0000, v81
    v_mul_f32 v95, v81, v94
    v_fma_f32 v91, -v95, v93, v81
    v_fma_f32 v81, v91, v94, v95
    v_cvt_pk_bf16_f32 v81, v81, v81
    v_and_b32 v81, 0xffff0000, v81
    v_sub_f32 v82, v82, v92
    v_cvt_pk_bf16_f32 v82, v82, v82
    v_and_b32 v82, 0xffff0000, v82
    v_mul_f32 v95, v82, v94
    v_fma_f32 v91, -v95, v93, v82
    v_fma_f32 v82, v91, v94, v95
    v_cvt_pk_bf16_f32 v82, v82, v82
    v_and_b32 v82, 0xffff0000, v82
    v_sub_f32 v83, v83, v92
    v_cvt_pk_bf16_f32 v83, v83, v83
    v_and_b32 v83, 0xffff0000, v83
    v_mul_f32 v95, v83, v94
    v_fma_f32 v91, -v95, v93, v83
    v_fma_f32 v83, v91, v94, v95
    v_cvt_pk_bf16_f32 v83, v83, v83
    v_and_b32 v83, 0xffff0000, v83
    v_sub_f32 v84, v84, v92
    v_cvt_pk_bf16_f32 v84, v84, v84
    v_and_b32 v84, 0xffff0000, v84
    v_mul_f32 v95, v84, v94
    v_fma_f32 v91, -v95, v93, v84
    v_fma_f32 v84, v91, v94, v95
    v_cvt_pk_bf16_f32 v84, v84, v84
    v_and_b32 v84, 0xffff0000, v84
    v_sub_f32 v85, v85, v92
    v_cvt_pk_bf16_f32 v85, v85, v85
    v_and_b32 v85, 0xffff0000, v85
    v_mul_f32 v95, v85, v94
    v_fma_f32 v91, -v95, v93, v85
    v_fma_f32 v85, v91, v94, v95
    v_cvt_pk_bf16_f32 v85, v85, v85
    v_and_b32 v85, 0xffff0000, v85
    v_sub_f32 v86, v86, v92
    v_cvt_pk_bf16_f32 v86, v86, v86
    v_and_b32 v86, 0xffff0000, v86
    v_mul_f32 v95, v86, v94
    v_fma_f32 v91, -v95, v93, v86
    v_fma_f32 v86, v91, v94, v95
    v_cvt_pk_bf16_f32 v86, v86, v86
    v_and_b32 v86, 0xffff0000, v86
    v_sub_f32 v87, v87, v92
    v_cvt_pk_bf16_f32 v87, v87, v87
    v_and_b32 v87, 0xffff0000, v87
    v_mul_f32 v95, v87, v94
    v_fma_f32 v91, -v95, v93, v87
    v_fma_f32 v87, v91, v94, v95
    v_cvt_pk_bf16_f32 v87, v87, v87
    v_and_b32 v87, 0xffff0000, v87
    v_sub_f32 v88, v88, v92
    v_cvt_pk_bf16_f32 v88, v88, v88
    v_and_b32 v88, 0xffff0000, v88
    v_mul_f32 v95, v88, v94
    v_fma_f32 v91, -v95, v93, v88
    v_fma_f32 v88, v91, v94, v95
    v_cvt_pk_bf16_f32 v88, v88, v88
    v_and_b32 v88, 0xffff0000, v88
    v_sub_f32 v89, v89, v92
    v_cvt_pk_bf16_f32 v89, v89, v89
    v_and_b32 v89, 0xffff0000, v89
    v_mul_f32 v95, v89, v94
    v_fma_f32 v91, -v95, v93, v89
    v_fma_f32 v89, v91, v94, v95
    v_cvt_pk_bf16_f32 v89, v89, v89
    v_and_b32 v89, 0xffff0000, v89
    s_mul_i32 s13, s12, 3072
    v_lshl_add_u32 v188, v1, 3, s13
    ds_write_b64 v188, v[80:81] offset:6144
    ds_write_b64 v188, v[82:83] offset:6656
    ds_write_b64 v188, v[84:85] offset:7168
    ds_write_b64 v188, v[86:87] offset:7680
    ds_write_b64 v188, v[88:89] offset:8192
    v_mov_b32 v190, 0
    v_mov_b32 v191, 0
    ds_write_b64 v188, v[190:191] offset:8704
L_C_NOLN:
    v_accvgpr_read_b32 v96, a32
    v_accvgpr_read_b32 v97, a33
    v_accvgpr_read_b32 v98, a34
    v_accvgpr_read_b32 v99, a35
    v_accvgpr_read_b32 v100, a36
    v_accvgpr_read_b32 v101, a37
    v_accvgpr_read_b32 v102, a38
    v_accvgpr_read_b32 v103, a39
    v_accvgpr_read_b32 v104, a40
    v_accvgpr_read_b32 v105, a41
    v_accvgpr_read_b32 v106, a42
    v_accvgpr_read_b32 v107, a43
    v_accvgpr_read_b32 v128, a44
    v_accvgpr_read_b32 v129, a45
    v_accvgpr_read_b32 v130, a46
    v_accvgpr_read_b32 v131, a47
    v_accvgpr_read_b32 v132, a48
    v_accvgpr_read_b32 v133, a49
    v_accvgpr_read_b32 v134, a50
    v_accvgpr_read_b32 v135, a51
    v_accvgpr_read_b32 v136, a52
    v_accvgpr_read_b32 v137, a53
    v_accvgpr_read_b32 v138, a54
    v_accvgpr_read_b32 v139, a55
    v_accvgpr_read_b32 v140, a56
    v_accvgpr_read_b32 v141, a57
    v_accvgpr_read_b32 v142, a58
    v_accvgpr_read_b32 v143, a59
    v_accvgpr_read_b32 v144, a60
    v_accvgpr_read_b32 v145, a61
    v_accvgpr_read_b32 v146, a62
    v_accvgpr_read_b32 v147, a63
    v_accvgpr_read_b32 v148, a64
    v_accvgpr_read_b32 v149, a65
    v_accvgpr_read_b32 v150, a66
    v_accvgpr_read_b32 v151, a67
    v_accvgpr_read_b32 v152, a68
    v_accvgpr_read_b32 v153, a69
    v_accvgpr_read_b32 v154, a70
    v_accvgpr_read_b32 v155, a71
    v_accvgpr_read_b32 v156, a72
    v_accvgpr_read_b32 v157, a73
    v_accvgpr_read_b32 v158, a74
    v_accvgpr_read_b32 v159, a75
    v_mov_b32 v16, 0
    v_mov_b32 v17, 0
    v_mov_b32 v18, 0
    v_mov_b32 v19, 0
    v_mov_b32 v20, 0
    v_mov_b32 v21, 0
    v_mov_b32 v22, 0
    v_mov_b32 v23, 0
    v_mov_b32 v24, 0
    v_mov_b32 v25, 0
    v_mov_b32 v26, 0
    v_mov_b32 v27, 0
    v_mov_b32 v28, 0
    v_mov_b32 v29, 0
    v_mov_b32 v30, 0
    v_mov_b32 v31, 0
    s_waitcnt lgkmcnt(0)
    s_barrier
    v_lshlrev_b32 v188, 2, v0

    ds_read_b32 v64, v188 offset:6144
    ds_read_b32 v65, v188 offset:7168
    ds_read_b32 v66, v188 offset:8192
    ds_read_b32 v67, v188 offset:9216
    ds_read_b32 v68, v188 offset:10240
    ds_read_b32 v69, v188 offset:11264
    s_waitcnt lgkmcnt(0)
    v_lshrrev_b32 v189, 16, v64
    v_dot2c_f32_bf16 v16, v96, v189
    v_dot2c_f32_bf16 v17, v96, v64
    v_dot2c_f32_bf16 v18, v97, v189
    v_dot2c_f32_bf16 v19, v97, v64
    v_dot2c_f32_bf16 v20, v98, v189
    v_dot2c_f32_bf16 v21, v98, v64
    v_dot2c_f32_bf16 v22, v99, v189
    v_dot2c_f32_bf16 v23, v99, v64
    v_lshrrev_b32 v189, 16, v67
    v_dot2c_f32_bf16 v24, v96, v189
    v_dot2c_f32_bf16 v25, v96, v67
    v_dot2c_f32_bf16 v26, v97, v189
    v_dot2c_f32_bf16 v27, v97, v67
    v_dot2c_f32_bf16 v28, v98, v189
    v_dot2c_f32_bf16 v29, v98, v67
    v_dot2c_f32_bf16 v30, v99, v189
    v_dot2c_f32_bf16 v31, v99, v67
    v_lshrrev_b32 v189, 16, v65
    v_dot2c_f32_bf16 v16, v100, v189
    v_dot2c_f32_bf16 v17, v100, v65
    v_dot2c_f32_bf16 v18, v101, v189
    v_dot2c_f32_bf16 v19, v101, v65
    v_dot2c_f32_bf16 v20, v102, v189
    v_dot2c_f32_bf16 v21, v102, v65
    v_dot2c_f32_bf16 v22, v103, v189
    v_dot2c_f32_bf16 v23, v103, v65
    v_lshrrev_b32 v189, 16, v68
    v_dot2c_f32_bf16 v24, v100, v189
    v_dot2c_f32_bf16 v25, v100, v68
    v_dot2c_f32_bf16 v26, v101, v189
    v_dot2c_f32_bf16 v27, v101, v68
    v_dot2c_f32_bf16 v28, v102, v189
    v_dot2c_f32_bf16 v29, v102, v68
    v_dot2c_f32_bf16 v30, v103, v189
    v_dot2c_f32_bf16 v31, v103, v68
    v_lshrrev_b32 v189, 16, v66
    v_dot2c_f32_bf16 v16, v104, v189
    v_dot2c_f32_bf16 v17, v104, v66
    v_dot2c_f32_bf16 v18, v105, v189
    v_dot2c_f32_bf16 v19, v105, v66
    v_dot2c_f32_bf16 v20, v106, v189
    v_dot2c_f32_bf16 v21, v106, v66
    v_dot2c_f32_bf16 v22, v107, v189
    v_dot2c_f32_bf16 v23, v107, v66
    v_lshrrev_b32 v189, 16, v69
    v_dot2c_f32_bf16 v24, v104, v189
    v_dot2c_f32_bf16 v25, v104, v69
    v_dot2c_f32_bf16 v26, v105, v189
    v_dot2c_f32_bf16 v27, v105, v69
    v_dot2c_f32_bf16 v28, v106, v189
    v_dot2c_f32_bf16 v29, v106, v69
    v_dot2c_f32_bf16 v30, v107, v189
    v_dot2c_f32_bf16 v31, v107, v69
    s_nop 3
    v_lshlrev_b32 v188, 6, v0
    ds_write_b128 v188, v[16:19] offset:12288
    ds_write_b128 v188, v[20:23] offset:12304
    ds_write_b128 v188, v[24:27] offset:12320
    ds_write_b128 v188, v[28:31] offset:12336
    s_waitcnt lgkmcnt(0)
    s_barrier
    v_lshrrev_b32 v188, 4, v0
    v_lshlrev_b32 v188, 10, v188
    v_and_b32 v189, 15, v0
    v_lshl_add_u32 v188, v189, 2, v188

    ds_read_b32 v72, v188 offset:12288
    ds_read_b32 v73, v188 offset:12352
    ds_read_b32 v74, v188 offset:12416
    ds_read_b32 v75, v188 offset:12480
    ds_read_b32 v76, v188 offset:12544
    ds_read_b32 v77, v188 offset:12608
    ds_read_b32 v78, v188 offset:12672
    ds_read_b32 v79, v188 offset:12736
    ds_read_b32 v80, v188 offset:12800
    ds_read_b32 v81, v188 offset:12864
    ds_read_b32 v82, v188 offset:12928
    ds_read_b32 v83, v188 offset:12992
    ds_read_b32 v84, v188 offset:13056
    ds_read_b32 v85, v188 offset:13120
    ds_read_b32 v86, v188 offset:13184
    ds_read_b32 v87, v188 offset:13248
    s_waitcnt lgkmcnt(0)
    v_add_f32 v72, v72, v80
    v_add_f32 v73, v73, v81
    v_add_f32 v74, v74, v82
    v_add_f32 v75, v75, v83
    v_add_f32 v76, v76, v84
    v_add_f32 v77, v77, v85
    v_add_f32 v78, v78, v86
    v_add_f32 v79, v79, v87
    v_add_f32 v72, v72, v76
    v_add_f32 v73, v73, v77
    v_add_f32 v74, v74, v78
    v_add_f32 v75, v75, v79
    v_add_f32 v72, v72, v74
    v_add_f32 v73, v73, v75
    v_add_f32 v72, v72, v73
    v_lshlrev_b32 v188, 2, v0
    ds_write_b32 v188, v72 offset:0
    s_waitcnt lgkmcnt(0)
    s_barrier
    v_cmp_gt_u32 vcc, 16, v0
    s_and_saveexec_b64 s[40:41], vcc
    s_cbranch_execz L_C_NOACT

    ds_read_b32 v16, v188 offset:0
    ds_read_b32 v17, v188 offset:64
    ds_read_b32 v18, v188 offset:128
    ds_read_b32 v19, v188 offset:192
    ds_read_b32 v20, v188 offset:256
    ds_read_b32 v21, v188 offset:320
    ds_read_b32 v22, v188 offset:384
    ds_read_b32 v23, v188 offset:448
    ds_read_b32 v24, v188 offset:512
    ds_read_b32 v25, v188 offset:576
    ds_read_b32 v26, v188 offset:640
    ds_read_b32 v27, v188 offset:704
    ds_read_b32 v28, v188 offset:768
    ds_read_b32 v29, v188 offset:832
    ds_read_b32 v30, v188 offset:896
    ds_read_b32 v31, v188 offset:960
    s_waitcnt lgkmcnt(0)

    v_add_f32 v16, v16, v24
    v_add_f32 v17, v17, v25
    v_add_f32 v18, v18, v26
    v_add_f32 v19, v19, v27
    v_add_f32 v20, v20, v28
    v_add_f32 v21, v21, v29
    v_add_f32 v22, v22, v30
    v_add_f32 v23, v23, v31
    v_add_f32 v16, v16, v20
    v_add_f32 v17, v17, v21
    v_add_f32 v18, v18, v22
    v_add_f32 v19, v19, v23
    v_add_f32 v16, v16, v18
    v_add_f32 v17, v17, v19
    v_add_f32 v16, v16, v17
    v_cvt_pk_bf16_f32 v16, v16, v16
    v_and_b32 v16, 0xffff0000, v16
    v_lshlrev_b32 v190, 16, v15
    v_add_f32 v16, v16, v190
    v_cvt_pk_bf16_f32 v16, v16, v16
    v_and_b32 v16, 0xffff0000, v16
    v_max_f32 v16, 0, v16
    v_mul_f32 v16, v16, v16
    v_cvt_pk_bf16_f32 v16, v16, v16
    v_and_b32 v16, 0xffff0000, v16
    ds_write_b32 v188, v16 offset:5120
L_C_NOACT:
    s_mov_b64 exec, s[40:41]
    s_waitcnt lgkmcnt(0)
    s_barrier
    v_cmp_gt_u32 vcc, 160, v0
    s_and_saveexec_b64 s[40:41], vcc
    s_cbranch_execz L_C_END
    v_lshlrev_b32 v188, 5, v4
    ds_read_b128 v[72:75], v188 offset:5120
    ds_read_b128 v[76:79], v188 offset:5136

    v_mov_b32 v16, 0
    v_mov_b32 v17, 0
    v_mov_b32 v18, 0
    v_mov_b32 v19, 0
    v_mov_b32 v20, 0
    v_mov_b32 v21, 0
    v_mov_b32 v22, 0
    v_mov_b32 v23, 0
    s_waitcnt lgkmcnt(0)
    v_lshrrev_b32 v189, 16, v72
    v_dot2c_f32_bf16 v16, v128, v189
    v_dot2c_f32_bf16 v17, v128, v72
    v_dot2c_f32_bf16 v18, v129, v189
    v_dot2c_f32_bf16 v19, v129, v72
    v_dot2c_f32_bf16 v20, v130, v189
    v_dot2c_f32_bf16 v21, v130, v72
    v_dot2c_f32_bf16 v22, v131, v189
    v_dot2c_f32_bf16 v23, v131, v72
    v_lshrrev_b32 v189, 16, v73
    v_dot2c_f32_bf16 v16, v132, v189
    v_dot2c_f32_bf16 v17, v132, v73
    v_dot2c_f32_bf16 v18, v133, v189
    v_dot2c_f32_bf16 v19, v133, v73
    v_dot2c_f32_bf16 v20, v134, v189
    v_dot2c_f32_bf16 v21, v134, v73
    v_dot2c_f32_bf16 v22, v135, v189
    v_dot2c_f32_bf16 v23, v135, v73
    v_lshrrev_b32 v189, 16, v74
    v_dot2c_f32_bf16 v16, v136, v189
    v_dot2c_f32_bf16 v17, v136, v74
    v_dot2c_f32_bf16 v18, v137, v189
    v_dot2c_f32_bf16 v19, v137, v74
    v_dot2c_f32_bf16 v20, v138, v189
    v_dot2c_f32_bf16 v21, v138, v74
    v_dot2c_f32_bf16 v22, v139, v189
    v_dot2c_f32_bf16 v23, v139, v74
    v_lshrrev_b32 v189, 16, v75
    v_dot2c_f32_bf16 v16, v140, v189
    v_dot2c_f32_bf16 v17, v140, v75
    v_dot2c_f32_bf16 v18, v141, v189
    v_dot2c_f32_bf16 v19, v141, v75
    v_dot2c_f32_bf16 v20, v142, v189
    v_dot2c_f32_bf16 v21, v142, v75
    v_dot2c_f32_bf16 v22, v143, v189
    v_dot2c_f32_bf16 v23, v143, v75
    v_lshrrev_b32 v189, 16, v76
    v_dot2c_f32_bf16 v16, v144, v189
    v_dot2c_f32_bf16 v17, v144, v76
    v_dot2c_f32_bf16 v18, v145, v189
    v_dot2c_f32_bf16 v19, v145, v76
    v_dot2c_f32_bf16 v20, v146, v189
    v_dot2c_f32_bf16 v21, v146, v76
    v_dot2c_f32_bf16 v22, v147, v189
    v_dot2c_f32_bf16 v23, v147, v76
    v_lshrrev_b32 v189, 16, v77
    v_dot2c_f32_bf16 v16, v148, v189
    v_dot2c_f32_bf16 v17, v148, v77
    v_dot2c_f32_bf16 v18, v149, v189
    v_dot2c_f32_bf16 v19, v149, v77
    v_dot2c_f32_bf16 v20, v150, v189
    v_dot2c_f32_bf16 v21, v150, v77
    v_dot2c_f32_bf16 v22, v151, v189
    v_dot2c_f32_bf16 v23, v151, v77
    v_lshrrev_b32 v189, 16, v78
    v_dot2c_f32_bf16 v16, v152, v189
    v_dot2c_f32_bf16 v17, v152, v78
    v_dot2c_f32_bf16 v18, v153, v189
    v_dot2c_f32_bf16 v19, v153, v78
    v_dot2c_f32_bf16 v20, v154, v189
    v_dot2c_f32_bf16 v21, v154, v78
    v_dot2c_f32_bf16 v22, v155, v189
    v_dot2c_f32_bf16 v23, v155, v78
    v_lshrrev_b32 v189, 16, v79
    v_dot2c_f32_bf16 v16, v156, v189
    v_dot2c_f32_bf16 v17, v156, v79
    v_dot2c_f32_bf16 v18, v157, v189
    v_dot2c_f32_bf16 v19, v157, v79
    v_dot2c_f32_bf16 v20, v158, v189
    v_dot2c_f32_bf16 v21, v158, v79
    v_dot2c_f32_bf16 v22, v159, v189
    v_dot2c_f32_bf16 v23, v159, v79
    s_nop 3
    v_or_b32 v16, 1, v16
    v_or_b32 v17, 1, v17
    v_or_b32 v18, 1, v18
    v_or_b32 v19, 1, v19
    v_or_b32 v20, 1, v20
    v_or_b32 v21, 1, v21
    v_or_b32 v22, 1, v22
    v_or_b32 v23, 1, v23
    v_mul_u32_u24 v188, 2560, v4
    v_lshl_add_u32 v188, v5, 5, v188
    s_mul_i32 s13, s49, 13440
    s_add_u32 s13, s13, 8304
    v_add_u32 v188, s13, v188
    global_store_dwordx4 v188, v[16:19], s[88:89] sc1
    global_store_dwordx4 v188, v[20:23], s[88:89] offset:16 sc1
L_C_END:
    s_mov_b64 exec, s[40:41]
L_C_SKIP:
    s_barrier

    s_cmp_ge_u32 s3, 160
    s_cbranch_scc1 L_END
    v_lshrrev_b32 v189, 1, v0
    v_mul_u32_u24 v189, 13440, v189
    v_and_b32 v190, 1, v0
    v_lshl_add_u32 v189, v190, 4, v189
    s_mul_i32 s13, s50, 2560
    s_lshl_b32 s43, s51, 5
    s_add_u32 s13, s13, s43
    s_add_u32 s13, s13, 8304
    v_add_u32 v189, s13, v189
    s_cmp_ge_u32 s12, 2
    s_cbranch_scc1 L_D_ONE
    v_add_u32 v190, 1720320, v189

L_D2:
    global_load_dwordx4 v[64:67], v189, s[88:89] sc1
    global_load_dwordx4 v[68:71], v190, s[88:89] sc1
    s_waitcnt vmcnt(0)
    v_and_b32 v188, 1, v64
    v_and_b32 v188, v188, v65
    v_and_b32 v188, v188, v66
    v_and_b32 v188, v188, v67
    v_and_b32 v188, v188, v68
    v_and_b32 v188, v188, v69
    v_and_b32 v188, v188, v70
    v_and_b32 v188, v188, v71
    v_cmp_eq_u32 vcc, 1, v188
    s_nop 1
    s_cmp_eq_u64 vcc, exec
    s_cbranch_scc1 L_D2_OK
    s_sleep 1
    s_branch L_D2
L_D2_OK:
    v_add_f32 v64, v64, v68
    v_add_f32 v65, v65, v69
    v_add_f32 v66, v66, v70
    v_add_f32 v67, v67, v71
    s_branch L_D_J
L_D_ONE:
L_D1:
    global_load_dwordx4 v[64:67], v189, s[88:89] sc1
    s_waitcnt vmcnt(0)
    v_and_b32 v188, 1, v64
    v_and_b32 v188, v188, v65
    v_and_b32 v188, v188, v66
    v_and_b32 v188, v188, v67
    v_cmp_eq_u32 vcc, 1, v188
    s_nop 1
    s_cmp_eq_u64 vcc, exec
    s_cbranch_scc1 L_D1_OK
    s_sleep 1
    s_branch L_D1
L_D1_OK:
L_D_J:
    v_lshlrev_b32 v188, 4, v0
    ds_write_b128 v188, v[64:67] offset:6144
    s_waitcnt lgkmcnt(0)
    s_barrier
    s_cmp_lg_u32 s12, 0
    s_cbranch_scc1 L_D_W
    v_lshrrev_b32 v188, 3, v0
    v_lshlrev_b32 v188, 9, v188
    v_and_b32 v189, 7, v0
    v_lshl_add_u32 v188, v189, 2, v188

    ds_read_b32 v16, v188 offset:6144
    ds_read_b32 v17, v188 offset:6176
    ds_read_b32 v18, v188 offset:6208
    ds_read_b32 v19, v188 offset:6240
    ds_read_b32 v20, v188 offset:6272
    ds_read_b32 v21, v188 offset:6304
    ds_read_b32 v22, v188 offset:6336
    ds_read_b32 v23, v188 offset:6368
    ds_read_b32 v24, v188 offset:6400
    ds_read_b32 v25, v188 offset:6432
    ds_read_b32 v26, v188 offset:6464
    ds_read_b32 v27, v188 offset:6496
    ds_read_b32 v28, v188 offset:6528
    ds_read_b32 v29, v188 offset:6560
    ds_read_b32 v30, v188 offset:6592
    ds_read_b32 v31, v188 offset:6624
    s_waitcnt lgkmcnt(0)
    v_add_f32 v16, v16, v24
    v_add_f32 v17, v17, v25
    v_add_f32 v18, v18, v26
    v_add_f32 v19, v19, v27
    v_add_f32 v20, v20, v28
    v_add_f32 v21, v21, v29
    v_add_f32 v22, v22, v30
    v_add_f32 v23, v23, v31
    v_add_f32 v16, v16, v20
    v_add_f32 v17, v17, v21
    v_add_f32 v18, v18, v22
    v_add_f32 v19, v19, v23
    v_add_f32 v16, v16, v18
    v_add_f32 v17, v17, v19
    v_add_f32 v16, v16, v17
    v_lshlrev_b32 v188, 2, v0
    ds_write_b32 v188, v16 offset:14336
    s_waitcnt lgkmcnt(0)
    v_lshlrev_b32 v188, 2, v189
    ds_read_b32 v16, v188 offset:14336
    ds_read_b32 v17, v188 offset:14368
    ds_read_b32 v18, v188 offset:14400
    ds_read_b32 v19, v188 offset:14432
    ds_read_b32 v20, v188 offset:14464
    ds_read_b32 v21, v188 offset:14496
    ds_read_b32 v22, v188 offset:14528
    ds_read_b32 v23, v188 offset:14560
    s_waitcnt lgkmcnt(0)
    v_add_f32 v16, v16, v20
    v_add_f32 v17, v17, v21
    v_add_f32 v18, v18, v22
    v_add_f32 v19, v19, v23
    v_add_f32 v16, v16, v18
    v_add_f32 v17, v17, v19
    v_add_f32 v16, v16, v17
    v_cvt_pk_bf16_f32 v16, v16, v16
    v_and_b32 v16, 0xffff0000, v16
    v_cmp_gt_u32 vcc, 8, v0
    s_and_saveexec_b64 s[40:41], vcc
    v_lshlrev_b32 v189, 16, v3
    v_add_f32 v16, v16, v189

    v_cvt_pk_bf16_f32 v16, v16, v16
    v_and_b32 v16, 0xffff0000, v16
    v_add_f32 v16, v11, v16
    v_cvt_pk_bf16_f32 v16, v16, v16
    v_and_b32 v16, 0xffff0000, v16
    s_lshl_b32 s13, s3, 3
    v_add_u32 v188, s13, v0
    v_lshlrev_b32 v188, 1, v188
    global_store_short_d16_hi v188, v16, s[84:85]
L_D_W:
L_END:

    s_endpgm
.section .rodata,"a"
.p2align 6
.amdhsa_kernel sequential_preLN__mha_block_cached__dense_activation_squared_relu__decode_kernel
  .amdhsa_next_free_vgpr 368
  .amdhsa_next_free_sgpr 102
  .amdhsa_accum_offset 196
  .amdhsa_group_segment_fixed_size 0
  .amdhsa_kernarg_size 104
  .amdhsa_user_sgpr_count 2
  .amdhsa_user_sgpr_kernarg_segment_ptr 1
  .amdhsa_system_sgpr_workgroup_id_x 1
  .amdhsa_float_denorm_mode_32 3
.end_amdhsa_kernel
```
